```python
import torch

def _softmax(x, axis=-1):
    return torch.softmax(x, dim=axis)
def _gelu(x):
    return torch.nn.functional.gelu(x, approximate="tanh")
def _silu(x):
    return torch.nn.functional.silu(x)
def _sigmoid(x):
    return torch.sigmoid(x)
def _layernorm(x, axis=-1, eps=1e-5):
    m = x.mean(dim=axis, keepdim=True)
    v = x.var(dim=axis, keepdim=True, unbiased=False)
    return (x - m) / torch.sqrt(v + eps)
def _scatter_add(tgt, idx, src, axis=0):
    return tgt.clone().index_add_(axis, idx, src)
def _segment_sum(src, seg, n):
    out = torch.zeros((n,) + src.shape[1:], dtype=src.dtype)
    return out.index_add_(0, seg, src)
def _pad(x, pw):
    flat = tuple(v for pair in reversed(pw) for v in pair)
    return torch.nn.functional.pad(x, flat)

kernel_name = 'interleave_layers__spectral_gfnet__glu_gated_reglu__prompt'

def setup_inputs():

    _w = (lambda a: (lambda t: t.to(torch.bfloat16) if t.is_floating_point() else t)(torch.as_tensor(a)))
    def _A_setup():
        B, S, D = 1, 2048, 640
        Df = D // 2 + 1
        return {
            "x": _w((lambda *s: torch.randn(*s, dtype=torch.bfloat16) * 0.05)(B, S, D)),
            "w_r": _w((lambda *s: torch.randn(*s, dtype=torch.bfloat16) * 0.4)(S, Df) * 0.02),
            "w_i": _w((lambda *s: torch.randn(*s, dtype=torch.bfloat16) * 0.4)(S, Df) * 0.02),
        }
    _A_in = _A_setup()

    def _B_setup():
        B, S, D, F = 1, 2048, 640, 1536
        return {
            "x": _w((lambda *s: torch.randn(*s, dtype=torch.bfloat16) * 0.05)(B, S, D)),
            "W_gate": _w((lambda *s: torch.randn(*s, dtype=torch.bfloat16) * 0.2)(D, F) * (2.0 / D) ** 0.5),
            "W_up": _w((lambda *s: torch.randn(*s, dtype=torch.bfloat16) * 0.2)(D, F) * (2.0 / D) ** 0.5),
            "W_down": _w((lambda *s: torch.randn(*s, dtype=torch.bfloat16) * 0.2)(F, D) * (1.0 / F) ** 0.5),
        }
    _B_in = _B_setup()

    return {
        "A_x": _A_in["x"],
        "A_w_r": _A_in["w_r"],
        "A_w_i": _A_in["w_i"],
        "B_x": _B_in["x"],
        "B_W_gate": _B_in["W_gate"],
        "B_W_up": _B_in["W_up"],
        "B_W_down": _B_in["W_down"],
    }

def reference(A_x, A_w_r, A_w_i, B_x, B_W_gate, B_W_up, B_W_down):
    def _A_ref(x, w_r, w_i):
        B, S, D = x.shape
        X = (lambda x, axes=(-2,-1): torch.fft.rfft2(x.float(), dim=axes))(x, axes=(-2, -1))
        W = w_r + 1j * w_i
        X = X * W
        y = (lambda x, s, axes=(-2,-1): torch.fft.irfft2(x, s=s, dim=axes).to(torch.bfloat16))(X, (S, D), axes=(-2, -1))
        return y

    def _B_ref(x, W_gate, W_up, W_down):
        gate = torch.einsum("bsd,df->bsf", x, W_gate)
        up = torch.einsum("bsd,df->bsf", x, W_up)
        gate = gate * (lambda x, dt: x.to(dt))(gate > 0, gate.dtype)
        h = gate * up
        return torch.einsum("bsf,fd->bsd", h, W_down)

    x = A_x
    x = x + _A_ref(_layernorm(x, axis=-1), A_w_r, A_w_i)
    x = x + _B_ref(_layernorm(x, axis=-1), B_W_gate, B_W_up, B_W_down)
    x = x + _A_ref(_layernorm(x, axis=-1), A_w_r, A_w_i)
    x = x + _B_ref(_layernorm(x, axis=-1), B_W_gate, B_W_up, B_W_down)
    return x
```

```asm
; @launch grid=(256,1,1) block=(256,1,1) lds=163840
.amdgcn_target "amdgcn-amd-amdhsa--gfx950"
.text
.globl interleave_layers__spectral_gfnet__glu_gated_reglu__prompt_kernel
.p2align 12
.p2align 8
.type interleave_layers__spectral_gfnet__glu_gated_reglu__prompt_kernel,@function
interleave_layers__spectral_gfnet__glu_gated_reglu__prompt_kernel:
    s_load_dwordx16 s[16:31], s[0:1], 0
    s_load_dwordx4 s[32:35], s[0:1], 64
    s_lshr_b32 s49, s2, 3
    s_cmp_ge_u32 s49, 32
    s_cbranch_scc1 L_end
    s_getpc_b64 s[12:13]
L_pc:
    s_mov_b32 s14, L_last-L_pc
    s_mov_b32 s15, 0x00020000
    s_lshl_b32 s4, s49, 12
    v_lshlrev_b32 v74, 4, v0
    buffer_load_dword v74, v74, s[12:15], s4 offen
    s_cmp_ge_u32 s49, 20
    s_cbranch_scc1 L_pw
    s_cmp_ge_u32 s49, 16
    s_cbranch_scc1 L_ptr
L_px:
    v_lshrrev_b32 v1, 6, v0
    v_and_b32 v0, 63, v0
    v_readfirstlane_b32 s3, v1
    v_and_b32 v1, 15, v0
    v_lshrrev_b32_e64 v2, 4, v0
    s_mul_i32 s92, s49, 128
    s_and_b32 s66, s2, 1
    s_and_b32 s67, s49, 3
    s_and_b32 s50, s2, 2
    s_lshl_b32 s50, s50, 1
    s_add_u32 s67, s67, s50
    s_lshl_b32 s65, s66, 3
    s_add_u32 s65, s65, s67
    s_mov_b32 s68, 0
    s_mul_i32 s48, s3, 3
    s_and_b32 s71, s48, 14
    s_add_u32 s71, s71, s48
    s_lshl_b32 s71, s71, 12
    s_mov_b32 s10, 268435456
    s_mov_b32 s11, 0x00020000
    s_movk_i32 s38, 256
    s_mov_b32 s39, 0x00020000
    v_lshrrev_b32 v14, 3, v0
    v_and_b32_e64 v15, 7, v0
    s_and_b32 s5, s2, 7
    s_lshl_b32 s5, s5, 4
    s_lshr_b32 s48, s2, 3
    s_add_u32 s5, s5, s48
    s_lshr_b32 s48, s5, 6
    s_lshl_b32 s48, s48, 1
    s_and_b32 s49, s5, 1
    s_add_u32 s48, s48, s49
    s_bfe_u32 s49, s5, 0x10005
    s_lshl_b32 s49, s49, 7
    s_add_u32 s48, s48, s49
    s_bfe_u32 s49, s5, 0x20001
    s_lshl_b32 s49, s49, 5
    s_add_u32 s48, s48, s49
    s_and_b32 s49, s5, 24
    s_add_u32 s48, s48, s49
    s_and_b32 s50, s3, 1
    s_lshl_b32 s49, s50, 2
    s_add_u32 s48, s48, s49
    s_mul_i32 s48, s48, 10240
    s_lshr_b32 s51, s3, 1
    s_lshl_b32 s49, s51, 7
    s_add_u32 s48, s48, s49
    v_mul_u32_u24 v4, 1280, v14
    v_lshl_add_u32 v4, v15, 4, v4
    s_mov_b32 s42, 2621440
    s_mov_b32 s43, 0x00020000
    s_waitcnt lgkmcnt(0)
    s_mov_b64 s[40:41], s[16:17]
    buffer_load_dwordx4 v[48:51], v4, s[40:43], s48 offen offset:0 nt
    buffer_load_dwordx4 v[52:55], v4, s[40:43], s48 offen offset:256 nt
    buffer_load_dwordx4 v[56:59], v4, s[40:43], s48 offen offset:512 nt
    buffer_load_dwordx4 v[60:63], v4, s[40:43], s48 offen offset:768 nt
    buffer_load_dwordx4 v[64:67], v4, s[40:43], s48 offen offset:1024 nt
    s_mov_b64 s[8:9], s[34:35]
    s_mov_b64 s[36:37], s[32:33]
    s_bitcmp1_b32 s3, 0
    s_cselect_b32 s84, s26, s24
    s_cselect_b32 s85, s27, s25
    s_mov_b32 s86, 1966080
    s_mov_b32 s87, 0x00020000
    s_lshr_b32 s48, s2, 3
    s_lshl_b32 s48, s48, 2
    s_add_u32 s48, s48, s3
    s_lshr_b32 s48, s48, 1
    s_mul_i32 s48, s48, 61440
    s_and_b32 s49, s2, 7
    s_mul_i32 s49, s49, 384
    s_sub_u32 s50, s49, 128
    s_and_b32 s50, s50, 0x380
    s_cmp_lt_u32 s50, 384
    s_cselect_b32 s50, 20, 0
    s_and_b32 s49, s49, 0xc00
    s_add_u32 s49, s49, 384
    v_mul_u32_u24 v5, 3072, v0
    s_add_u32 s48, s48, s49
    v_cmp_gt_u32 vcc, s50, v0
    s_nop 1
    v_cndmask_b32_e64 v5, -16, v5, vcc
    buffer_load_dword v75, v5, s[84:87], s48 offen
    s_mov_b32 s40, s18
    s_mov_b32 s41, s19
    s_mov_b32 s42, 1314816
    s_mov_b32 s43, 0x00020000
    s_mov_b32 s44, s20
    s_mov_b32 s45, s21
    s_mov_b32 s46, 1314816
    s_mov_b32 s47, 0x00020000
    s_bfe_u32 s48, s5, 0x30002
    s_lshl_b32 s48, s48, 2
    s_add_u32 s48, s48, s3
    s_lshl_b32 s48, s48, 2
    s_bfe_u32 s49, s5, 0x20005
    s_add_u32 s48, s48, s49
    s_lshl_b32 s48, s48, 2
    s_and_b32 s49, s5, 3
    s_add_u32 s48, s48, s49
    s_mul_i32 s48, s48, 2568
    s_mul_i32 s49, s3, 2688
    s_add_u32 s49, s49, 40960
    v_lshlrev_b32 v6, 4, v0
    v_cmp_gt_u32 vcc, 42, v0
    s_nop 1
    v_cndmask_b32_e64 v5, -8, 0, vcc
    v_lshl_add_u32 v5, v5, 2, v6
    s_add_u32 m0, s49, 0
    s_nop 0
    buffer_load_dwordx4 v5, s[40:43], s48 offen nt lds
    s_add_u32 m0, s49, 10752
    s_nop 0
    buffer_load_dwordx4 v5, s[44:47], s48 offen nt lds
    v_cmp_gt_u32_e64 vcc, 20, v0
    s_nop 1
    v_cndmask_b32_e64 v5, -7, 0, vcc
    v_cmp_gt_u32 vcc, 62, v0
    s_nop 1
    v_cndmask_b32_e64 v5, -15, v5, vcc
    v_lshl_add_u32 v5, v5, 2, v6
    s_add_u32 s48, s48, 992
    s_add_u32 m0, s49, 1024
    s_nop 0
    buffer_load_dwordx4 v5, s[40:43], s48 offen nt lds
    s_add_u32 m0, s49, 11776
    s_nop 0
    buffer_load_dwordx4 v5, s[44:47], s48 offen nt lds
    s_add_u32 s48, s48, 964
    s_mov_b32 exec_hi, 0xff
    s_add_u32 m0, s49, 2048
    s_nop 0
    buffer_load_dwordx4 v6, s[40:43], s48 offen nt lds
    s_add_u32 m0, s49, 12800
    s_nop 0
    buffer_load_dwordx4 v6, s[44:47], s48 offen nt lds
    s_mov_b32 exec_hi, -1
    s_xor_b32 s4, s3, 0
    s_lshl_b32 s4, s4, 8
    v_and_or_b32 v77, v0, 12, s4
    s_cselect_b32 s4, 0, 1
    buffer_load_dword v76, v77, s[36:39], 0 offen offset:128 sc1
    s_lshl_b32 s48, s3, 4
    v_add_u32 v5, s48, v1
    v_cmp_eq_u32 s[62:63], 0, v5
    v_mul_u32_u24 v5, 77, v5
    v_and_b32 v5, 127, v5
    v_cvt_f32_u32_e64 v5, v5
    v_mul_f32 v5, 0x3c000000, v5
    v_mul_f32 v6, 0x41c80000, v5
    v_lshlrev_b32 v4, 3, v2
    v_cvt_f32_u32 v4, v4
    v_mul_f32_e64 v4, v4, v5
    v_mov_b32 v11, 0xbf803f80
    v_bfe_i32 v3, v1, 0, 1
    v_and_b32 v3, 0x80008000, v3
    v_cos_f32_e64 v7, v4
    v_sin_f32 v9, -v4
    v_add_f32 v4, v4, v5
    v_cos_f32 v8, v4
    v_sin_f32 v10, -v4
    v_add_f32_e64 v4, v4, v5
    v_cvt_pk_bf16_f32 v16, v7, v8
    v_cvt_pk_bf16_f32 v20, v9, v10
    v_xor_b32_e64 v32, v3, v16
    v_cndmask_b32 v20, v20, v11, s[62:63]
    v_xor_b32 v36, v3, v20
    v_cos_f32 v7, v4
    v_sin_f32 v9, -v4
    v_add_f32 v4, v4, v5
    v_cos_f32 v8, v4
    v_sin_f32 v10, -v4
    v_add_f32_e64 v4, v4, v5
    v_cvt_pk_bf16_f32 v17, v7, v8
    v_cvt_pk_bf16_f32 v21, v9, v10
    v_xor_b32_e64 v33, v3, v17
    v_cndmask_b32 v21, v21, v11, s[62:63]
    v_xor_b32 v37, v3, v21
    v_cos_f32 v7, v4
    v_sin_f32 v9, -v4
    v_add_f32 v4, v4, v5
    v_cos_f32 v8, v4
    v_sin_f32 v10, -v4
    v_add_f32_e64 v4, v4, v5
    v_cvt_pk_bf16_f32 v18, v7, v8
    v_cvt_pk_bf16_f32 v22, v9, v10
    v_xor_b32_e64 v34, v3, v18
    v_cndmask_b32 v22, v22, v11, s[62:63]
    v_xor_b32 v38, v3, v22
    v_cos_f32 v7, v4
    v_sin_f32 v9, -v4
    v_add_f32 v4, v4, v5
    v_cos_f32 v8, v4
    v_sin_f32 v10, -v4
    v_add_f32_e64 v4, v4, v6
    v_cvt_pk_bf16_f32 v19, v7, v8
    v_cvt_pk_bf16_f32 v23, v9, v10
    v_xor_b32_e64 v35, v3, v19
    v_cndmask_b32 v23, v23, v11, s[62:63]
    v_xor_b32 v39, v3, v23
    v_cos_f32 v7, v4
    v_sin_f32 v9, -v4
    v_add_f32 v4, v4, v5
    v_cos_f32 v8, v4
    v_sin_f32 v10, -v4
    v_add_f32_e64 v4, v4, v5
    v_cvt_pk_bf16_f32 v24, v7, v8
    v_cvt_pk_bf16_f32 v28, v9, v10
    v_xor_b32_e64 v40, v3, v24
    v_cndmask_b32 v28, v28, v11, s[62:63]
    v_xor_b32 v44, v3, v28
    v_cos_f32 v7, v4
    v_sin_f32 v9, -v4
    v_add_f32 v4, v4, v5
    v_cos_f32 v8, v4
    v_sin_f32 v10, -v4
    v_add_f32_e64 v4, v4, v5
    v_cvt_pk_bf16_f32 v25, v7, v8
    v_cvt_pk_bf16_f32 v29, v9, v10
    v_xor_b32_e64 v41, v3, v25
    v_cndmask_b32 v29, v29, v11, s[62:63]
    v_xor_b32 v45, v3, v29
    v_cos_f32 v7, v4
    v_sin_f32 v9, -v4
    v_add_f32 v4, v4, v5
    v_cos_f32 v8, v4
    v_sin_f32 v10, -v4
    v_add_f32_e64 v4, v4, v5
    v_cvt_pk_bf16_f32 v26, v7, v8
    v_cvt_pk_bf16_f32 v30, v9, v10
    v_xor_b32_e64 v42, v3, v26
    v_cndmask_b32 v30, v30, v11, s[62:63]
    v_xor_b32 v46, v3, v30
    v_cos_f32 v7, v4
    v_sin_f32 v9, -v4
    v_add_f32 v4, v4, v5
    v_cos_f32 v8, v4
    v_sin_f32 v10, -v4
    v_add_f32_e64 v4, v4, v6
    v_cvt_pk_bf16_f32 v27, v7, v8
    v_cvt_pk_bf16_f32 v31, v9, v10
    v_xor_b32_e64 v43, v3, v27
    v_cndmask_b32 v31, v31, v11, s[62:63]
    v_xor_b32_e64 v47, v3, v31
    s_mov_b32 s84, 0x3d64f92e
    s_mov_b32 s85, 0x3c8d8369
    s_mov_b32 s86, 0xbd393e4c
    s_mov_b32 s87, 0xbd59c440
    s_mov_b32 s88, 0xbd069650
    s_mov_b32 s89, 0x3d59c440
    v_add_u32 v4, s3, v2
    v_cmp_eq_u32 vcc, 0, v4
    v_mov_b32 v13, 1.0
    v_mov_b32 v4, 0
    v_mov_b32 v221, 0x3d64f92e
    v_mov_b32 v5, 0x3d21e89b
    v_cndmask_b32 v12, v13, v4, vcc
    v_mov_b32 v223, v221
    v_cndmask_b32 v220, v221, v5, vcc
    v_cndmask_b32 v222, v221, v5, vcc
    s_and_b32 s50, s3, 1
    s_lshr_b32 s51, s3, 1
    s_lshl_b32 s50, s50, 3
    v_add_u32 v6, s50, v14
    v_xor_b32 v6, v6, v15
    v_lshlrev_b32 v6, 4, v6
    s_lshl_b32 s51, s51, 3
    v_add_u32 v4, s51, v15
    v_and_b32_e64 v5, 3, v4
    v_lshl_add_u32 v6, v5, 8, v6
    v_lshrrev_b32_e64 v5, 2, v4
    v_mul_u32_u24 v5, 5120, v5
    v_add_u32 v6, v6, v5
    v_add_u32 v5, 0, v4
    v_mul_u32_u24 v7, 205, v5
    v_lshrrev_b32 v7, 10, v7
    v_mul_u32_u24 v7, 5, v7
    v_sub_u32_e64 v5, v5, v7
    v_lshl_add_u32 v68, v5, 10, v6
    v_add_u32_e64 v5, 1, v4
    v_mul_u32_u24 v7, 205, v5
    v_lshrrev_b32 v7, 10, v7
    v_mul_u32_u24 v7, 5, v7
    v_sub_u32_e64 v5, v5, v7
    v_lshl_add_u32 v69, v5, 10, v6
    v_add_u32_e64 v5, 2, v4
    v_mul_u32_u24 v7, 205, v5
    v_lshrrev_b32 v7, 10, v7
    v_mul_u32_u24 v7, 5, v7
    v_sub_u32_e64 v5, v5, v7
    v_lshl_add_u32 v70, v5, 10, v6
    v_add_u32_e64 v5, 3, v4
    v_mul_u32_u24 v7, 205, v5
    v_lshrrev_b32 v7, 10, v7
    v_mul_u32_u24 v7, 5, v7
    v_sub_u32_e64 v5, v5, v7
    v_lshl_add_u32 v71, v5, 10, v6
    v_add_u32_e64 v5, 4, v4
    v_mul_u32_u24 v7, 205, v5
    v_lshrrev_b32 v7, 10, v7
    v_mul_u32_u24 v7, 5, v7
    v_sub_u32_e64 v5, v5, v7
    v_lshl_add_u32 v72, v5, 10, v6
    s_mov_b32 s91, 0x80008000
    s_lshl_b32 s90, s3, 4
    v_cvt_f32_u32 v3, v2
    v_add_u32 v11, s90, v1
    v_cvt_f32_u32 v11, v11
    v_mul_f32 v5, 0x3c800000, v11
    v_mul_f32 v4, 0x41000000, v3
    v_mul_f32 v4, v4, v5
    v_cos_f32 v6, v4
    v_sin_f32 v8, v4
    v_add_f32 v4, v4, v5
    v_cos_f32 v7, v4
    v_sin_f32 v9, v4
    v_add_f32_e64 v4, v4, v5
    v_cvt_pk_bf16_f32 v128, v6, v7
    v_cvt_pk_bf16_f32 v132, v8, v9
    v_xor_b32 v136, s91, v132
    v_cos_f32 v6, v4
    v_sin_f32 v8, v4
    v_add_f32 v4, v4, v5
    v_cos_f32 v7, v4
    v_sin_f32 v9, v4
    v_add_f32_e64 v4, v4, v5
    v_cvt_pk_bf16_f32 v129, v6, v7
    v_cvt_pk_bf16_f32 v133, v8, v9
    v_xor_b32 v137, s91, v133
    v_cos_f32 v6, v4
    v_sin_f32 v8, v4
    v_add_f32 v4, v4, v5
    v_cos_f32 v7, v4
    v_sin_f32 v9, v4
    v_add_f32_e64 v4, v4, v5
    v_cvt_pk_bf16_f32 v130, v6, v7
    v_cvt_pk_bf16_f32 v134, v8, v9
    v_xor_b32 v138, s91, v134
    v_cos_f32 v6, v4
    v_sin_f32 v8, v4
    v_add_f32 v4, v4, v5
    v_cos_f32 v7, v4
    v_sin_f32 v9, v4
    v_add_f32_e64 v4, v4, v5
    v_cvt_pk_bf16_f32 v131, v6, v7
    v_cvt_pk_bf16_f32 v135, v8, v9
    v_xor_b32_e64 v139, s91, v135
    v_mul_f32 v5, 0x3a000000, v11
    v_mul_f32 v10, 0x41500000, v5
    v_mul_f32 v4, 4.0, v3
    v_mul_f32 v4, v4, v5
    v_cos_f32 v224, v4
    v_sin_f32 v232, v4
    v_add_f32 v4, v4, v5
    v_cos_f32 v225, v4
    v_sin_f32 v233, v4
    v_add_f32 v4, v4, v5
    v_cos_f32 v226, v4
    v_sin_f32 v234, v4
    v_add_f32 v4, v4, v5
    v_cos_f32 v227, v4
    v_sin_f32 v235, v4
    v_add_f32 v4, v4, v10
    v_cos_f32 v228, v4
    v_sin_f32 v236, v4
    v_add_f32 v4, v4, v5
    v_cos_f32 v229, v4
    v_sin_f32 v237, v4
    v_add_f32 v4, v4, v5
    v_cos_f32 v230, v4
    v_sin_f32 v238, v4
    v_add_f32 v4, v4, v5
    v_cos_f32 v231, v4
    v_sin_f32_e64 v239, v4
    v_bfe_i32 v11, v1, 0, 1
    v_and_b32 v11, s91, v11
    v_xor_b32 v140, v11, v128
    v_xor_b32 v141, v11, v129
    v_xor_b32 v142, v11, v130
    v_xor_b32 v143, v11, v131
    v_xor_b32 v144, v11, v132
    v_xor_b32 v145, v11, v133
    v_xor_b32 v146, v11, v134
    v_xor_b32 v147, v11, v135
    v_xor_b32 v148, v11, v136
    v_xor_b32 v149, v11, v137
    v_xor_b32 v150, v11, v138
    v_xor_b32_e64 v151, v11, v139
    s_mov_b32 s54, 0xffff
    s_waitcnt vmcnt(9)
    v_bfi_b32 v176, s54, v48, v60
    s_waitcnt vmcnt(8)
    v_bfi_b32 v177, s54, v53, v65
    v_bfi_b32 v178, s54, v58, v50
    v_bfi_b32 v179, s54, v63, v55
    ds_write_b128 v68, v[176:179] offset:0
    v_bfi_b32 v180, s54, v52, v64
    v_bfi_b32 v181, s54, v57, v49
    v_bfi_b32 v182, s54, v62, v54
    v_bfi_b32 v183, s54, v67, v59
    ds_write_b128 v69, v[180:183] offset:0
    v_bfi_b32 v184, s54, v56, v48
    v_bfi_b32 v185, s54, v61, v53
    v_bfi_b32 v186, s54, v66, v58
    v_bfi_b32 v187, s54, v51, v63
    ds_write_b128 v70, v[184:187] offset:0
    v_bfi_b32 v188, s54, v60, v52
    v_bfi_b32 v189, s54, v65, v57
    v_bfi_b32 v190, s54, v50, v62
    v_bfi_b32 v191, s54, v55, v67
    ds_write_b128 v71, v[188:191] offset:0
    v_bfi_b32 v176, s54, v64, v56
    v_bfi_b32 v177, s54, v49, v61
    v_bfi_b32 v178, s54, v54, v66
    v_bfi_b32 v179, s54, v59, v51
    ds_write_b128 v72, v[176:179] offset:0
    v_xor_b32 v4, v1, v2
    v_lshlrev_b32 v4, 4, v4
    v_lshl_add_u32 v4, v2, 8, v4
    v_xor_b32_e64 v5, 64, v4
    s_waitcnt lgkmcnt(0)
    s_barrier
    ds_read_b128 v[176:179], v4 offset:0
    ds_read_b128 v[180:183], v4 offset:1024
    ds_read_b128 v[184:187], v4 offset:2048
    ds_read_b128 v[188:191], v4 offset:3072
    ds_read_b128 v[192:195], v4 offset:4096
    ds_read_b128 v[196:199], v5 offset:5120
    ds_read_b128 v[200:203], v5 offset:6144
    ds_read_b128 v[204:207], v5 offset:7168
    s_waitcnt lgkmcnt(7)
    v_mfma_f32_16x16x32_bf16 v[88:91], v[16:19], v[176:179], 0
    v_mfma_f32_16x16x32_bf16 v[92:95], v[20:23], v[176:179], 0
    ds_read_b128 v[176:179], v5 offset:8192
    s_waitcnt lgkmcnt(7)
    v_mfma_f32_16x16x32_bf16 v[96:99], v[16:19], v[180:183], 0
    v_mfma_f32_16x16x32_bf16 v[100:103], v[20:23], v[180:183], 0
    ds_read_b128 v[180:183], v5 offset:9216
    s_waitcnt lgkmcnt(7)
    v_mfma_f32_16x16x32_bf16 v[104:107], v[16:19], v[184:187], 0
    v_mfma_f32_16x16x32_bf16 v[108:111], v[20:23], v[184:187], 0
    ds_read_b128 v[184:187], v4 offset:10240
    s_waitcnt lgkmcnt(7)
    v_mfma_f32_16x16x32_bf16 v[112:115], v[16:19], v[188:191], 0
    v_mfma_f32_16x16x32_bf16 v[116:119], v[20:23], v[188:191], 0
    ds_read_b128 v[188:191], v4 offset:11264
    s_waitcnt lgkmcnt(7)
    v_mfma_f32_16x16x32_bf16 v[120:123], v[16:19], v[192:195], 0
    v_mfma_f32_16x16x32_bf16 v[124:127], v[20:23], v[192:195], 0
    ds_read_b128 v[192:195], v4 offset:12288
    s_waitcnt lgkmcnt(7)
    v_mfma_f32_16x16x32_bf16 v[88:91], v[24:27], v[196:199], v[88:91]
    v_mfma_f32_16x16x32_bf16 v[92:95], v[28:31], v[196:199], v[92:95]
    ds_read_b128 v[196:199], v4 offset:13312
    s_waitcnt lgkmcnt(7)
    v_mfma_f32_16x16x32_bf16 v[96:99], v[24:27], v[200:203], v[96:99]
    v_mfma_f32_16x16x32_bf16 v[100:103], v[28:31], v[200:203], v[100:103]
    ds_read_b128 v[200:203], v4 offset:14336
    s_waitcnt lgkmcnt(7)
    v_mfma_f32_16x16x32_bf16 v[104:107], v[24:27], v[204:207], v[104:107]
    v_mfma_f32_16x16x32_bf16 v[108:111], v[28:31], v[204:207], v[108:111]
    ds_read_b128 v[204:207], v5 offset:15360
    s_waitcnt lgkmcnt(7)
    v_mfma_f32_16x16x32_bf16 v[112:115], v[24:27], v[176:179], v[112:115]
    v_mfma_f32_16x16x32_bf16 v[116:119], v[28:31], v[176:179], v[116:119]
    ds_read_b128 v[176:179], v5 offset:16384
    s_waitcnt lgkmcnt(7)
    v_mfma_f32_16x16x32_bf16 v[120:123], v[24:27], v[180:183], v[120:123]
    v_mfma_f32_16x16x32_bf16 v[124:127], v[28:31], v[180:183], v[124:127]
    ds_read_b128 v[180:183], v5 offset:17408
    s_waitcnt lgkmcnt(7)
    v_mfma_f32_16x16x32_bf16 v[88:91], v[32:35], v[184:187], v[88:91]
    v_mfma_f32_16x16x32_bf16 v[92:95], v[36:39], v[184:187], v[92:95]
    ds_read_b128 v[184:187], v5 offset:18432
    s_waitcnt lgkmcnt(7)
    v_mfma_f32_16x16x32_bf16 v[96:99], v[32:35], v[188:191], v[96:99]
    v_mfma_f32_16x16x32_bf16 v[100:103], v[36:39], v[188:191], v[100:103]
    ds_read_b128 v[188:191], v5 offset:19456
    s_waitcnt lgkmcnt(7)
    v_mfma_f32_16x16x32_bf16 v[104:107], v[32:35], v[192:195], v[104:107]
    v_mfma_f32_16x16x32_bf16 v[108:111], v[36:39], v[192:195], v[108:111]
    s_waitcnt lgkmcnt(6)
    v_mfma_f32_16x16x32_bf16 v[112:115], v[32:35], v[196:199], v[112:115]
    v_mfma_f32_16x16x32_bf16 v[116:119], v[36:39], v[196:199], v[116:119]
    s_waitcnt lgkmcnt(5)
    v_mfma_f32_16x16x32_bf16 v[120:123], v[32:35], v[200:203], v[120:123]
    v_mfma_f32_16x16x32_bf16 v[124:127], v[36:39], v[200:203], v[124:127]
    s_waitcnt lgkmcnt(4)
    v_mfma_f32_16x16x32_bf16 v[88:91], v[40:43], v[204:207], v[88:91]
    v_mfma_f32_16x16x32_bf16 v[92:95], v[44:47], v[204:207], v[92:95]
    s_waitcnt lgkmcnt(3)
    v_mfma_f32_16x16x32_bf16 v[96:99], v[40:43], v[176:179], v[96:99]
    v_mfma_f32_16x16x32_bf16 v[100:103], v[44:47], v[176:179], v[100:103]
    s_waitcnt lgkmcnt(2)
    v_mfma_f32_16x16x32_bf16 v[104:107], v[40:43], v[180:183], v[104:107]
    v_mfma_f32_16x16x32_bf16 v[108:111], v[44:47], v[180:183], v[108:111]
    s_waitcnt lgkmcnt(1)
    v_mfma_f32_16x16x32_bf16 v[112:115], v[40:43], v[184:187], v[112:115]
    v_mfma_f32_16x16x32_bf16 v[116:119], v[44:47], v[184:187], v[116:119]
    s_waitcnt lgkmcnt(0)
    v_mfma_f32_16x16x32_bf16 v[120:123], v[40:43], v[188:191], v[120:123]
    v_mfma_f32_16x16x32_bf16 v[124:127], v[44:47], v[188:191], v[124:127]
    v_and_b32 v4, 3, v14
    v_lshrrev_b32 v6, 5, v0
    v_lshl_add_u32 v4, v4, 2, v6
    v_lshlrev_b32_e64 v4, 13, v4
    v_lshl_add_u32 v4, v15, 4, v4
    s_mul_i32 s48, s3, 655360
    s_and_b32 s49, s5, 64
    s_add_u32 s49, s49, s5
    s_add_u32 s48, s48, 4194304
    s_lshl_b32 s49, s49, 7
    s_add_u32 s48, s48, s49
    s_cmp_eq_u32 s3, 3
    s_nop 0
    s_cselect_b32 s50, 0xffa80000, 0
    s_add_u32 s50, s50, 131072
    v_pk_add_f32 v[208:209], v[96:97], v[120:121]
    v_pk_add_f32 v[210:211], v[104:105], v[112:113]
    v_pk_add_f32 v[212:213], v[96:97], v[120:121] neg_lo:[0,1] neg_hi:[0,1]
    v_pk_add_f32 v[214:215], v[104:105], v[112:113] neg_lo:[0,1] neg_hi:[0,1]
    v_pk_mul_f32 v[216:217], v[88:89], s[84:85] op_sel_hi:[1,0]
    v_pk_add_f32 v[88:89], v[88:89], v[208:209]
    v_pk_fma_f32 v[96:97], v[208:209], s[84:85], v[216:217] op_sel:[0,1,0]
    v_pk_fma_f32 v[104:105], v[208:209], s[86:87], v[216:217] op_sel_hi:[1,0,1]
    v_pk_mul_f32 v[120:121], v[212:213], s[86:87] op_sel:[0,1]
    v_pk_mul_f32 v[112:113], v[212:213], s[88:89] op_sel_hi:[1,0]
    v_pk_add_f32 v[88:89], v[88:89], v[210:211]
    v_pk_fma_f32 v[96:97], v[210:211], s[86:87], v[96:97] op_sel_hi:[1,0,1]
    v_pk_fma_f32 v[104:105], v[210:211], s[84:85], v[104:105] op_sel:[0,1,0]
    v_pk_fma_f32 v[120:121], v[214:215], s[88:89], v[120:121] op_sel_hi:[1,0,1]
    v_pk_fma_f32 v[112:113], v[214:215], s[88:89], v[112:113] op_sel:[0,1,0]
    v_pk_mul_f32 v[88:89], v[88:89], v[220:221]
    v_pk_add_f32 v[208:209], v[100:101], v[124:125]
    v_pk_add_f32 v[210:211], v[108:109], v[116:117]
    v_pk_add_f32 v[212:213], v[100:101], v[124:125] neg_lo:[0,1] neg_hi:[0,1]
    v_pk_add_f32 v[214:215], v[108:109], v[116:117] neg_lo:[0,1] neg_hi:[0,1]
    v_pk_mul_f32 v[216:217], v[92:93], s[84:85] op_sel_hi:[1,0]
    v_pk_add_f32 v[92:93], v[92:93], v[208:209]
    v_pk_fma_f32 v[100:101], v[208:209], s[84:85], v[216:217] op_sel:[0,1,0]
    v_pk_fma_f32 v[108:109], v[208:209], s[86:87], v[216:217] op_sel_hi:[1,0,1]
    v_pk_mul_f32 v[124:125], v[212:213], s[86:87] op_sel:[0,1]
    v_pk_mul_f32 v[116:117], v[212:213], s[88:89] op_sel_hi:[1,0]
    v_pk_add_f32 v[92:93], v[92:93], v[210:211]
    v_pk_fma_f32 v[100:101], v[210:211], s[86:87], v[100:101] op_sel_hi:[1,0,1]
    v_pk_fma_f32 v[108:109], v[210:211], s[84:85], v[108:109] op_sel:[0,1,0]
    v_pk_fma_f32 v[124:125], v[214:215], s[88:89], v[124:125] op_sel_hi:[1,0,1]
    v_pk_fma_f32 v[116:117], v[214:215], s[88:89], v[116:117] op_sel:[0,1,0]
    v_pk_mul_f32 v[92:93], v[92:93], v[222:223]
    v_pk_fma_f32 v[218:219], v[124:125], v[12:13], v[96:97] neg_lo:[1,0,0] neg_hi:[1,0,0]
    v_pk_fma_f32 v[124:125], v[96:97], v[12:13], v[124:125]
    v_pk_fma_f32 v[96:97], v[100:101], v[12:13], v[120:121]
    v_pk_fma_f32 v[100:101], v[120:121], v[12:13], v[100:101] neg_lo:[1,0,0] neg_hi:[1,0,0]
    v_pk_fma_f32 v[120:121], v[116:117], v[12:13], v[104:105] neg_lo:[1,0,0] neg_hi:[1,0,0]
    v_pk_fma_f32 v[116:117], v[104:105], v[12:13], v[116:117]
    v_pk_fma_f32 v[104:105], v[108:109], v[12:13], v[112:113]
    v_pk_fma_f32 v[108:109], v[112:113], v[12:13], v[108:109] neg_lo:[1,0,0] neg_hi:[1,0,0]
    v_pk_add_f32 v[208:209], v[98:99], v[122:123]
    v_pk_add_f32 v[210:211], v[106:107], v[114:115]
    v_pk_add_f32 v[212:213], v[98:99], v[122:123] neg_lo:[0,1] neg_hi:[0,1]
    v_pk_add_f32 v[214:215], v[106:107], v[114:115] neg_lo:[0,1] neg_hi:[0,1]
    v_pk_mul_f32 v[216:217], v[90:91], s[84:85] op_sel_hi:[1,0]
    v_pk_add_f32 v[90:91], v[90:91], v[208:209]
    v_pk_fma_f32 v[98:99], v[208:209], s[84:85], v[216:217] op_sel:[0,1,0]
    v_pk_fma_f32 v[106:107], v[208:209], s[86:87], v[216:217] op_sel_hi:[1,0,1]
    v_pk_mul_f32 v[122:123], v[212:213], s[86:87] op_sel:[0,1]
    v_pk_mul_f32 v[114:115], v[212:213], s[88:89] op_sel_hi:[1,0]
    v_pk_add_f32 v[90:91], v[90:91], v[210:211]
    v_pk_fma_f32 v[98:99], v[210:211], s[86:87], v[98:99] op_sel_hi:[1,0,1]
    v_pk_fma_f32 v[106:107], v[210:211], s[84:85], v[106:107] op_sel:[0,1,0]
    v_pk_fma_f32 v[122:123], v[214:215], s[88:89], v[122:123] op_sel_hi:[1,0,1]
    v_pk_fma_f32 v[114:115], v[214:215], s[88:89], v[114:115] op_sel:[0,1,0]
    v_pk_mul_f32 v[90:91], v[90:91], s[84:85] op_sel_hi:[1,0]
    v_pk_add_f32 v[208:209], v[102:103], v[126:127]
    v_pk_add_f32 v[210:211], v[110:111], v[118:119]
    v_pk_add_f32 v[212:213], v[102:103], v[126:127] neg_lo:[0,1] neg_hi:[0,1]
    v_pk_add_f32 v[214:215], v[110:111], v[118:119] neg_lo:[0,1] neg_hi:[0,1]
    v_pk_mul_f32 v[216:217], v[94:95], s[84:85] op_sel_hi:[1,0]
    v_pk_add_f32 v[94:95], v[94:95], v[208:209]
    v_pk_fma_f32 v[102:103], v[208:209], s[84:85], v[216:217] op_sel:[0,1,0]
    v_pk_fma_f32 v[110:111], v[208:209], s[86:87], v[216:217] op_sel_hi:[1,0,1]
    v_pk_mul_f32 v[126:127], v[212:213], s[86:87] op_sel:[0,1]
    v_pk_mul_f32 v[118:119], v[212:213], s[88:89] op_sel_hi:[1,0]
    v_pk_add_f32 v[94:95], v[94:95], v[210:211]
    v_pk_fma_f32 v[102:103], v[210:211], s[86:87], v[102:103] op_sel_hi:[1,0,1]
    v_pk_fma_f32 v[110:111], v[210:211], s[84:85], v[110:111] op_sel:[0,1,0]
    v_pk_fma_f32 v[126:127], v[214:215], s[88:89], v[126:127] op_sel_hi:[1,0,1]
    v_pk_fma_f32 v[118:119], v[214:215], s[88:89], v[118:119] op_sel:[0,1,0]
    v_pk_mul_f32 v[94:95], v[94:95], s[84:85] op_sel_hi:[1,0]
    v_pk_add_f32 v[112:113], v[98:99], v[126:127] neg_lo:[0,1] neg_hi:[0,1]
    v_pk_add_f32 v[126:127], v[126:127], v[98:99]
    v_pk_add_f32 v[98:99], v[122:123], v[102:103]
    v_pk_add_f32 v[102:103], v[102:103], v[122:123] neg_lo:[0,1] neg_hi:[0,1]
    v_pk_add_f32 v[122:123], v[106:107], v[118:119] neg_lo:[0,1] neg_hi:[0,1]
    v_pk_add_f32 v[118:119], v[118:119], v[106:107]
    v_pk_add_f32 v[106:107], v[114:115], v[110:111]
    v_pk_add_f32 v[110:111], v[110:111], v[114:115] neg_lo:[0,1] neg_hi:[0,1]
    v_pk_mul_f32 v[208:209], v[88:89], v[12:13]
    v_pk_mul_f32 v[208:209], v[208:209], v[88:89]
    v_pk_mul_f32 v[210:211], v[90:91], v[90:91]
    v_pk_fma_f32 v[208:209], v[92:93], v[92:93], v[208:209]
    v_pk_fma_f32 v[210:211], v[94:95], v[94:95], v[210:211]
    v_pk_fma_f32 v[208:209], v[218:219], v[218:219], v[208:209]
    v_pk_fma_f32 v[208:209], v[96:97], v[96:97], v[208:209]
    v_pk_fma_f32 v[210:211], v[112:113], v[112:113], v[210:211]
    v_pk_fma_f32 v[210:211], v[98:99], v[98:99], v[210:211]
    v_pk_fma_f32 v[208:209], v[120:121], v[120:121], v[208:209]
    v_pk_fma_f32 v[208:209], v[104:105], v[104:105], v[208:209]
    v_pk_fma_f32 v[210:211], v[122:123], v[122:123], v[210:211]
    v_pk_fma_f32 v[210:211], v[106:107], v[106:107], v[210:211]
    v_pk_fma_f32 v[208:209], v[116:117], v[116:117], v[208:209]
    v_pk_fma_f32 v[208:209], v[108:109], v[108:109], v[208:209]
    v_pk_fma_f32 v[210:211], v[118:119], v[118:119], v[210:211]
    v_pk_fma_f32 v[210:211], v[110:111], v[110:111], v[210:211]
    v_pk_fma_f32 v[208:209], v[124:125], v[124:125], v[208:209]
    v_pk_fma_f32 v[208:209], v[100:101], v[100:101], v[208:209]
    v_pk_fma_f32 v[210:211], v[126:127], v[126:127], v[210:211]
    v_pk_fma_f32 v[210:211], v[102:103], v[102:103], v[210:211]
    v_pk_add_f32 v[208:209], v[208:209], v[210:211]
    v_add_f32 v8, v208, v209
    s_lshl_b32 s49, s3, 8
    v_lshl_add_u32 v9, v0, 2, s49
    ds_write_b32 v9, v8 offset:20480
    s_movk_i32 s51, 8184
    v_cvt_pk_bf16_f32 v176, v88, v92
    v_cvt_pk_bf16_f32 v177, v89, v93
    v_cvt_pk_bf16_f32 v178, v90, v94
    v_cvt_pk_bf16_f32 v179, v91, v95
    v_mov_b32 v6, v176
    v_mov_b32_e64 v7, v177
    v_mov_b32_dpp v176, v178 row_ror:8 row_mask:0xf bank_mask:0xc
    v_mov_b32_dpp v177, v179 row_ror:8 row_mask:0xf bank_mask:0xc
    v_mov_b32_dpp v178, v6 row_ror:8 row_mask:0xf bank_mask:0x3
    v_mov_b32_dpp v179, v7 row_ror:8 row_mask:0xf bank_mask:0x3
    buffer_store_dwordx4 v[176:179], v4, s[8:11], s48 offen sc1
    s_add_u32 s48, s48, s50
    v_cvt_pk_bf16_f32 v180, v218, v96
    v_cvt_pk_bf16_f32 v181, v219, v97
    v_cvt_pk_bf16_f32 v182, v112, v98
    v_cvt_pk_bf16_f32 v183, v113, v99
    v_mov_b32 v6, v180
    v_mov_b32_e64 v7, v181
    v_mov_b32_dpp v180, v182 row_ror:8 row_mask:0xf bank_mask:0xc
    v_mov_b32_dpp v181, v183 row_ror:8 row_mask:0xf bank_mask:0xc
    v_mov_b32_dpp v182, v6 row_ror:8 row_mask:0xf bank_mask:0x3
    v_mov_b32_dpp v183, v7 row_ror:8 row_mask:0xf bank_mask:0x3
    buffer_store_dwordx4 v[180:183], v4, s[8:11], s48 offen sc1
    s_add_u32 s48, s48, 131072
    v_lshlrev_b32 v9, 2, v0
    s_waitcnt vmcnt(3)
    s_waitcnt lgkmcnt(0)
    s_barrier
    ds_read_b32 v208, v9 offset:20480
    ds_read_b32 v209, v9 offset:20736
    ds_read_b32 v210, v9 offset:20992
    ds_read_b32 v211, v9 offset:21248
    v_cvt_pk_bf16_f32 v184, v120, v104
    v_cvt_pk_bf16_f32 v185, v121, v105
    v_cvt_pk_bf16_f32 v186, v122, v106
    v_cvt_pk_bf16_f32 v187, v123, v107
    v_mov_b32 v6, v184
    v_mov_b32 v7, v185
    v_mov_b32_dpp v184, v186 row_ror:8 row_mask:0xf bank_mask:0xc
    v_mov_b32_dpp v185, v187 row_ror:8 row_mask:0xf bank_mask:0xc
    v_mov_b32_dpp v186, v6 row_ror:8 row_mask:0xf bank_mask:0x3
    v_mov_b32_dpp v187, v7 row_ror:8 row_mask:0xf bank_mask:0x3
    buffer_store_dwordx4 v[184:187], v4, s[8:11], s48 offen sc1
    s_add_u32 s48, s48, 131072
    v_cvt_pk_bf16_f32 v188, v116, v108
    v_cvt_pk_bf16_f32 v189, v117, v109
    v_cvt_pk_bf16_f32 v190, v118, v110
    v_cvt_pk_bf16_f32 v191, v119, v111
    v_mov_b32 v6, v188
    v_mov_b32 v7, v189
    v_mov_b32_dpp v188, v190 row_ror:8 row_mask:0xf bank_mask:0xc
    v_mov_b32_dpp v189, v191 row_ror:8 row_mask:0xf bank_mask:0xc
    v_mov_b32_dpp v190, v6 row_ror:8 row_mask:0xf bank_mask:0x3
    v_mov_b32_dpp v191, v7 row_ror:8 row_mask:0xf bank_mask:0x3
    buffer_store_dwordx4 v[188:191], v4, s[8:11], s48 offen sc1
    s_add_u32 s48, s48, 131072
    v_lshlrev_b32_e64 v9, 3, v15
    v_lshl_add_u32 v9, v14, 2, v9
    v_mad_u32_u24 v9, v2, s51, v9
    s_lshl_b32 s49, s5, 6
    s_add_u32 s49, s49, 131072
    s_waitcnt lgkmcnt(0)
    v_pk_add_f32 v[208:209], v[208:209], v[210:211]
    v_add_f32 v8, v208, v209
    v_mov_b32 v5, v8
    s_nop 1
    v_permlane32_swap_b32 v8, v5
    v_add_f32 v8, v8, v5
    v_mov_b32 v5, v8
    s_nop 1
    v_permlane16_swap_b32 v8, v5
    v_add_f32 v8, v8, v5
    s_cmp_eq_u32 s3, 0
    s_cbranch_scc0 L_ss_6
    s_mov_b32 exec_hi, 0
    buffer_store_dword v8, v9, s[8:11], s49 offen sc1
    s_mov_b32 exec_hi, -1
L_ss_6:
    v_cvt_pk_bf16_f32 v192, v124, v100
    v_cvt_pk_bf16_f32 v193, v125, v101
    v_cvt_pk_bf16_f32 v194, v126, v102
    v_cvt_pk_bf16_f32 v195, v127, v103
    v_mov_b32 v6, v192
    v_mov_b32_e64 v7, v193
    v_mov_b32_dpp v192, v194 row_ror:8 row_mask:0xf bank_mask:0xc
    v_mov_b32_dpp v193, v195 row_ror:8 row_mask:0xf bank_mask:0xc
    v_mov_b32_dpp v194, v6 row_ror:8 row_mask:0xf bank_mask:0x3
    v_mov_b32_dpp v195, v7 row_ror:8 row_mask:0xf bank_mask:0x3
    buffer_store_dwordx4 v[192:195], v4, s[8:11], s48 offen sc1
    s_waitcnt vmcnt(5)
    buffer_load_dword v76, v77, s[36:39], 0 offen offset:0 sc1
    v_and_b32 v6, 3, v0
    v_lshrrev_b32_e64 v7, 2, v0
    v_mul_u32_u24 v8, 336, v6
    v_and_b32_e64 v5, 1, v0
    v_add3_u32 v8, v8, v7, v5
    s_mul_i32 s48, s3, 160
    v_lshl_add_u32 v8, v8, 1, s48
    ds_read_u16 v16, v8 offset:40962
    ds_read_u16 v20, v8 offset:51714
    ds_read_u16 v17, v8 offset:43650
    ds_read_u16 v21, v8 offset:54402
    ds_read_u16 v18, v8 offset:46338
    ds_read_u16 v22, v8 offset:57090
    ds_read_u16 v19, v8 offset:49026
    ds_read_u16 v23, v8 offset:59778
    s_mul_i32 s48, s3, 655360
    s_lshl_b32 s49, s5, 6
    s_add_u32 s48, s48, 27000832
    v_and_b32 v5, 7, v7
    v_lshlrev_b32 v5, 7, v5
    v_xor_b32 v5, s49, v5
    v_lshl_add_u32 v7, v7, 13, v5
    v_lshl_add_u32 v60, v6, 4, v7
    s_mov_b32 s59, s48
    s_nop 0
    ds_read_u16 v24, v8 offset:40994
    ds_read_u16 v28, v8 offset:51746
    ds_read_u16 v25, v8 offset:43682
    ds_read_u16 v29, v8 offset:54434
    ds_read_u16 v26, v8 offset:46370
    ds_read_u16 v30, v8 offset:57122
    s_waitcnt lgkmcnt(12)
    v_lshl_or_b32 v40, v20, 16, v16
    s_waitcnt lgkmcnt(10)
    v_lshl_or_b32 v41, v21, 16, v17
    s_waitcnt lgkmcnt(8)
    v_lshl_or_b32 v42, v22, 16, v18
    s_waitcnt lgkmcnt(6)
    v_lshl_or_b32 v43, v23, 16, v19
    ds_read_u16 v27, v8 offset:49058
    ds_read_u16 v31, v8 offset:59810
    buffer_store_dwordx4 v[40:43], v60, s[8:11], s59 offen sc1
    s_add_u32 s59, s59, 131072
    ds_read_u16 v32, v8 offset:41026
    ds_read_u16 v36, v8 offset:51778
    ds_read_u16 v33, v8 offset:43714
    ds_read_u16 v37, v8 offset:54466
    ds_read_u16 v34, v8 offset:46402
    ds_read_u16 v38, v8 offset:57154
    s_waitcnt lgkmcnt(12)
    v_lshl_or_b32 v44, v28, 16, v24
    s_waitcnt lgkmcnt(10)
    v_lshl_or_b32 v45, v29, 16, v25
    s_waitcnt lgkmcnt(8)
    v_lshl_or_b32 v46, v30, 16, v26
    s_waitcnt lgkmcnt(6)
    v_lshl_or_b32 v47, v31, 16, v27
    ds_read_u16 v35, v8 offset:49090
    ds_read_u16 v39, v8 offset:59842
    buffer_store_dwordx4 v[44:47], v60, s[8:11], s59 offen sc1
    s_add_u32 s59, s59, 131072
    ds_read_u16 v16, v8 offset:41058
    ds_read_u16 v20, v8 offset:51810
    ds_read_u16 v17, v8 offset:43746
    ds_read_u16 v21, v8 offset:54498
    ds_read_u16 v18, v8 offset:46434
    ds_read_u16 v22, v8 offset:57186
    s_waitcnt lgkmcnt(12)
    v_lshl_or_b32 v48, v36, 16, v32
    s_waitcnt lgkmcnt(10)
    v_lshl_or_b32 v49, v37, 16, v33
    s_waitcnt lgkmcnt(8)
    v_lshl_or_b32 v50, v38, 16, v34
    s_waitcnt lgkmcnt(6)
    v_lshl_or_b32 v51, v39, 16, v35
    ds_read_u16 v19, v8 offset:49122
    ds_read_u16 v23, v8 offset:59874
    buffer_store_dwordx4 v[48:51], v60, s[8:11], s59 offen sc1
    s_add_u32 s59, s59, 131072
    ds_read_u16 v24, v8 offset:41090
    ds_read_u16 v28, v8 offset:51842
    ds_read_u16 v25, v8 offset:43778
    ds_read_u16 v29, v8 offset:54530
    ds_read_u16 v26, v8 offset:46466
    ds_read_u16 v30, v8 offset:57218
    s_waitcnt lgkmcnt(12)
    v_lshl_or_b32 v52, v20, 16, v16
    s_waitcnt lgkmcnt(10)
    v_lshl_or_b32 v53, v21, 16, v17
    s_waitcnt lgkmcnt(8)
    v_lshl_or_b32 v54, v22, 16, v18
    s_waitcnt lgkmcnt(6)
    v_lshl_or_b32 v55, v23, 16, v19
    ds_read_u16 v27, v8 offset:49154
    ds_read_u16 v31, v8 offset:59906
    buffer_store_dwordx4 v[52:55], v60, s[8:11], s59 offen sc1
    s_add_u32 s59, s59, 131072
    s_waitcnt lgkmcnt(6)
    v_lshl_or_b32 v56, v28, 16, v24
    s_waitcnt lgkmcnt(4)
    v_lshl_or_b32 v57, v29, 16, v25
    s_waitcnt lgkmcnt(2)
    v_lshl_or_b32 v58, v30, 16, v26
    s_waitcnt lgkmcnt(0)
    v_lshl_or_b32 v59, v31, 16, v27
    buffer_store_dwordx4 v[56:59], v60, s[8:11], s59 offen sc1
    s_mov_b32 s91, 0x80008000
    s_lshl_b32 s90, s3, 4
    v_cvt_f32_u32 v3, v2
    v_cvt_f32_u32_e64 v11, v1
    v_mul_f32 v5, 0x3d000000, v11
    v_mul_f32 v4, 4.0, v3
    v_mul_f32 v4, v4, v5
    v_cos_f32 v6, v4
    v_sin_f32 v8, v4
    v_add_f32 v4, v4, v5
    v_cos_f32 v7, v4
    v_sin_f32 v9, v4
    v_add_f32 v4, v4, v5
    v_cvt_pk_bf16_f32 v152, v6, v7
    v_cvt_pk_bf16_f32 v156, v8, v9
    v_xor_b32 v160, s91, v156
    v_cos_f32 v6, v4
    v_sin_f32 v8, v4
    v_add_f32 v4, v4, v5
    v_cos_f32 v7, v4
    v_sin_f32 v9, v4
    v_add_f32_e64 v4, v4, v5
    v_cvt_pk_bf16_f32 v153, v6, v7
    v_cvt_pk_bf16_f32 v157, v8, v9
    v_xor_b32_e64 v161, s91, v157
    v_bfe_i32 v11, v1, 0, 1
    v_and_b32 v11, s91, v11
    v_xor_b32 v154, v11, v152
    v_xor_b32 v155, v11, v153
    v_xor_b32 v158, v11, v156
    v_xor_b32 v159, v11, v157
    v_xor_b32 v162, v11, v160
    v_xor_b32_e64 v163, v11, v161
    v_mov_b32 v11, 0x80000000
    v_xor_b32 v164, v11, v152
    v_xor_b32 v165, v11, v153
    v_xor_b32 v166, v11, v154
    v_xor_b32 v167, v11, v155
    v_xor_b32 v168, v11, v156
    v_xor_b32 v169, v11, v157
    v_xor_b32 v170, v11, v158
    v_xor_b32 v171, v11, v159
    v_xor_b32 v172, v11, v160
    v_xor_b32 v173, v11, v161
    v_xor_b32 v174, v11, v162
    v_xor_b32 v175, v11, v163
    s_add_u32 s48, s92, 0
    v_mov_b32 v10, 1
    v_mul_u32_u24 v11, 4096, v0
    v_lshl_add_u32 v11, s3, 28, v11
    s_waitcnt vmcnt(5) lgkmcnt(0)
    v_cmp_gt_u32 vcc, s4, v76
    s_nop 0
    s_cbranch_vccnz L_slow3
L_back3:
    s_mov_b64 exec, 0xff
    s_barrier
    buffer_atomic_add v10, v11, s[8:11], s48 offen sc1
    s_mov_b64 exec, -1
    s_mov_b32 s91, 0x80008000
    s_lshl_b32 s90, s3, 4
    v_cvt_f32_u32 v3, v2
    v_lshl_add_u32 v10, v2, 2, s90
    v_cvt_f32_u32 v10, v10
    v_add_u32 v11, 0, v1
    v_cvt_f32_u32_e64 v11, v11
    v_mul_f32 v5, 0x3a000000, v11
    v_mul_f32 v4, v10, v5
    v_cos_f32 v240, v4
    v_sin_f32 v248, v4
    v_add_f32 v4, v4, v5
    v_cos_f32 v241, v4
    v_sin_f32 v249, v4
    v_add_f32 v4, v4, v5
    v_cos_f32 v242, v4
    v_sin_f32 v250, v4
    v_add_f32 v4, v4, v5
    v_cos_f32 v243, v4
    v_sin_f32 v251, v4
    v_add_u32 v11, 16, v1
    v_cvt_f32_u32 v11, v11
    v_mul_f32 v5, 0x3a000000, v11
    v_mul_f32 v4, v10, v5
    v_cos_f32 v244, v4
    v_sin_f32 v252, v4
    v_add_f32 v4, v4, v5
    v_cos_f32 v245, v4
    v_sin_f32 v253, v4
    v_add_f32 v4, v4, v5
    v_cos_f32 v246, v4
    v_sin_f32 v254, v4
    v_add_f32 v4, v4, v5
    v_cos_f32 v247, v4
    v_sin_f32 v255, v4
    s_lshl_b32 s89, s3, 5
    s_and_b32 s89, s89, 32
    s_add_u32 s89, s89, 0
    v_and_b32 v11, 12, v1
    v_add3_u32 v11, v11, v1, s89
    v_cvt_f32_u32_e64 v11, v11
    v_mul_f32 v5, 0x3c800000, v11
    v_mul_f32 v10, 0x41500000, v5
    v_mul_f32 v4, 4.0, v3
    v_mul_f32 v4, v4, v5
    v_cos_f32 v6, v4
    v_sin_f32 v8, v4
    v_add_f32 v4, v4, v5
    v_cos_f32 v7, v4
    v_sin_f32 v9, v4
    v_add_f32 v4, v4, v5
    v_cvt_pk_bf16_f32 v178, v6, v7
    v_cvt_pk_bf16_f32 v176, v8, v9
    v_xor_b32 v180, s91, v176
    v_cos_f32 v6, v4
    v_sin_f32 v8, v4
    v_add_f32 v4, v4, v5
    v_cos_f32 v7, v4
    v_sin_f32 v9, v4
    v_add_f32_e64 v4, v4, v10
    v_cvt_pk_bf16_f32 v179, v6, v7
    v_cvt_pk_bf16_f32 v177, v8, v9
    v_xor_b32 v181, s91, v177
    v_cos_f32 v6, v4
    v_sin_f32 v8, v4
    v_add_f32 v4, v4, v5
    v_cos_f32 v7, v4
    v_sin_f32 v9, v4
    v_add_f32_e64 v4, v4, v5
    v_cvt_pk_bf16_f32 v184, v6, v7
    v_cvt_pk_bf16_f32 v182, v8, v9
    v_xor_b32 v186, s91, v182
    v_cos_f32 v6, v4
    v_sin_f32 v8, v4
    v_add_f32 v4, v4, v5
    v_cos_f32 v7, v4
    v_sin_f32 v9, v4
    v_add_f32_e64 v4, v4, v10
    v_cvt_pk_bf16_f32 v185, v6, v7
    v_cvt_pk_bf16_f32 v183, v8, v9
    v_xor_b32_e64 v187, s91, v183
    v_bfe_i32 v11, v1, 0, 1
    v_and_b32 v11, s91, v11
    v_xor_b32 v188, v11, v176
    v_xor_b32 v189, v11, v177
    v_xor_b32 v190, v11, v178
    v_xor_b32 v191, v11, v179
    v_xor_b32 v192, v11, v180
    v_xor_b32 v193, v11, v181
    v_xor_b32 v194, v11, v182
    v_xor_b32 v195, v11, v183
    v_xor_b32 v196, v11, v184
    v_xor_b32 v197, v11, v185
    v_xor_b32 v198, v11, v186
    v_xor_b32 v199, v11, v187
    s_add_u32 s48, s92, 16
    v_mov_b32_e64 v10, 1
    v_mul_u32_u24 v11, 4096, v0
    s_and_b32 s5, s2, 7
    s_lshl_b32 s5, s5, 5
    s_add_u32 s5, s5, s3
    s_lshl_b32 s5, s5, 7
    s_add_u32 s5, s5, 2160
    v_and_b32_e64 v79, 4, v0
    v_lshl_add_u32 v11, s3, 28, v11
    s_waitcnt vmcnt(0) lgkmcnt(0)
    s_barrier
    buffer_load_dword v76, v79, s[8:11], s5 offen sc1
    s_mov_b64 exec, 0xff
    buffer_atomic_add v10, v11, s[8:11], s48 offen sc1
    s_mov_b64 exec, -1
L_p0done:
    s_nop 1
    s_mov_b32 s91, 0x80008000
    s_lshl_b32 s90, s3, 4
    v_cvt_f32_u32 v3, v2
    s_lshl_b32 s89, s3, 5
    s_and_b32 s89, s89, 32
    s_add_u32 s89, s89, 4
    v_and_b32 v11, 12, v1
    v_add3_u32 v11, v11, v1, s89
    v_cvt_f32_u32_e64 v11, v11
    v_mul_f32 v5, 0x3c800000, v11
    v_mul_f32 v10, 0x41500000, v5
    v_mul_f32 v4, 4.0, v3
    v_mul_f32 v4, v4, v5
    v_cos_f32 v6, v4
    v_sin_f32 v8, v4
    v_add_f32 v4, v4, v5
    v_cos_f32 v7, v4
    v_sin_f32 v9, v4
    v_add_f32 v4, v4, v5
    v_cvt_pk_bf16_f32 v202, v6, v7
    v_cvt_pk_bf16_f32 v200, v8, v9
    v_xor_b32 v204, s91, v200
    v_cos_f32 v6, v4
    v_sin_f32 v8, v4
    v_add_f32 v4, v4, v5
    v_cos_f32 v7, v4
    v_sin_f32 v9, v4
    v_add_f32_e64 v4, v4, v10
    v_cvt_pk_bf16_f32 v203, v6, v7
    v_cvt_pk_bf16_f32 v201, v8, v9
    v_xor_b32 v205, s91, v201
    v_cos_f32 v6, v4
    v_sin_f32 v8, v4
    v_add_f32 v4, v4, v5
    v_cos_f32 v7, v4
    v_sin_f32 v9, v4
    v_add_f32_e64 v4, v4, v5
    v_cvt_pk_bf16_f32 v208, v6, v7
    v_cvt_pk_bf16_f32 v206, v8, v9
    v_xor_b32 v210, s91, v206
    v_cos_f32 v6, v4
    v_sin_f32 v8, v4
    v_add_f32 v4, v4, v5
    v_cos_f32 v7, v4
    v_sin_f32 v9, v4
    v_add_f32_e64 v4, v4, v10
    v_cvt_pk_bf16_f32 v209, v6, v7
    v_cvt_pk_bf16_f32 v207, v8, v9
    v_xor_b32_e64 v211, s91, v207
    v_bfe_i32 v11, v1, 0, 1
    v_and_b32 v11, s91, v11
    v_xor_b32 v212, v11, v200
    v_xor_b32 v213, v11, v201
    v_xor_b32 v214, v11, v202
    v_xor_b32 v215, v11, v203
    v_xor_b32 v216, v11, v204
    v_xor_b32 v217, v11, v205
    v_xor_b32 v218, v11, v206
    v_xor_b32 v219, v11, v207
    v_xor_b32 v220, v11, v208
    v_xor_b32 v221, v11, v209
    v_xor_b32 v222, v11, v210
    v_xor_b32 v223, v11, v211
    s_waitcnt vmcnt(1)
    v_and_b32 v78, 0x80008, v76
    v_cmp_eq_u32_e64 vcc, 0, v78
    s_nop 0
    s_cbranch_vccnz L_slow4
L_back4:
    v_readlane_b32 s48, v78, 0
    v_readlane_b32 s49, v76, 4
    s_lshr_b32 s48, s48, 1
    s_add_u32 s48, s48, s49
    s_add_u32 s48, s48, s2
    s_and_b32 s48, s48, 4
    s_andn2_b32 s6, s2, 4
    s_or_b32 s6, s6, s48
    s_lshr_b32 s49, s6, 5
    s_lshl_b32 s64, s48, 1
    s_add_u32 s64, s64, s49
    s_lshl_b32 s48, s48, 11
    s_lshl_b32 s49, s49, 15
    s_add_u32 s49, s49, s48
    s_add_u32 s97, s49, 20971520
    s_and_b32 s49, s6, 2
    s_lshl_b32 s49, s49, 13
    s_add_u32 s48, s48, s49
    s_lshl_b32 s49, s66, 12
    s_add_u32 s93, s48, s49
    s_lshr_b32 s48, s6, 3
    s_mul_i32 s49, s48, 52
    s_lshr_b32 s49, s49, 8
    s_mul_i32 s50, s49, 5
    s_sub_u32 s48, s48, s50
    s_lshl_b32 s49, s49, 3
    s_and_b32 s50, s6, 7
    s_add_u32 s49, s49, s50
    s_lshl_b32 s49, s49, 1
    s_sub_u32 s50, s48, 1
    s_cmp_lt_u32 s50, 2
    s_cselect_b32 s50, 0, 64
    s_cmp_eq_u32 s49, 0
    s_cselect_b32 s50, s50, s49
    s_mul_i32 s51, s50, 3
    s_lshl_b32 s52, s48, 1
    s_add_u32 s51, s51, s52
    s_mul_i32 s52, s51, 205
    s_lshr_b32 s52, s52, 10
    s_mul_i32 s52, s52, 5
    s_sub_u32 s51, s51, s52
    s_lshl_b32 s51, s51, 7
    s_add_u32 s50, s50, s51
    s_sub_u32 s51, 640, s50
    s_cmp_gt_u32 s50, 320
    s_cselect_b32 s50, s51, s50
    s_cselect_b32 s76, 0x80008000, 0
    s_cselect_b32 s80, 0x80000000, 0
    s_or_b32 s80, s80, 0x3a000000
    s_cmp_eq_u32 s50, 320
    s_cselect_b32 s75, 0, -1
    s_cselect_b32 s79, 0, 0x3a000000
    s_lshl_b32 s50, s50, 2
    s_add_u32 s50, s50, s3
    s_lshl_b32 s50, s50, 11
    s_add_u32 s73, s50, 26992640
    s_add_u32 s50, s49, 1
    s_mul_i32 s51, s50, 3
    s_lshl_b32 s52, s48, 1
    s_add_u32 s51, s51, s52
    s_mul_i32 s52, s51, 205
    s_lshr_b32 s52, s52, 10
    s_mul_i32 s52, s52, 5
    s_sub_u32 s51, s51, s52
    s_lshl_b32 s51, s51, 7
    s_add_u32 s50, s50, s51
    s_sub_u32 s51, 640, s50
    s_cmp_gt_u32 s50, 320
    s_cselect_b32 s50, s51, s50
    s_cselect_b32 s78, 0x80008000, 0
    s_cselect_b32 s82, 0x80000000, 0
    s_or_b32 s82, s82, 0x3a000000
    s_cmp_eq_u32 s50, 320
    s_cselect_b32 s77, 0, -1
    s_cselect_b32 s81, 0, 0x3a000000
    s_lshl_b32 s50, s50, 2
    s_add_u32 s50, s50, s3
    s_lshl_b32 s50, s50, 11
    s_add_u32 s74, s50, 26992640
    v_lshlrev_b32 v12, 4, v0
    v_lshlrev_b32 v13, 3, v0
    s_cmp_ge_u32 s6, 128
    s_cselect_b32 s52, 0xffa80000, 0
    s_cselect_b32 s53, 0xff700000, 0
    s_lshl_b32 s48, s6, 2
    s_add_u32 s48, s48, s3
    s_lshl_b32 s48, s48, 12
    s_add_u32 s53, s53, s48
    s_add_u32 s53, s53, 8388608
    s_and_b32 s48, s6, 0xf8
    s_and_b32 s49, s6, 3
    s_lshl_b32 s49, s49, 1
    s_add_u32 s48, s48, s49
    s_lshl_b32 s48, s48, 2
    s_and_b32 s49, s3, 2
    s_add_u32 s49, s49, s3
    s_add_u32 s48, s48, s49
    s_lshl_b32 s48, s48, 12
    s_and_b32 s49, s6, 4
    s_lshl_b32 s49, s49, 11
    s_add_u32 s48, s48, s49
    s_add_u32 s52, s52, s48
    s_add_u32 s52, s52, 4194304
    s_lshl_b32 s54, s3, 11
    s_add_u32 s54, s54, s49
    s_add_u32 s54, s54, 131072
    v_and_b32_e64 v15, 0x39, v0
    v_bfe_u32 v14, v0, 1, 1
    v_lshl_add_u32 v15, v14, 2, v15
    v_bfe_u32 v14, v0, 2, 1
    v_lshl_add_u32 v15, v14, 1, v15
    v_lshlrev_b32_e64 v15, 4, v15
    s_lshl_b32 s83, s65, 2
    s_add_u32 s83, s83, s3
    s_mul_i32 s83, s83, 61440
    s_add_u32 s83, s83, 23068672
    s_cmp_eq_u32 s3, 1
    s_cbranch_scc1 L_wait_7p
    s_mov_b64 exec, 0
    s_cmp_eq_u32 s3, 0
    s_cbranch_scc1 L_pg1237
    s_cmp_eq_u32 s3, 2
    s_cbranch_scc1 L_pg1835
    s_branch L_hopr0
L_wait_7p:
    s_add_u32 s48, s93, 0
    v_mul_u32_u24 v11, 128, v0
    s_mov_b32 s7, 0x20000
    s_mov_b32 exec_lo, 0xffff
    s_mov_b32 exec_hi, 0
L_poll_8:
    buffer_load_dword v10, v11, s[8:11], s48 offen sc1
    s_sub_u32 s7, s7, 1
    s_cbranch_scc1 L_polld_9
    s_waitcnt vmcnt(0)
    v_cmp_gt_u32 vcc, 8, v10
    s_nop 0
    s_cbranch_vccnz L_poll_8
L_polld_9:
L_hopr0:
    s_mov_b64 exec, -1
L_wait_7:
    s_barrier
    buffer_load_dwordx2 v[16:17], v13, s[8:11], s54 offen offset:0 sc1
    buffer_load_dwordx2 v[18:19], v13, s[8:11], s54 offen offset:512 sc1
    buffer_load_dwordx2 v[20:21], v13, s[8:11], s54 offen offset:1024 sc1
    buffer_load_dwordx2 v[22:23], v13, s[8:11], s54 offen offset:1536 sc1
    buffer_load_dwordx4 v[96:99], v12, s[8:11], s52 offen offset:0 sc1
    buffer_load_dwordx4 v[100:103], v12, s[8:11], s52 offen offset:1024 sc1
    buffer_load_dwordx4 v[104:107], v12, s[8:11], s52 offen offset:2048 sc1
    buffer_load_dwordx4 v[108:111], v12, s[8:11], s52 offen offset:3072 sc1
    s_lshl_b32 s48, s3, 11
    v_add_u32 v13, s48, v12
    s_lshl_b32 s48, s3, 10
    v_add_u32 v3, s48, v12
    s_lshr_b32 s48, s3, 1
    s_lshl_b32 s48, s48, 12
    v_add_u32 v11, s48, v12
L_pg1237:
    s_cbranch_execz L_hopr0
    s_mov_b32 s56, 0x3acccccd
    v_mov_b32 v4, 0x3727c5ac
    s_mov_b32 s57, 0xffff0000
    s_waitcnt vmcnt(7)
    v_pk_fma_f32 v[16:17], v[16:17], s[56:57], v[4:5] op_sel_hi:[1,0,0]
    s_waitcnt vmcnt(6)
    v_pk_fma_f32 v[18:19], v[18:19], s[56:57], v[4:5] op_sel_hi:[1,0,0]
    s_waitcnt vmcnt(5)
    v_pk_fma_f32 v[20:21], v[20:21], s[56:57], v[4:5] op_sel_hi:[1,0,0]
    s_waitcnt vmcnt(4)
    v_pk_fma_f32 v[22:23], v[22:23], s[56:57], v[4:5] op_sel_hi:[1,0,0]
    v_rsq_f32 v16, v16
    v_rsq_f32 v17, v17
    v_rsq_f32 v18, v18
    v_rsq_f32 v19, v19
    v_rsq_f32 v20, v20
    v_rsq_f32 v21, v21
    v_rsq_f32 v22, v22
    v_rsq_f32 v23, v23
    s_add_u32 s55, s93, 16
    v_min_u32 v10, 27, v0
    v_lshrrev_b32_e64 v14, 4, v10
    v_mul_u32_u24 v14, 528, v14
    v_mul_u32_u24 v10, 128, v10
    v_add_u32_e64 v10, v10, v14
    buffer_load_dword v14, v10, s[8:11], s55 offen sc1
    s_waitcnt vmcnt(4)
    v_lshlrev_b32 v40, 16, v96
    v_lshlrev_b32 v41, 16, v98
    s_waitcnt vmcnt(3)
    v_lshlrev_b32 v42, 16, v100
    v_lshlrev_b32 v43, 16, v102
    s_waitcnt vmcnt(2)
    v_lshlrev_b32 v44, 16, v104
    v_lshlrev_b32 v45, 16, v106
    s_waitcnt vmcnt(1)
    v_lshlrev_b32 v46, 16, v108
    v_lshlrev_b32 v47, 16, v110
    v_pk_mul_f32 v[40:41], v[40:41], v[16:17]
    v_pk_mul_f32 v[42:43], v[42:43], v[18:19]
    v_pk_mul_f32 v[44:45], v[44:45], v[20:21]
    v_pk_mul_f32 v[46:47], v[46:47], v[22:23]
    v_cvt_pk_bf16_f32 v24, v40, v41
    v_cvt_pk_bf16_f32 v25, v42, v43
    v_cvt_pk_bf16_f32 v26, v44, v45
    v_cvt_pk_bf16_f32 v27, v46, v47
    v_and_b32 v24, s75, v24
    v_and_b32 v25, s75, v25
    v_and_b32 v26, s75, v26
    v_and_b32 v27, s75, v27
    ds_write_b128 v13, v[24:27] offset:0
    v_and_b32 v48, s57, v96
    v_and_b32 v49, s57, v98
    v_and_b32 v50, s57, v100
    v_and_b32 v51, s57, v102
    v_and_b32 v52, s57, v104
    v_and_b32 v53, s57, v106
    v_and_b32 v54, s57, v108
    v_and_b32 v55, s57, v110
    v_pk_mul_f32 v[48:49], v[48:49], v[16:17]
    v_pk_mul_f32 v[50:51], v[50:51], v[18:19]
    v_pk_mul_f32 v[52:53], v[52:53], v[20:21]
    v_pk_mul_f32 v[54:55], v[54:55], v[22:23]
    v_cvt_pk_bf16_f32 v28, v48, v49
    v_cvt_pk_bf16_f32 v29, v50, v51
    v_cvt_pk_bf16_f32 v30, v52, v53
    v_cvt_pk_bf16_f32 v31, v54, v55
    v_xor_b32 v28, s76, v28
    v_xor_b32 v29, s76, v29
    v_xor_b32 v30, s76, v30
    v_xor_b32 v31, s76, v31
    ds_write_b128 v13, v[28:31] offset:1024
    v_lshlrev_b32 v76, 16, v97
    v_lshlrev_b32 v77, 16, v99
    v_lshlrev_b32 v78, 16, v101
    v_lshlrev_b32 v79, 16, v103
    v_lshlrev_b32 v80, 16, v105
    v_lshlrev_b32 v81, 16, v107
    v_lshlrev_b32 v82, 16, v109
    v_lshlrev_b32 v83, 16, v111
    v_pk_mul_f32 v[76:77], v[76:77], v[16:17]
    v_pk_mul_f32 v[78:79], v[78:79], v[18:19]
    v_pk_mul_f32 v[80:81], v[80:81], v[20:21]
    v_pk_mul_f32 v[82:83], v[82:83], v[22:23]
    v_cvt_pk_bf16_f32 v60, v76, v77
    v_cvt_pk_bf16_f32 v61, v78, v79
    v_cvt_pk_bf16_f32 v62, v80, v81
    v_cvt_pk_bf16_f32 v63, v82, v83
    ds_write_b128 v13, v[60:63] offset:8192
    s_waitcnt lgkmcnt(1)
    s_barrier
    ds_read_b128 v[24:27], v12 offset:0
    ds_read_b128 v[28:31], v12 offset:1024
    ds_read_b128 v[32:35], v12 offset:2048
    ds_read_b128 v[36:39], v12 offset:3072
    v_and_b32 v84, s57, v97
    v_and_b32 v85, s57, v99
    v_and_b32 v86, s57, v101
    v_and_b32 v87, s57, v103
    v_and_b32 v88, s57, v105
    v_and_b32 v89, s57, v107
    v_and_b32 v90, s57, v109
    v_and_b32 v91, s57, v111
    v_pk_mul_f32 v[84:85], v[84:85], v[16:17]
    v_pk_mul_f32 v[86:87], v[86:87], v[18:19]
    v_pk_mul_f32 v[88:89], v[88:89], v[20:21]
    v_pk_mul_f32 v[90:91], v[90:91], v[22:23]
    v_cvt_pk_bf16_f32 v64, v84, v85
    v_cvt_pk_bf16_f32 v65, v86, v87
    v_cvt_pk_bf16_f32 v66, v88, v89
    v_cvt_pk_bf16_f32 v67, v90, v91
    v_xor_b32 v64, s78, v64
    v_xor_b32 v65, s78, v65
    v_xor_b32 v66, s78, v66
    v_xor_b32 v67, s78, v67
    ds_write_b128 v13, v[64:67] offset:9216
    ds_read_b128 v[60:63], v12 offset:4096
    ds_read_b128 v[64:67], v12 offset:5120
    ds_read_b128 v[68:71], v12 offset:6144
    ds_read_b128 v[72:75], v12 offset:7168
    s_waitcnt vmcnt(0)
    v_cmp_gt_u32_e64 vcc, 8, v14
    s_nop 0
    s_cbranch_vccnz L_slow5
L_back5:
    s_lshr_b32 s48, s73, 6
    s_and_b32 s48, s48, 0x380
    v_xor_b32_e64 v116, s48, v12
    buffer_load_dwordx4 v[112:115], v116, s[8:11], s73 offen offset:0 sc1
    buffer_load_dwordx4 v[116:119], v116, s[8:11], s73 offen offset:1024 sc1
    s_lshr_b32 s48, s74, 6
    s_and_b32 s48, s48, 0x380
    v_xor_b32 v124, s48, v12
    buffer_load_dwordx4 v[120:123], v124, s[8:11], s74 offen offset:0 sc1
    buffer_load_dwordx4 v[124:127], v124, s[8:11], s74 offen offset:1024 sc1
    s_waitcnt lgkmcnt(8)
    v_mfma_f32_16x16x32_bf16 v[40:43], v[24:27], v[128:131], 0
    v_mfma_f32_16x16x32_bf16 v[48:51], v[24:27], v[136:139], 0
    s_waitcnt lgkmcnt(7)
    v_mfma_f32_16x16x32_bf16 v[40:43], v[28:31], v[132:135], v[40:43]
    v_mfma_f32_16x16x32_bf16 v[48:51], v[28:31], v[128:131], v[48:51]
    s_waitcnt lgkmcnt(6)
    v_mfma_f32_16x16x32_bf16 v[40:43], v[32:35], v[140:143], v[40:43]
    v_mfma_f32_16x16x32_bf16 v[48:51], v[32:35], v[148:151], v[48:51]
    s_waitcnt lgkmcnt(5)
    v_mfma_f32_16x16x32_bf16 v[40:43], v[36:39], v[144:147], v[40:43]
    v_mfma_f32_16x16x32_bf16 v[48:51], v[36:39], v[140:143], v[48:51]
    s_waitcnt lgkmcnt(3)
    v_mfma_f32_16x16x32_bf16 v[44:47], v[60:63], v[128:131], 0
    s_waitcnt lgkmcnt(3)
    s_barrier
    v_mfma_f32_16x16x32_bf16 v[52:55], v[60:63], v[136:139], 0
    ds_read_b128 v[24:27], v12 offset:8192
    s_waitcnt lgkmcnt(3)
    v_mfma_f32_16x16x32_bf16 v[44:47], v[64:67], v[132:135], v[44:47]
    ds_read_b128 v[28:31], v12 offset:9216
    v_mfma_f32_16x16x32_bf16 v[52:55], v[64:67], v[128:131], v[52:55]
    ds_read_b128 v[32:35], v12 offset:10240
    s_waitcnt lgkmcnt(4)
    v_mfma_f32_16x16x32_bf16 v[44:47], v[68:71], v[140:143], v[44:47]
    ds_read_b128 v[36:39], v12 offset:11264
    v_mfma_f32_16x16x32_bf16 v[52:55], v[68:71], v[148:151], v[52:55]
    s_waitcnt lgkmcnt(4)
    v_mfma_f32_16x16x32_bf16 v[44:47], v[72:75], v[144:147], v[44:47]
    buffer_load_dwordx4 a[0:3], v15, s[8:11], s83 offen offset:0 sc1
    v_mfma_f32_16x16x32_bf16 v[52:55], v[72:75], v[140:143], v[52:55]
    ds_read_b128 v[60:63], v12 offset:12288
    ds_read_b128 v[64:67], v12 offset:13312
    ds_read_b128 v[68:71], v12 offset:14336
    ds_read_b128 v[72:75], v12 offset:15360
    s_waitcnt lgkmcnt(7)
    v_mfma_f32_16x16x32_bf16 v[76:79], v[24:27], v[128:131], 0
    v_mfma_f32_16x16x32_bf16 v[84:87], v[24:27], v[136:139], 0
    v_mul_f32_e64 v56, v40, v224
    s_waitcnt lgkmcnt(6)
    v_mfma_f32_16x16x32_bf16 v[76:79], v[28:31], v[132:135], v[76:79]
    v_mul_f32_e64 v58, v48, v224
    buffer_load_dwordx4 a[4:7], v15, s[8:11], s83 offen offset:1024 sc1
    v_fma_f32 v56, v48, v232, v56
    v_mfma_f32_16x16x32_bf16 v[84:87], v[28:31], v[128:131], v[84:87]
    v_fma_f32 v58, -v40, v232, v58
    v_mul_f32 v57, v41, v225
    s_waitcnt lgkmcnt(5)
    v_mfma_f32_16x16x32_bf16 v[76:79], v[32:35], v[140:143], v[76:79]
    v_mul_f32_e64 v59, v49, v225
    v_fma_f32 v57, v49, v233, v57
    v_mfma_f32_16x16x32_bf16 v[84:87], v[32:35], v[148:151], v[84:87]
    v_fma_f32 v59, -v41, v233, v59
    v_cvt_pk_bf16_f32 v24, v56, v57
    buffer_load_dwordx4 a[8:11], v15, s[8:11], s83 offen offset:2048 sc1
    v_cvt_pk_bf16_f32 v28, v58, v59
    s_waitcnt lgkmcnt(4)
    v_mfma_f32_16x16x32_bf16 v[76:79], v[36:39], v[144:147], v[76:79]
    v_mul_f32 v56, v42, v226
    v_mul_f32_e64 v58, v50, v226
    v_mfma_f32_16x16x32_bf16 v[84:87], v[36:39], v[140:143], v[84:87]
    v_fma_f32 v56, v50, v234, v56
    v_fma_f32 v58, -v42, v234, v58
    s_waitcnt lgkmcnt(3)
    v_mfma_f32_16x16x32_bf16 v[80:83], v[60:63], v[128:131], 0
    v_mul_f32 v57, v43, v227
    v_mul_f32_e64 v59, v51, v227
    v_fma_f32 v57, v51, v235, v57
    buffer_load_dwordx4 a[12:15], v15, s[8:11], s83 offen offset:3072 sc1
    s_add_u32 s83, s83, 0x1000
    v_mfma_f32_16x16x32_bf16 v[88:91], v[60:63], v[136:139], 0
    v_fma_f32 v59, -v43, v235, v59
    v_cvt_pk_bf16_f32 v25, v56, v57
    s_waitcnt lgkmcnt(2)
    v_mfma_f32_16x16x32_bf16 v[80:83], v[64:67], v[132:135], v[80:83]
    v_cvt_pk_bf16_f32 v29, v58, v59
    v_mul_f32 v56, v44, v228
    v_mfma_f32_16x16x32_bf16 v[88:91], v[64:67], v[128:131], v[88:91]
    v_mul_f32_e64 v58, v52, v228
    v_fma_f32 v56, v52, v236, v56
    s_waitcnt lgkmcnt(1)
    v_mfma_f32_16x16x32_bf16 v[80:83], v[68:71], v[140:143], v[80:83]
    buffer_load_dwordx4 a[16:19], v15, s[8:11], s83 offen offset:0 sc1
    v_fma_f32 v58, -v44, v236, v58
    v_mul_f32 v57, v45, v229
    v_mul_f32_e64 v59, v53, v229
    v_mfma_f32_16x16x32_bf16 v[88:91], v[68:71], v[148:151], v[88:91]
    v_fma_f32 v57, v53, v237, v57
    v_fma_f32 v59, -v45, v237, v59
    s_waitcnt lgkmcnt(0)
    v_mfma_f32_16x16x32_bf16 v[80:83], v[72:75], v[144:147], v[80:83]
    v_cvt_pk_bf16_f32 v26, v56, v57
    v_cvt_pk_bf16_f32 v30, v58, v59
    v_mfma_f32_16x16x32_bf16 v[88:91], v[72:75], v[140:143], v[88:91]
    v_mul_f32 v56, v46, v230
    buffer_load_dwordx4 a[20:23], v15, s[8:11], s83 offen offset:1024 sc1
    v_mul_f32_e64 v58, v54, v230
    v_fma_f32 v56, v54, v238, v56
    v_fma_f32 v58, -v46, v238, v58
    v_mul_f32 v57, v47, v231
    v_mul_f32 v59, v55, v231
    v_fma_f32 v57, v55, v239, v57
    v_fma_f32 v59, -v47, v239, v59
    v_cvt_pk_bf16_f32 v27, v56, v57
    v_cvt_pk_bf16_f32 v31, v58, v59
    v_mul_f32_e64 v92, v76, v224
    buffer_load_dwordx4 a[24:27], v15, s[8:11], s83 offen offset:2048 sc1
    v_mfma_f32_16x16x32_bf16 v[40:43], v[152:155], v[24:27], 0
    v_mul_f32_e64 v94, v84, v224
    v_fma_f32 v92, v84, v232, v92
    v_fma_f32 v94, -v76, v232, v94
    v_mfma_f32_16x16x32_bf16 v[48:51], v[160:163], v[24:27], 0
    v_mul_f32 v93, v77, v225
    v_mul_f32 v95, v85, v225
    v_fma_f32 v93, v85, v233, v93
    v_mfma_f32_16x16x32_bf16 v[40:43], v[156:159], v[28:31], v[40:43]
    v_fma_f32 v95, -v77, v233, v95
    buffer_load_dwordx4 a[28:31], v15, s[8:11], s83 offen offset:3072 sc1
    s_add_u32 s83, s83, 0x1000
    v_cvt_pk_bf16_f32 v60, v92, v93
    v_cvt_pk_bf16_f32 v64, v94, v95
    v_mfma_f32_16x16x32_bf16 v[48:51], v[152:155], v[28:31], v[48:51]
    v_mul_f32 v92, v78, v226
    v_mul_f32 v94, v86, v226
    v_fma_f32 v92, v86, v234, v92
    v_mfma_f32_16x16x32_bf16 v[44:47], v[164:167], v[24:27], 0
    v_fma_f32 v94, -v78, v234, v94
    v_mul_f32 v93, v79, v227
    v_mul_f32 v95, v87, v227
    v_mfma_f32_16x16x32_bf16 v[52:55], v[172:175], v[24:27], 0
    buffer_load_dwordx4 a[32:35], v15, s[8:11], s83 offen offset:0 sc1
    v_fma_f32 v93, v87, v235, v93
    v_fma_f32 v95, -v79, v235, v95
    v_cvt_pk_bf16_f32 v61, v92, v93
    v_mfma_f32_16x16x32_bf16 v[44:47], v[168:171], v[28:31], v[44:47]
    v_cvt_pk_bf16_f32 v65, v94, v95
    v_mul_f32 v92, v80, v228
    v_mul_f32 v94, v88, v228
    v_mfma_f32_16x16x32_bf16 v[52:55], v[164:167], v[28:31], v[52:55]
    v_fma_f32 v92, v88, v236, v92
    v_fma_f32 v94, -v80, v236, v94
    buffer_load_dwordx4 a[36:39], v15, s[8:11], s83 offen offset:1024 sc1
    v_mul_f32 v93, v81, v229
    v_mul_f32 v95, v89, v229
    v_fma_f32 v93, v89, v237, v93
    v_fma_f32 v95, -v81, v237, v95
    v_cvt_pk_bf16_f32 v62, v92, v93
    v_cvt_pk_bf16_f32 v66, v94, v95
    v_pk_mul_f32 v[92:93], v[82:83], v[230:231]
    v_pk_mul_f32 v[94:95], v[90:91], v[230:231]
    v_pk_fma_f32 v[92:93], v[90:91], v[238:239], v[92:93]
    v_pk_fma_f32 v[94:95], v[82:83], v[238:239], v[94:95] neg_lo:[1,0,0] neg_hi:[1,0,0]
    v_cvt_pk_bf16_f32 v63, v92, v93
    buffer_load_dwordx4 a[40:43], v15, s[8:11], s83 offen offset:2048 sc1
    v_cvt_pk_bf16_f32 v67, v94, v95
    s_waitcnt vmcnt(14)
    v_lshlrev_b32 v32, 16, v112
    v_mfma_f32_16x16x32_bf16 v[76:79], v[152:155], v[60:63], 0
    v_and_b32 v34, s57, v112
    v_mul_f32 v56, v40, v32
    v_mul_f32_e64 v58, v48, v32
    v_mfma_f32_16x16x32_bf16 v[84:87], v[160:163], v[60:63], 0
    v_fma_f32 v56, -v48, v34, v56
    v_fma_f32 v58, v40, v34, v58
    v_lshlrev_b32_e64 v33, 16, v113
    buffer_load_dwordx4 a[44:47], v15, s[8:11], s83 offen offset:3072 sc1
    s_add_u32 s83, s83, 0x1000
    v_mfma_f32_16x16x32_bf16 v[76:79], v[156:159], v[64:67], v[76:79]
    v_and_b32 v35, s57, v113
    v_mul_f32 v57, v41, v33
    v_mul_f32_e64 v59, v49, v33
    v_mfma_f32_16x16x32_bf16 v[84:87], v[152:155], v[64:67], v[84:87]
    v_fma_f32 v57, -v49, v35, v57
    v_fma_f32 v59, v41, v35, v59
    v_cvt_pk_bf16_f32 v24, v56, v57
    v_mfma_f32_16x16x32_bf16 v[80:83], v[164:167], v[60:63], 0
    v_cvt_pk_bf16_f32 v28, v58, v59
    v_lshlrev_b32_e64 v32, 16, v114
    buffer_load_dwordx4 a[48:51], v15, s[8:11], s83 offen offset:0 sc1
    v_and_b32_e64 v34, s57, v114
    v_mfma_f32_16x16x32_bf16 v[88:91], v[172:175], v[60:63], 0
    v_mul_f32 v56, v42, v32
    v_mul_f32 v58, v50, v32
    v_fma_f32 v56, -v50, v34, v56
    v_mfma_f32_16x16x32_bf16 v[80:83], v[168:171], v[64:67], v[80:83]
    v_fma_f32 v58, v42, v34, v58
    v_lshlrev_b32 v33, 16, v115
    v_and_b32 v35, s57, v115
    v_mfma_f32_16x16x32_bf16 v[88:91], v[164:167], v[64:67], v[88:91]
    buffer_load_dwordx4 a[52:55], v15, s[8:11], s83 offen offset:1024 sc1
    v_mul_f32 v57, v43, v33
    v_mul_f32 v59, v51, v33
    v_fma_f32 v57, -v51, v35, v57
    v_fma_f32 v59, v43, v35, v59
    v_cvt_pk_bf16_f32 v25, v56, v57
    v_cvt_pk_bf16_f32 v29, v58, v59
    s_waitcnt vmcnt(16)
    v_lshlrev_b32 v32, 16, v116
    v_and_b32 v34, s57, v116
    v_lshlrev_b32 v33, 16, v117
    v_and_b32_e64 v35, s57, v117
    buffer_load_dwordx4 a[56:59], v15, s[8:11], s83 offen offset:2048 sc1
    v_pk_mul_f32 v[56:57], v[44:45], v[32:33]
    v_pk_mul_f32 v[58:59], v[52:53], v[32:33]
    v_pk_fma_f32 v[56:57], v[52:53], v[34:35], v[56:57] neg_lo:[1,0,0] neg_hi:[1,0,0]
    v_pk_fma_f32 v[58:59], v[44:45], v[34:35], v[58:59]
    v_cvt_pk_bf16_f32 v26, v56, v57
    v_cvt_pk_bf16_f32 v30, v58, v59
    v_lshlrev_b32 v32, 16, v118
    v_and_b32 v34, s57, v118
    v_lshlrev_b32 v33, 16, v119
    v_and_b32 v35, s57, v119
    v_pk_mul_f32 v[56:57], v[46:47], v[32:33]
    buffer_load_dwordx4 a[60:63], v15, s[8:11], s83 offen offset:3072 sc1
    s_add_u32 s83, s83, 0x1000
    v_pk_mul_f32 v[58:59], v[54:55], v[32:33]
    v_pk_fma_f32 v[56:57], v[54:55], v[34:35], v[56:57] neg_lo:[1,0,0] neg_hi:[1,0,0]
    v_pk_fma_f32 v[58:59], v[46:47], v[34:35], v[58:59]
    v_cvt_pk_bf16_f32 v27, v56, v57
    v_cvt_pk_bf16_f32 v31, v58, v59
    s_waitcnt vmcnt(17)
    v_lshlrev_b32 v68, 16, v120
    v_mfma_f32_16x16x32_bf16 v[40:43], v[24:27], v[152:155], 0
    v_and_b32 v70, s57, v120
    v_mul_f32 v92, v76, v68
    v_mul_f32_e64 v94, v84, v68
    buffer_load_dwordx4 a[64:67], v15, s[8:11], s83 offen offset:0 sc1
    v_mfma_f32_16x16x32_bf16 v[48:51], v[24:27], v[156:159], 0
    v_fma_f32 v92, -v84, v70, v92
    v_fma_f32 v94, v76, v70, v94
    v_lshlrev_b32_e64 v69, 16, v121
    v_mfma_f32_16x16x32_bf16 v[40:43], v[28:31], v[160:163], v[40:43]
    v_and_b32 v71, s57, v121
    v_mul_f32 v93, v77, v69
    v_mul_f32_e64 v95, v85, v69
    v_mfma_f32_16x16x32_bf16 v[48:51], v[28:31], v[152:155], v[48:51]
    v_fma_f32 v93, -v85, v71, v93
    v_fma_f32 v95, v77, v71, v95
    buffer_load_dwordx4 a[68:71], v15, s[8:11], s83 offen offset:1024 sc1
    v_cvt_pk_bf16_f32 v60, v92, v93
    v_mfma_f32_16x16x32_bf16 v[44:47], v[24:27], v[164:167], 0
    v_cvt_pk_bf16_f32 v64, v94, v95
    v_lshlrev_b32 v68, 16, v122
    v_and_b32 v70, s57, v122
    v_mfma_f32_16x16x32_bf16 v[52:55], v[24:27], v[168:171], 0
    v_mul_f32 v92, v78, v68
    v_mul_f32 v94, v86, v68
    v_fma_f32 v92, -v86, v70, v92
    v_mfma_f32_16x16x32_bf16 v[44:47], v[28:31], v[172:175], v[44:47]
    buffer_load_dwordx4 a[72:75], v15, s[8:11], s83 offen offset:2048 sc1
    v_fma_f32 v94, v78, v70, v94
    v_lshlrev_b32 v69, 16, v123
    v_and_b32 v71, s57, v123
    v_mfma_f32_16x16x32_bf16 v[52:55], v[28:31], v[164:167], v[52:55]
    v_mul_f32 v93, v79, v69
    v_mul_f32 v95, v87, v69
    v_fma_f32 v93, -v87, v71, v93
    v_fma_f32 v95, v79, v71, v95
    v_cvt_pk_bf16_f32 v61, v92, v93
    v_cvt_pk_bf16_f32 v65, v94, v95
    buffer_load_dwordx4 a[76:79], v15, s[8:11], s83 offen offset:3072 sc1
    s_add_u32 s83, s83, 0x1000
    s_waitcnt vmcnt(20)
    v_lshlrev_b32 v68, 16, v124
    v_and_b32 v70, s57, v124
    v_lshlrev_b32 v69, 16, v125
    v_and_b32_e64 v71, s57, v125
    v_pk_mul_f32 v[92:93], v[80:81], v[68:69]
    v_pk_mul_f32 v[94:95], v[88:89], v[68:69]
    v_pk_fma_f32 v[92:93], v[88:89], v[70:71], v[92:93] neg_lo:[1,0,0] neg_hi:[1,0,0]
    v_pk_fma_f32 v[94:95], v[80:81], v[70:71], v[94:95]
    v_cvt_pk_bf16_f32 v62, v92, v93
    v_cvt_pk_bf16_f32 v66, v94, v95
    v_lshlrev_b32_e64 v68, 16, v126
    buffer_load_dwordx4 a[80:83], v15, s[8:11], s83 offen offset:0 sc1
    v_and_b32 v70, s57, v126
    v_lshlrev_b32 v69, 16, v127
    v_and_b32_e64 v71, s57, v127
    v_pk_mul_f32 v[92:93], v[82:83], v[68:69]
    v_pk_mul_f32 v[94:95], v[90:91], v[68:69]
    v_pk_fma_f32 v[92:93], v[90:91], v[70:71], v[92:93] neg_lo:[1,0,0] neg_hi:[1,0,0]
    v_pk_fma_f32 v[94:95], v[82:83], v[70:71], v[94:95]
    v_cvt_pk_bf16_f32 v63, v92, v93
    v_cvt_pk_bf16_f32 v67, v94, v95
    v_mul_f32_e64 v56, v40, v240
    buffer_load_dwordx4 a[84:87], v15, s[8:11], s83 offen offset:1024 sc1
    v_mfma_f32_16x16x32_bf16 v[76:79], v[60:63], v[152:155], 0
    v_mul_f32_e64 v58, v48, v240
    v_fma_f32 v56, -v48, v248, v56
    v_fma_f32 v58, v40, v248, v58
    v_mfma_f32_16x16x32_bf16 v[84:87], v[60:63], v[156:159], 0
    v_mul_f32 v57, v41, v241
    v_mul_f32 v59, v49, v241
    v_fma_f32 v57, -v49, v249, v57
    v_mfma_f32_16x16x32_bf16 v[76:79], v[64:67], v[160:163], v[76:79]
    v_fma_f32 v59, v41, v249, v59
    v_cvt_pk_bf16_f32 v24, v56, v57
    buffer_load_dwordx4 a[88:91], v15, s[8:11], s83 offen offset:2048 sc1
    v_cvt_pk_bf16_f32 v26, v58, v59
    v_mfma_f32_16x16x32_bf16 v[84:87], v[64:67], v[152:155], v[84:87]
    v_mul_f32 v56, v42, v242
    v_mul_f32 v58, v50, v242
    v_fma_f32 v56, -v50, v250, v56
    v_mfma_f32_16x16x32_bf16 v[80:83], v[60:63], v[164:167], 0
    v_fma_f32 v58, v42, v250, v58
    v_mul_f32 v57, v43, v243
    v_mul_f32 v59, v51, v243
    v_mfma_f32_16x16x32_bf16 v[88:91], v[60:63], v[168:171], 0
    buffer_load_dwordx4 a[92:95], v15, s[8:11], s83 offen offset:3072 sc1
    s_add_u32 s83, s83, 0x1000
    v_fma_f32 v57, -v51, v251, v57
    v_fma_f32 v59, v43, v251, v59
    v_cvt_pk_bf16_f32 v25, v56, v57
    v_mfma_f32_16x16x32_bf16 v[80:83], v[64:67], v[172:175], v[80:83]
    v_cvt_pk_bf16_f32 v27, v58, v59
    v_mul_f32 v56, v44, v244
    v_mul_f32 v58, v52, v244
    v_mfma_f32_16x16x32_bf16 v[88:91], v[64:67], v[164:167], v[88:91]
    v_fma_f32 v56, -v52, v252, v56
    v_fma_f32 v58, v44, v252, v58
    v_mul_f32_e64 v57, v45, v245
    buffer_load_dwordx4 a[96:99], v15, s[8:11], s83 offen offset:0 sc1
    v_mul_f32_e64 v59, v53, v245
    v_fma_f32 v57, -v53, v253, v57
    v_fma_f32 v59, v45, v253, v59
    v_cvt_pk_bf16_f32 v28, v56, v57
    v_cvt_pk_bf16_f32 v30, v58, v59
    v_pk_mul_f32 v[56:57], v[46:47], v[246:247]
    v_pk_mul_f32 v[58:59], v[54:55], v[246:247]
    v_pk_fma_f32 v[56:57], v[54:55], v[254:255], v[56:57] neg_lo:[1,0,0] neg_hi:[1,0,0]
    v_pk_fma_f32 v[58:59], v[46:47], v[254:255], v[58:59]
    v_cvt_pk_bf16_f32 v29, v56, v57
    buffer_load_dwordx4 a[100:103], v15, s[8:11], s83 offen offset:1024 sc1
    v_cvt_pk_bf16_f32 v31, v58, v59
    ds_write_b128 v3, v[24:27] offset:16384
    ds_write_b128 v3, v[28:31] offset:20480
    v_pk_mul_f32 v[92:93], v[76:77], v[240:241]
    v_pk_mul_f32 v[94:95], v[84:85], v[240:241]
    v_pk_fma_f32 v[92:93], v[84:85], v[248:249], v[92:93] neg_lo:[1,0,0] neg_hi:[1,0,0]
    v_pk_fma_f32 v[94:95], v[76:77], v[248:249], v[94:95]
    v_cvt_pk_bf16_f32 v60, v92, v93
    v_cvt_pk_bf16_f32 v62, v94, v95
    v_pk_mul_f32 v[92:93], v[78:79], v[242:243]
    buffer_load_dwordx4 a[104:107], v15, s[8:11], s83 offen offset:2048 sc1
    v_pk_mul_f32 v[94:95], v[86:87], v[242:243]
    s_waitcnt lgkmcnt(0)
    s_barrier
    ds_read_b128 v[24:27], v11 offset:16384
    ds_read_b128 v[28:31], v11 offset:17408
    ds_read_b128 v[32:35], v11 offset:18432
    ds_read_b128 v[36:39], v11 offset:19456
    v_pk_fma_f32 v[92:93], v[86:87], v[250:251], v[92:93] neg_lo:[1,0,0] neg_hi:[1,0,0]
    v_pk_fma_f32 v[94:95], v[78:79], v[250:251], v[94:95]
    v_cvt_pk_bf16_f32 v61, v92, v93
    v_cvt_pk_bf16_f32 v63, v94, v95
    buffer_load_dwordx4 a[108:111], v15, s[8:11], s83 offen offset:3072 sc1
    s_add_u32 s83, s83, 0x1000
    v_pk_mul_f32 v[92:93], v[80:81], v[244:245]
    v_pk_mul_f32 v[94:95], v[88:89], v[244:245]
    v_pk_fma_f32 v[92:93], v[88:89], v[252:253], v[92:93] neg_lo:[1,0,0] neg_hi:[1,0,0]
    v_pk_fma_f32 v[94:95], v[80:81], v[252:253], v[94:95]
    v_cvt_pk_bf16_f32 v64, v92, v93
    v_cvt_pk_bf16_f32 v66, v94, v95
    v_pk_mul_f32 v[92:93], v[82:83], v[246:247]
    v_pk_mul_f32 v[94:95], v[90:91], v[246:247]
    v_pk_fma_f32 v[92:93], v[90:91], v[254:255], v[92:93] neg_lo:[1,0,0] neg_hi:[1,0,0]
    v_pk_fma_f32 v[94:95], v[82:83], v[254:255], v[94:95]
    buffer_load_dwordx4 a[112:115], v15, s[8:11], s83 offen offset:0 sc1
    v_cvt_pk_bf16_f32 v65, v92, v93
    v_cvt_pk_bf16_f32 v67, v94, v95
    ds_write_b128 v3, v[60:63] offset:24576
    ds_write_b128 v3, v[64:67] offset:28672
    s_waitcnt lgkmcnt(5)
    v_mfma_f32_16x16x32_bf16 v[40:43], v[178:181], v[24:27], 0
    v_mfma_f32_16x16x32_bf16 v[48:51], v[176:179], v[24:27], 0
    v_mfma_f32_16x16x32_bf16 v[44:47], v[202:205], v[24:27], 0
    v_mfma_f32_16x16x32_bf16 v[52:55], v[200:203], v[24:27], 0
    s_waitcnt lgkmcnt(4)
    v_mfma_f32_16x16x32_bf16 v[40:43], v[184:187], v[28:31], v[40:43]
    v_mfma_f32_16x16x32_bf16 v[48:51], v[182:185], v[28:31], v[48:51]
    buffer_load_dwordx4 a[116:119], v15, s[8:11], s83 offen offset:1024 sc1
    s_waitcnt lgkmcnt(0)
    s_barrier
    ds_read_b128 v[60:63], v11 offset:24576
    ds_read_b128 v[64:67], v11 offset:25600
    ds_read_b128 v[68:71], v11 offset:26624
    ds_read_b128 v[72:75], v11 offset:27648
    v_mfma_f32_16x16x32_bf16 v[44:47], v[208:211], v[28:31], v[44:47]
    v_mfma_f32_16x16x32_bf16 v[52:55], v[206:209], v[28:31], v[52:55]
    v_mfma_f32_16x16x32_bf16 v[40:43], v[190:193], v[32:35], v[40:43]
    v_mfma_f32_16x16x32_bf16 v[48:51], v[188:191], v[32:35], v[48:51]
    buffer_load_dwordx4 a[120:123], v15, s[8:11], s83 offen offset:2048 sc1
    v_mfma_f32_16x16x32_bf16 v[44:47], v[214:217], v[32:35], v[44:47]
    v_mfma_f32_16x16x32_bf16 v[52:55], v[212:215], v[32:35], v[52:55]
    v_mfma_f32_16x16x32_bf16 v[40:43], v[196:199], v[36:39], v[40:43]
    v_mfma_f32_16x16x32_bf16 v[48:51], v[194:197], v[36:39], v[48:51]
    v_mfma_f32_16x16x32_bf16 v[44:47], v[220:223], v[36:39], v[44:47]
    v_mfma_f32_16x16x32_bf16 v[52:55], v[218:221], v[36:39], v[52:55]
    v_lshlrev_b32 v56, 16, v96
    s_waitcnt lgkmcnt(3)
    v_mfma_f32_16x16x32_bf16 v[76:79], v[178:181], v[60:63], 0
    v_and_b32 v57, s57, v96
    v_fmac_f32 v56, s79, v40
    buffer_load_dwordx4 a[124:127], v15, s[8:11], s83 offen offset:3072 sc1
    s_add_u32 s83, s83, 0x1000
    v_mfma_f32_16x16x32_bf16 v[84:87], v[176:179], v[60:63], 0
    v_fmac_f32_e64 v57, s80, v48
    v_cvt_pk_bf16_f32 v96, v56, v57
    v_lshlrev_b32_e64 v58, 16, v98
    v_mfma_f32_16x16x32_bf16 v[80:83], v[202:205], v[60:63], 0
    v_and_b32 v59, s57, v98
    v_fmac_f32 v58, s79, v41
    v_mfma_f32_16x16x32_bf16 v[88:91], v[200:203], v[60:63], 0
    v_fmac_f32_e64 v59, s80, v49
    v_cvt_pk_bf16_f32 v98, v58, v59
    v_lshlrev_b32_e64 v56, 16, v100
    buffer_load_dwordx4 a[128:131], v15, s[8:11], s83 offen offset:0 sc1
    s_waitcnt lgkmcnt(2)
    v_mfma_f32_16x16x32_bf16 v[76:79], v[184:187], v[64:67], v[76:79]
    v_and_b32 v57, s57, v100
    v_fmac_f32_e64 v56, s79, v42
    v_mfma_f32_16x16x32_bf16 v[84:87], v[182:185], v[64:67], v[84:87]
    v_fmac_f32_e64 v57, s80, v50
    v_cvt_pk_bf16_f32 v100, v56, v57
    v_lshlrev_b32_e64 v58, 16, v102
    v_mfma_f32_16x16x32_bf16 v[80:83], v[208:211], v[64:67], v[80:83]
    v_and_b32 v59, s57, v102
    v_fmac_f32 v58, s79, v43
    buffer_load_dwordx4 a[132:135], v15, s[8:11], s83 offen offset:1024 sc1
    v_mfma_f32_16x16x32_bf16 v[88:91], v[206:209], v[64:67], v[88:91]
    v_fmac_f32_e64 v59, s80, v51
    v_cvt_pk_bf16_f32 v102, v58, v59
    v_lshlrev_b32 v56, 16, v104
    s_waitcnt lgkmcnt(1)
    v_mfma_f32_16x16x32_bf16 v[76:79], v[190:193], v[68:71], v[76:79]
    v_and_b32 v57, s57, v104
    v_fmac_f32 v56, s79, v44
    v_mfma_f32_16x16x32_bf16 v[84:87], v[188:191], v[68:71], v[84:87]
    v_fmac_f32_e64 v57, s80, v52
    v_cvt_pk_bf16_f32 v104, v56, v57
    v_lshlrev_b32_e64 v58, 16, v106
    buffer_load_dwordx4 a[136:139], v15, s[8:11], s83 offen offset:2048 sc1
    v_mfma_f32_16x16x32_bf16 v[80:83], v[214:217], v[68:71], v[80:83]
    v_and_b32 v59, s57, v106
    v_fmac_f32 v58, s79, v45
    v_mfma_f32_16x16x32_bf16 v[88:91], v[212:215], v[68:71], v[88:91]
    v_fmac_f32_e64 v59, s80, v53
    v_cvt_pk_bf16_f32 v106, v58, v59
    v_lshlrev_b32 v56, 16, v108
    s_waitcnt lgkmcnt(0)
    v_mfma_f32_16x16x32_bf16 v[76:79], v[196:199], v[72:75], v[76:79]
    v_and_b32 v57, s57, v108
    v_fmac_f32 v56, s79, v46
    buffer_load_dwordx4 a[140:143], v15, s[8:11], s83 offen offset:3072 sc1
    s_add_u32 s83, s83, 0x1000
    v_mfma_f32_16x16x32_bf16 v[84:87], v[194:197], v[72:75], v[84:87]
    v_fmac_f32_e64 v57, s80, v54
    v_cvt_pk_bf16_f32 v108, v56, v57
    v_lshlrev_b32_e64 v58, 16, v110
    v_mfma_f32_16x16x32_bf16 v[80:83], v[220:223], v[72:75], v[80:83]
    v_and_b32 v59, s57, v110
    v_fmac_f32 v58, s79, v47
    v_mfma_f32_16x16x32_bf16 v[88:91], v[218:221], v[72:75], v[88:91]
L_pg1835:
    s_cbranch_execz L_hopr0
    v_fmac_f32 v59, s80, v55
    v_cvt_pk_bf16_f32 v110, v58, v59
    v_lshlrev_b32 v92, 16, v97
    v_and_b32 v93, s57, v97
    v_fmac_f32 v92, s81, v76
    v_fmac_f32 v93, s82, v84
    v_cvt_pk_bf16_f32 v97, v92, v93
    v_lshlrev_b32 v94, 16, v99
    v_and_b32 v95, s57, v99
    v_fmac_f32 v94, s81, v77
    v_fmac_f32 v95, s82, v85
    v_cvt_pk_bf16_f32 v99, v94, v95
    buffer_store_dwordx4 v[96:99], v12, s[8:11], s53 offen offset:0 sc1
    v_lshlrev_b32 v92, 16, v101
    v_and_b32 v93, s57, v101
    v_fmac_f32 v92, s81, v78
    v_fmac_f32 v93, s82, v86
    v_cvt_pk_bf16_f32 v101, v92, v93
    v_lshlrev_b32 v94, 16, v103
    v_and_b32 v95, s57, v103
    v_fmac_f32 v94, s81, v79
    v_fmac_f32 v95, s82, v87
    v_cvt_pk_bf16_f32 v103, v94, v95
    buffer_store_dwordx4 v[100:103], v12, s[8:11], s53 offen offset:1024 sc1
    v_lshlrev_b32 v92, 16, v105
    v_and_b32 v93, s57, v105
    v_fmac_f32 v92, s81, v80
    v_fmac_f32 v93, s82, v88
    v_cvt_pk_bf16_f32 v105, v92, v93
    v_lshlrev_b32 v94, 16, v107
    v_and_b32 v95, s57, v107
    v_fmac_f32 v94, s81, v81
    v_fmac_f32 v95, s82, v89
    v_cvt_pk_bf16_f32 v107, v94, v95
    buffer_store_dwordx4 v[104:107], v12, s[8:11], s53 offen offset:2048 sc1
    v_lshlrev_b32 v92, 16, v109
    v_and_b32 v93, s57, v109
    v_fmac_f32 v92, s81, v82
    v_fmac_f32 v93, s82, v90
    v_cvt_pk_bf16_f32 v109, v92, v93
    v_lshlrev_b32 v94, 16, v111
    v_and_b32 v95, s57, v111
    v_fmac_f32 v94, s81, v83
    v_fmac_f32 v95, s82, v91
    v_cvt_pk_bf16_f32 v111, v94, v95
    buffer_store_dwordx4 v[108:111], v12, s[8:11], s53 offen offset:3072 sc1
    s_add_u32 s48, s92, 64
    v_mov_b32 v16, 1
    v_mul_u32_u24 v17, 4096, v0
    v_lshl_add_u32 v17, s3, 28, v17
    s_mov_b64 exec, 0xff
    s_waitcnt vmcnt(0) lgkmcnt(0)
    s_barrier
    buffer_atomic_add v16, v17, s[8:11], s48 offen sc1
    s_mov_b64 exec, -1
    s_nop 0
    buffer_load_dwordx4 a[144:147], v15, s[8:11], s83 offen offset:0 sc1
    buffer_load_dwordx4 a[148:151], v15, s[8:11], s83 offen offset:1024 sc1
    buffer_load_dwordx4 a[152:155], v15, s[8:11], s83 offen offset:2048 sc1
    buffer_load_dwordx4 a[156:159], v15, s[8:11], s83 offen offset:3072 sc1
    s_add_u32 s83, s83, 0x1000
    buffer_load_dwordx4 a[160:163], v15, s[8:11], s83 offen offset:0 sc1
    buffer_load_dwordx4 a[164:167], v15, s[8:11], s83 offen offset:1024 sc1
    buffer_load_dwordx4 a[168:171], v15, s[8:11], s83 offen offset:2048 sc1
    buffer_load_dwordx4 a[172:175], v15, s[8:11], s83 offen offset:3072 sc1
    s_add_u32 s83, s83, 0x1000
    buffer_load_dwordx4 a[176:179], v15, s[8:11], s83 offen offset:0 sc1
    buffer_load_dwordx4 a[180:183], v15, s[8:11], s83 offen offset:1024 sc1
    buffer_load_dwordx4 a[184:187], v15, s[8:11], s83 offen offset:2048 sc1
    buffer_load_dwordx4 a[188:191], v15, s[8:11], s83 offen offset:3072 sc1
    s_add_u32 s83, s83, 0x1000
    buffer_load_dwordx4 a[192:195], v15, s[8:11], s83 offen offset:0 sc1
    buffer_load_dwordx4 a[196:199], v15, s[8:11], s83 offen offset:1024 sc1
    buffer_load_dwordx4 a[200:203], v15, s[8:11], s83 offen offset:2048 sc1
    buffer_load_dwordx4 a[204:207], v15, s[8:11], s83 offen offset:3072 sc1
    s_add_u32 s83, s83, 0x1000
L_g1:
    s_nop 1
L_pg1913:
    s_cbranch_execz L_pg9259
    s_and_b32 s48, s67, 3
    s_mul_i32 s48, s48, 491520
    s_add_u32 s48, s48, s71
    s_lshr_b32 s49, s67, 2
    s_lshl_b32 s50, s49, 21
    s_add_u32 s48, s48, s50
    s_lshr_b32 s50, s64, 3
    s_xor_b32 s49, s49, s50
    s_lshl_b32 s49, s49, 13
    s_add_u32 s48, s48, s49
    s_add_u32 s48, s48, 33554432
    s_add_u32 s84, s48, 393216
    s_add_u32 s49, s3, 1
    s_and_b32 s49, s49, 3
    s_mul_i32 s49, s49, 98304
    s_add_u32 s85, s48, s49
    s_add_u32 s49, s3, 2
    s_and_b32 s49, s49, 3
    s_mul_i32 s49, s49, 98304
    s_add_u32 s86, s48, s49
    s_add_u32 s49, s3, 3
    s_and_b32 s49, s49, 3
    s_mul_i32 s49, s49, 98304
    s_add_u32 s87, s48, s49
    s_add_u32 s49, s3, 4
    s_and_b32 s49, s49, 3
    s_mul_i32 s49, s49, 98304
    s_add_u32 s88, s48, s49
    v_mov_b32 v10, v15
    v_lshlrev_b32_e64 v13, 4, v0
    v_add_u32 v15, 16384, v13
    s_and_b32 s48, s3, 1
    s_lshl_b32 s48, s48, 13
    s_add_u32 s48, s48, 4096
    v_add_u32 v14, s48, v13
    v_lshrrev_b32 v9, 2, v0
    v_lshlrev_b32 v11, 7, v9
    v_and_b32 v9, 8, v9
    v_xor_b32 v9, v9, v1
    v_lshlrev_b32 v9, 4, v9
    v_lshl_add_u32 v9, v2, 14, v9
    s_lshl_b32 s48, s64, 10
    s_lshr_b32 s49, s3, 1
    s_lshl_b32 s50, s49, 8
    s_add_u32 s48, s48, s50
    s_and_b32 s50, s3, 1
    s_lshl_b32 s51, s50, 16
    s_add_u32 s48, s48, s51
    s_add_u32 s52, s48, 8388608
    s_mul_i32 s49, s49, 40960
    s_lshl_b32 s50, s50, 10
    s_add_u32 m0, s49, s50
    v_and_b32 v3, 1, v2
    v_lshl_add_u32 v3, v2, 2, v3
    v_lshlrev_b32 v3, 7, v3
    v_and_b32 v12, 7, v0
    v_lshl_add_u32 v3, v12, 4, v3
    v_and_or_b32 v4, v0, 8, v3
    v_xor_b32 v5, 128, v4
    v_add_u32 v6, 40960, v4
    v_add_u32 v7, 40960, v5
    v_bfe_u32 v3, v0, 3, 1
    v_and_or_b32 v3, v2, 2, v3
    v_mul_u32_u24 v3, 98304, v3
    v_and_b32 v12, 0xf0, v4
    v_add_u32_e64 v8, v12, v3
    s_lshl_b32 s48, s65, 2
    s_add_u32 s48, s48, s3
    s_lshl_b32 s49, s48, 7
    s_add_u32 s54, s49, s97
    s_bfe_u32 s50, s64, 0x20001
    s_lshl_b32 s49, s50, 21
    s_lshr_b32 s51, s64, 3
    s_xor_b32 s50, s50, s51
    s_and_b32 s50, s50, 1
    s_lshl_b32 s50, s50, 13
    s_add_u32 s49, s49, s50
    s_and_b32 s50, s64, 1
    s_mul_i32 s50, s50, 786432
    s_add_u32 s49, s49, s50
    s_add_u32 s49, s49, 37748736
    s_mul_i32 s48, s48, 3
    s_and_b32 s50, s48, 0xe0
    s_add_u32 s50, s50, s48
    s_lshl_b32 s50, s50, 8
    s_add_u32 s53, s50, s49
    s_add_u32 s48, s48, 1
    s_and_b32 s50, s48, 0xe0
    s_add_u32 s50, s50, s48
    s_lshl_b32 s50, s50, 8
    s_add_u32 s69, s50, s49
    s_add_u32 s48, s48, 1
    s_and_b32 s50, s48, 0xe0
    s_add_u32 s50, s50, s48
    s_lshl_b32 s50, s50, 8
    s_add_u32 s70, s50, s49
    s_mul_i32 s48, s66, 196608
    s_add_u32 s48, s48, s71
    s_add_u32 s100, s48, s49
    s_mov_b32 s56, s100
    s_add_u32 s57, s56, 98304
    s_lshl_b32 s48, s66, 3
    s_add_u32 s48, s48, s3
    s_lshl_b32 s48, s48, 11
    s_add_u32 s55, s48, s97
    s_mul_i32 s59, s66, 40960
    s_sub_u32 s58, 40960, s59
    s_mov_b32 s63, s58
    v_cmp_gt_u32 vcc, 2, v0
    v_mov_b32 v3, 1073741824
    v_lshlrev_b32 v12, 14, v0
    v_cndmask_b32_e64 v3, v3, v12, vcc
    s_cmp_eq_u32 s3, 1
    s_cbranch_scc1 L_wait_10p
    s_mov_b64 exec, 0
    s_cmp_eq_u32 s3, 0
    s_cbranch_scc1 L_pg2460
    s_cmp_eq_u32 s3, 2
    s_cbranch_scc1 L_pg3023
    s_branch L_pg3616
L_wait_10p:
    s_add_u32 s48, s93, 64
    v_mul_u32_u24 v17, 128, v0
    s_mov_b32 s7, 0x20000
    s_mov_b32 exec_lo, 0xfffff
    s_mov_b32 exec_hi, 0
L_poll_11:
    buffer_load_dword v16, v17, s[8:11], s48 offen sc1
    s_sub_u32 s7, s7, 1
    s_cbranch_scc1 L_polld_12
    s_waitcnt vmcnt(0)
    v_cmp_gt_u32_e64 vcc, 8, v16
    s_nop 0
    s_cbranch_vccnz L_poll_11
L_polld_12:
L_hopr4:
    s_mov_b64 exec, -1
L_wait_10:
    s_barrier
    buffer_load_dwordx4 v9, s[8:11], s52 offen offset:0 sc1 lds
    s_add_u32 s52, s52, 129024
    buffer_load_dwordx4 v9, s[8:11], s52 offen offset:2048 sc1 lds
    s_add_u32 s52, s52, 0x20800
    s_add_u32 m0, m0, 4096
    s_nop 0
    buffer_load_dwordx4 v9, s[8:11], s52 offen offset:0 sc1 lds
    s_add_u32 s52, s52, 129024
    buffer_load_dwordx4 v9, s[8:11], s52 offen offset:2048 sc1 lds
    s_add_u32 s52, s52, 0x20800
    s_add_u32 m0, m0, 4096
    s_nop 0
    buffer_load_dwordx4 v9, s[8:11], s52 offen offset:0 sc1 lds
    s_add_u32 s52, s52, 129024
    buffer_load_dwordx4 v9, s[8:11], s52 offen offset:2048 sc1 lds
    s_add_u32 s52, s52, 0x20800
    s_add_u32 m0, m0, 4096
    s_nop 0
    buffer_load_dwordx4 v9, s[8:11], s52 offen offset:0 sc1 lds
    s_add_u32 s52, s52, 129024
    buffer_load_dwordx4 v9, s[8:11], s52 offen offset:2048 sc1 lds
    s_add_u32 s52, s52, 0x20800
    s_add_u32 m0, m0, 4096
    s_waitcnt vmcnt(7)
    s_barrier
    s_nop 0
    ds_read_b64 v[64:65], v4 offset:0
    ds_read_b64 v[66:67], v4 offset:256
    ds_read_b64 v[68:69], v5 offset:0
    ds_read_b64 v[70:71], v5 offset:256
    ds_read_b64 v[72:73], v6 offset:0
    ds_read_b64 v[74:75], v6 offset:256
    ds_read_b64 v[76:77], v7 offset:0
    ds_read_b64 v[78:79], v7 offset:256
    s_waitcnt lgkmcnt(6)
    v_mfma_f32_16x16x32_bf16 v[16:19], a[0:3], v[64:67], 0
    buffer_load_dwordx4 v9, s[8:11], s52 offen offset:0 sc1 lds
    v_mfma_f32_16x16x32_bf16 v[20:23], a[4:7], v[64:67], 0
    s_waitcnt vmcnt(6)
    s_barrier
    ds_read_b64 v[80:81], v4 offset:2048
    v_mfma_f32_16x16x32_bf16 v[24:27], a[8:11], v[64:67], 0
    s_waitcnt lgkmcnt(5)
    s_add_u32 s52, s52, 129024
    ds_read_b64 v[82:83], v4 offset:2304
    v_mfma_f32_16x16x32_bf16 v[28:31], a[0:3], v[68:71], 0
    ds_read_b64 v[84:85], v5 offset:2048
    ds_read_b64 v[86:87], v5 offset:2304
    v_mfma_f32_16x16x32_bf16 v[32:35], a[4:7], v[68:71], 0
    buffer_load_dwordx4 v9, s[8:11], s52 offen offset:2048 sc1 lds
    v_mfma_f32_16x16x32_bf16 v[36:39], a[8:11], v[68:71], 0
    s_waitcnt lgkmcnt(6)
    s_add_u32 s52, s52, 0x20800
    ds_read_b64 v[88:89], v6 offset:2048
    v_mfma_f32_16x16x32_bf16 v[40:43], a[0:3], v[72:75], 0
    s_add_u32 m0, m0, 4096
    ds_read_b64 v[90:91], v6 offset:2304
    ds_read_b64 v[92:93], v7 offset:2048
    v_mfma_f32_16x16x32_bf16 v[44:47], a[4:7], v[72:75], 0
    ds_read_b64 v[94:95], v7 offset:2304
    v_mfma_f32_16x16x32_bf16 v[48:51], a[8:11], v[72:75], 0
    s_waitcnt lgkmcnt(8)
    buffer_load_dwordx4 v9, s[8:11], s52 offen offset:0 sc1 lds
    v_mfma_f32_16x16x32_bf16 v[52:55], a[0:3], v[76:79], 0
    s_add_u32 s52, s52, 129024
    v_mfma_f32_16x16x32_bf16 v[56:59], a[4:7], v[76:79], 0
    v_mfma_f32_16x16x32_bf16 v[60:63], a[8:11], v[76:79], 0
    s_waitcnt lgkmcnt(6)
    v_mfma_f32_16x16x32_bf16 v[16:19], a[12:15], v[80:83], v[16:19]
    buffer_load_dwordx4 v9, s[8:11], s52 offen offset:2048 sc1 lds
    v_mfma_f32_16x16x32_bf16 v[20:23], a[16:19], v[80:83], v[20:23]
    s_add_u32 s52, s52, 0x20800
    ds_read_b64 v[64:65], v4 offset:4096
    s_add_u32 m0, m0, 4096
    v_mfma_f32_16x16x32_bf16 v[24:27], a[20:23], v[80:83], v[24:27]
    s_waitcnt lgkmcnt(5)
    ds_read_b64 v[66:67], v4 offset:4352
    ds_read_b64 v[68:69], v5 offset:4096
    v_mfma_f32_16x16x32_bf16 v[28:31], a[12:15], v[84:87], v[28:31]
    ds_read_b64 v[70:71], v5 offset:4352
    ds_read_b64 v[72:73], v6 offset:4096
    v_mfma_f32_16x16x32_bf16 v[32:35], a[16:19], v[84:87], v[32:35]
    buffer_load_dwordx4 v9, s[8:11], s52 offen offset:0 sc1 lds
    v_mfma_f32_16x16x32_bf16 v[36:39], a[20:23], v[84:87], v[36:39]
    s_waitcnt lgkmcnt(7)
    s_add_u32 s52, s52, 129024
    ds_read_b64 v[74:75], v6 offset:4352
    v_mfma_f32_16x16x32_bf16 v[40:43], a[12:15], v[88:91], v[40:43]
    ds_read_b64 v[76:77], v7 offset:4096
    ds_read_b64 v[78:79], v7 offset:4352
    v_mfma_f32_16x16x32_bf16 v[44:47], a[16:19], v[88:91], v[44:47]
    v_mfma_f32_16x16x32_bf16 v[48:51], a[20:23], v[88:91], v[48:51]
    s_waitcnt lgkmcnt(8)
    buffer_load_dwordx4 v9, s[8:11], s52 offen offset:2048 sc1 lds
    v_mfma_f32_16x16x32_bf16 v[52:55], a[12:15], v[92:95], v[52:55]
    s_add_u32 s52, s52, 0x20800
    s_add_u32 m0, m0, 4096
    v_mfma_f32_16x16x32_bf16 v[56:59], a[16:19], v[92:95], v[56:59]
    v_mfma_f32_16x16x32_bf16 v[60:63], a[20:23], v[92:95], v[60:63]
    s_waitcnt lgkmcnt(6)
    v_mfma_f32_16x16x32_bf16 v[16:19], a[24:27], v[64:67], v[16:19]
    buffer_load_dwordx4 v9, s[8:11], s52 offen offset:0 sc1 lds
    v_mfma_f32_16x16x32_bf16 v[20:23], a[28:31], v[64:67], v[20:23]
    s_waitcnt vmcnt(9)
    s_barrier
    ds_read_b64 v[80:81], v4 offset:6144
    v_mfma_f32_16x16x32_bf16 v[24:27], a[32:35], v[64:67], v[24:27]
    s_waitcnt lgkmcnt(5)
    s_add_u32 s52, s52, 129024
    ds_read_b64 v[82:83], v4 offset:6400
    v_mfma_f32_16x16x32_bf16 v[28:31], a[24:27], v[68:71], v[28:31]
    ds_read_b64 v[84:85], v5 offset:6144
    ds_read_b64 v[86:87], v5 offset:6400
    v_mfma_f32_16x16x32_bf16 v[32:35], a[28:31], v[68:71], v[32:35]
    buffer_load_dwordx4 v9, s[8:11], s52 offen offset:2048 sc1 lds
    v_mfma_f32_16x16x32_bf16 v[36:39], a[32:35], v[68:71], v[36:39]
    s_waitcnt lgkmcnt(6)
    s_add_u32 s52, s52, 0xff720800
    ds_read_b64 v[88:89], v6 offset:6144
    v_mfma_f32_16x16x32_bf16 v[40:43], a[24:27], v[72:75], v[40:43]
    s_add_u32 m0, m0, 4096
    ds_read_b64 v[90:91], v6 offset:6400
    ds_read_b64 v[92:93], v7 offset:6144
    v_mfma_f32_16x16x32_bf16 v[44:47], a[28:31], v[72:75], v[44:47]
    ds_read_b64 v[94:95], v7 offset:6400
    v_mfma_f32_16x16x32_bf16 v[48:51], a[32:35], v[72:75], v[48:51]
    s_waitcnt lgkmcnt(8)
    buffer_load_dwordx4 v9, s[8:11], s52 offen offset:0 sc1 lds
    v_mfma_f32_16x16x32_bf16 v[52:55], a[24:27], v[76:79], v[52:55]
    s_add_u32 s52, s52, 129024
    v_mfma_f32_16x16x32_bf16 v[56:59], a[28:31], v[76:79], v[56:59]
    v_mfma_f32_16x16x32_bf16 v[60:63], a[32:35], v[76:79], v[60:63]
    s_waitcnt lgkmcnt(6)
    v_mfma_f32_16x16x32_bf16 v[16:19], a[36:39], v[80:83], v[16:19]
    buffer_load_dwordx4 v9, s[8:11], s52 offen offset:2048 sc1 lds
    v_mfma_f32_16x16x32_bf16 v[20:23], a[40:43], v[80:83], v[20:23]
    s_add_u32 s52, s52, 0x20800
    ds_read_b64 v[64:65], v4 offset:8192
    s_add_u32 m0, m0, 4096
    v_mfma_f32_16x16x32_bf16 v[24:27], a[44:47], v[80:83], v[24:27]
    s_waitcnt lgkmcnt(5)
    ds_read_b64 v[66:67], v4 offset:8448
    ds_read_b64 v[68:69], v5 offset:8192
    v_mfma_f32_16x16x32_bf16 v[28:31], a[36:39], v[84:87], v[28:31]
    ds_read_b64 v[70:71], v5 offset:8448
    ds_read_b64 v[72:73], v6 offset:8192
    v_mfma_f32_16x16x32_bf16 v[32:35], a[40:43], v[84:87], v[32:35]
    buffer_load_dwordx4 v9, s[8:11], s52 offen offset:0 sc1 lds
    v_mfma_f32_16x16x32_bf16 v[36:39], a[44:47], v[84:87], v[36:39]
    s_waitcnt lgkmcnt(7)
    s_add_u32 s52, s52, 129024
    ds_read_b64 v[74:75], v6 offset:8448
    v_mfma_f32_16x16x32_bf16 v[40:43], a[36:39], v[88:91], v[40:43]
    ds_read_b64 v[76:77], v7 offset:8192
    ds_read_b64 v[78:79], v7 offset:8448
    v_mfma_f32_16x16x32_bf16 v[44:47], a[40:43], v[88:91], v[44:47]
    v_mfma_f32_16x16x32_bf16 v[48:51], a[44:47], v[88:91], v[48:51]
    s_waitcnt lgkmcnt(8)
    buffer_load_dwordx4 v9, s[8:11], s52 offen offset:2048 sc1 lds
    v_mfma_f32_16x16x32_bf16 v[52:55], a[36:39], v[92:95], v[52:55]
    s_sub_u32 s52, s52, 0xff95f600
    s_add_u32 m0, m0, 45056
    v_mfma_f32_16x16x32_bf16 v[56:59], a[40:43], v[92:95], v[56:59]
    v_mfma_f32_16x16x32_bf16 v[60:63], a[44:47], v[92:95], v[60:63]
    s_waitcnt lgkmcnt(6)
    v_mfma_f32_16x16x32_bf16 v[16:19], a[48:51], v[64:67], v[16:19]
    buffer_load_dwordx4 a[208:211], v10, s[8:11], s83 offen offset:0 sc1
    v_mfma_f32_16x16x32_bf16 v[20:23], a[52:55], v[64:67], v[20:23]
    ds_read_b64 v[80:81], v4 offset:10240
    ds_read_b64 v[82:83], v4 offset:10496
    v_mfma_f32_16x16x32_bf16 v[24:27], a[56:59], v[64:67], v[24:27]
    s_waitcnt lgkmcnt(6)
    ds_read_b64 v[84:85], v5 offset:10240
    ds_read_b64 v[86:87], v5 offset:10496
    v_mfma_f32_16x16x32_bf16 v[28:31], a[48:51], v[68:71], v[28:31]
    ds_read_b64 v[88:89], v6 offset:10240
    ds_read_b64 v[90:91], v6 offset:10496
    v_mfma_f32_16x16x32_bf16 v[32:35], a[52:55], v[68:71], v[32:35]
    buffer_load_dwordx4 a[212:215], v10, s[8:11], s83 offen offset:1024 sc1
    v_mfma_f32_16x16x32_bf16 v[36:39], a[56:59], v[68:71], v[36:39]
    s_waitcnt lgkmcnt(8)
    s_add_u32 s98, s93, 2608
    v_min_u32 v240, 11, v0
    v_mfma_f32_16x16x32_bf16 v[40:43], a[48:51], v[72:75], v[40:43]
    ds_read_b64 v[92:93], v7 offset:10240
    v_mul_u32_u24 v240, 128, v240
    v_mfma_f32_16x16x32_bf16 v[44:47], a[52:55], v[72:75], v[44:47]
    ds_read_b64 v[94:95], v7 offset:10496
    v_mfma_f32_16x16x32_bf16 v[48:51], a[56:59], v[72:75], v[48:51]
    s_waitcnt lgkmcnt(8)
    buffer_load_dwordx4 a[216:219], v10, s[8:11], s83 offen offset:2048 sc1
    v_mfma_f32_16x16x32_bf16 v[52:55], a[48:51], v[76:79], v[52:55]
    v_mfma_f32_16x16x32_bf16 v[56:59], a[52:55], v[76:79], v[56:59]
    v_mfma_f32_16x16x32_bf16 v[60:63], a[56:59], v[76:79], v[60:63]
    s_waitcnt lgkmcnt(6)
    v_mfma_f32_16x16x32_bf16 v[16:19], a[60:63], v[80:83], v[16:19]
    buffer_load_dword v12, v240, s[8:11], s98 offen sc1
    v_mfma_f32_16x16x32_bf16 v[20:23], a[64:67], v[80:83], v[20:23]
    s_waitcnt vmcnt(14)
    s_barrier
    ds_read_b64 v[64:65], v4 offset:12288
    v_mfma_f32_16x16x32_bf16 v[24:27], a[68:71], v[80:83], v[24:27]
    s_waitcnt lgkmcnt(5)
    ds_read_b64 v[66:67], v4 offset:12544
    ds_read_b64 v[68:69], v5 offset:12288
    v_mfma_f32_16x16x32_bf16 v[28:31], a[60:63], v[84:87], v[28:31]
    buffer_load_dwordx4 a[220:223], v10, s[8:11], s83 offen offset:3072 sc1
    v_mfma_f32_16x16x32_bf16 v[32:35], a[64:67], v[84:87], v[32:35]
    s_add_u32 s83, s83, 0x1000
    ds_read_b64 v[70:71], v5 offset:12544
    ds_read_b64 v[72:73], v6 offset:12288
    v_mfma_f32_16x16x32_bf16 v[36:39], a[68:71], v[84:87], v[36:39]
    s_waitcnt lgkmcnt(7)
    ds_read_b64 v[74:75], v6 offset:12544
    ds_read_b64 v[76:77], v7 offset:12288
    v_mfma_f32_16x16x32_bf16 v[40:43], a[60:63], v[88:91], v[40:43]
    ds_read_b64 v[78:79], v7 offset:12544
    v_mfma_f32_16x16x32_bf16 v[44:47], a[64:67], v[88:91], v[44:47]
    buffer_load_dwordx4 a[224:227], v10, s[8:11], s83 offen offset:0 sc1
    v_mfma_f32_16x16x32_bf16 v[48:51], a[68:71], v[88:91], v[48:51]
    s_waitcnt lgkmcnt(8)
    v_mfma_f32_16x16x32_bf16 v[52:55], a[60:63], v[92:95], v[52:55]
    v_mfma_f32_16x16x32_bf16 v[56:59], a[64:67], v[92:95], v[56:59]
    v_mfma_f32_16x16x32_bf16 v[60:63], a[68:71], v[92:95], v[60:63]
    s_waitcnt lgkmcnt(6)
    buffer_load_dwordx4 v9, s[8:11], s52 offen offset:0 sc1 lds
    v_mfma_f32_16x16x32_bf16 v[16:19], a[72:75], v[64:67], v[16:19]
    s_add_u32 s52, s52, 129024
    ds_read_b64 v[80:81], v4 offset:14336
    ds_read_b64 v[82:83], v4 offset:14592
    v_mfma_f32_16x16x32_bf16 v[20:23], a[76:79], v[64:67], v[20:23]
    ds_read_b64 v[84:85], v5 offset:14336
    ds_read_b64 v[86:87], v5 offset:14592
    v_mfma_f32_16x16x32_bf16 v[24:27], a[80:83], v[64:67], v[24:27]
    s_waitcnt lgkmcnt(8)
    ds_read_b64 v[88:89], v6 offset:14336
    ds_read_b64 v[90:91], v6 offset:14592
    v_mfma_f32_16x16x32_bf16 v[28:31], a[72:75], v[68:71], v[28:31]
    buffer_load_dwordx4 v9, s[8:11], s52 offen offset:2048 sc1 lds
    s_add_u32 s52, s52, 0x20800
    v_mfma_f32_16x16x32_bf16 v[32:35], a[76:79], v[68:71], v[32:35]
    s_add_u32 m0, m0, 4096
    ds_read_b64 v[92:93], v7 offset:14336
    ds_read_b64 v[94:95], v7 offset:14592
    v_mfma_f32_16x16x32_bf16 v[36:39], a[80:83], v[68:71], v[36:39]
    s_waitcnt lgkmcnt(10)
    v_mfma_f32_16x16x32_bf16 v[40:43], a[72:75], v[72:75], v[40:43]
    v_mfma_f32_16x16x32_bf16 v[44:47], a[76:79], v[72:75], v[44:47]
    buffer_load_dwordx4 v9, s[8:11], s52 offen offset:0 sc1 lds
    v_mfma_f32_16x16x32_bf16 v[48:51], a[80:83], v[72:75], v[48:51]
    s_waitcnt lgkmcnt(8)
    s_add_u32 s52, s52, 129024
    v_mfma_f32_16x16x32_bf16 v[52:55], a[72:75], v[76:79], v[52:55]
    v_mfma_f32_16x16x32_bf16 v[56:59], a[76:79], v[76:79], v[56:59]
    v_mfma_f32_16x16x32_bf16 v[60:63], a[80:83], v[76:79], v[60:63]
    s_waitcnt lgkmcnt(6)
    buffer_load_dwordx4 v9, s[8:11], s52 offen offset:2048 sc1 lds
    s_add_u32 s52, s52, 0x20800
    v_mfma_f32_16x16x32_bf16 v[16:19], a[84:87], v[80:83], v[16:19]
    s_add_u32 m0, m0, 4096
    ds_read_b64 v[64:65], v4 offset:16384
    ds_read_b64 v[66:67], v4 offset:16640
    v_mfma_f32_16x16x32_bf16 v[20:23], a[88:91], v[80:83], v[20:23]
    ds_read_b64 v[68:69], v5 offset:16384
    ds_read_b64 v[70:71], v5 offset:16640
    v_mfma_f32_16x16x32_bf16 v[24:27], a[92:95], v[80:83], v[24:27]
    s_waitcnt lgkmcnt(8)
    ds_read_b64 v[72:73], v6 offset:16384
    ds_read_b64 v[74:75], v6 offset:16640
    v_mfma_f32_16x16x32_bf16 v[28:31], a[84:87], v[84:87], v[28:31]
    buffer_load_dwordx4 v9, s[8:11], s52 offen offset:0 sc1 lds
    v_mfma_f32_16x16x32_bf16 v[32:35], a[88:91], v[84:87], v[32:35]
    s_add_u32 s52, s52, 129024
    ds_read_b64 v[76:77], v7 offset:16384
    ds_read_b64 v[78:79], v7 offset:16640
    v_mfma_f32_16x16x32_bf16 v[36:39], a[92:95], v[84:87], v[36:39]
    s_waitcnt lgkmcnt(10)
    v_mfma_f32_16x16x32_bf16 v[40:43], a[84:87], v[88:91], v[40:43]
    v_mfma_f32_16x16x32_bf16 v[44:47], a[88:91], v[88:91], v[44:47]
    buffer_load_dwordx4 v9, s[8:11], s52 offen offset:2048 sc1 lds
    s_add_u32 s52, s52, 0x20800
    v_mfma_f32_16x16x32_bf16 v[48:51], a[92:95], v[88:91], v[48:51]
    s_waitcnt lgkmcnt(8)
    s_add_u32 m0, m0, 4096
    v_mfma_f32_16x16x32_bf16 v[52:55], a[84:87], v[92:95], v[52:55]
    v_mfma_f32_16x16x32_bf16 v[56:59], a[88:91], v[92:95], v[56:59]
    v_mfma_f32_16x16x32_bf16 v[60:63], a[92:95], v[92:95], v[60:63]
    s_waitcnt lgkmcnt(6)
    buffer_load_dwordx4 a[228:231], v10, s[8:11], s83 offen offset:1024 sc1
    v_mfma_f32_16x16x32_bf16 v[16:19], a[96:99], v[64:67], v[16:19]
    ds_read_b64 v[80:81], v4 offset:18432
    ds_read_b64 v[82:83], v4 offset:18688
    v_mfma_f32_16x16x32_bf16 v[20:23], a[100:103], v[64:67], v[20:23]
    ds_read_b64 v[84:85], v5 offset:18432
    ds_read_b64 v[86:87], v5 offset:18688
    v_mfma_f32_16x16x32_bf16 v[24:27], a[104:107], v[64:67], v[24:27]
    s_waitcnt lgkmcnt(8)
    ds_read_b64 v[88:89], v6 offset:18432
    ds_read_b64 v[90:91], v6 offset:18688
    v_mfma_f32_16x16x32_bf16 v[28:31], a[96:99], v[68:71], v[28:31]
    buffer_load_dwordx4 a[232:235], v10, s[8:11], s83 offen offset:2048 sc1
    v_mfma_f32_16x16x32_bf16 v[32:35], a[100:103], v[68:71], v[32:35]
    ds_read_b64 v[92:93], v7 offset:18432
    ds_read_b64 v[94:95], v7 offset:18688
    v_mfma_f32_16x16x32_bf16 v[36:39], a[104:107], v[68:71], v[36:39]
    s_waitcnt lgkmcnt(10)
    v_mfma_f32_16x16x32_bf16 v[40:43], a[96:99], v[72:75], v[40:43]
    v_mfma_f32_16x16x32_bf16 v[44:47], a[100:103], v[72:75], v[44:47]
    buffer_load_dwordx4 a[236:239], v10, s[8:11], s83 offen offset:3072 sc1
    v_mfma_f32_16x16x32_bf16 v[48:51], a[104:107], v[72:75], v[48:51]
    s_waitcnt lgkmcnt(8)
    s_add_u32 s83, s83, 0x1000
    v_mfma_f32_16x16x32_bf16 v[52:55], a[96:99], v[76:79], v[52:55]
    v_mfma_f32_16x16x32_bf16 v[56:59], a[100:103], v[76:79], v[56:59]
    v_mfma_f32_16x16x32_bf16 v[60:63], a[104:107], v[76:79], v[60:63]
    s_waitcnt lgkmcnt(6)
    buffer_load_dwordx4 v9, s[8:11], s52 offen offset:0 sc1 lds
    v_mfma_f32_16x16x32_bf16 v[16:19], a[108:111], v[80:83], v[16:19]
    s_add_u32 s52, s52, 129024
    s_waitcnt vmcnt(21)
    s_barrier
    v_mfma_f32_16x16x32_bf16 v[20:23], a[112:115], v[80:83], v[20:23]
    ds_read_b64 v[64:65], v4 offset:20480
    ds_read_b64 v[66:67], v4 offset:20736
    v_mfma_f32_16x16x32_bf16 v[24:27], a[116:119], v[80:83], v[24:27]
    s_waitcnt lgkmcnt(6)
    ds_read_b64 v[68:69], v5 offset:20480
    ds_read_b64 v[70:71], v5 offset:20736
    v_mfma_f32_16x16x32_bf16 v[28:31], a[108:111], v[84:87], v[28:31]
    buffer_load_dwordx4 v9, s[8:11], s52 offen offset:2048 sc1 lds
    s_add_u32 s52, s52, 0x20800
    v_mfma_f32_16x16x32_bf16 v[32:35], a[112:115], v[84:87], v[32:35]
    s_add_u32 m0, m0, 4096
    ds_read_b64 v[72:73], v6 offset:20480
    ds_read_b64 v[74:75], v6 offset:20736
    v_mfma_f32_16x16x32_bf16 v[36:39], a[116:119], v[84:87], v[36:39]
    s_waitcnt lgkmcnt(8)
    ds_read_b64 v[76:77], v7 offset:20480
    ds_read_b64 v[78:79], v7 offset:20736
    v_mfma_f32_16x16x32_bf16 v[40:43], a[108:111], v[88:91], v[40:43]
    v_mfma_f32_16x16x32_bf16 v[44:47], a[112:115], v[88:91], v[44:47]
    buffer_load_dwordx4 v9, s[8:11], s52 offen offset:0 sc1 lds
    v_mfma_f32_16x16x32_bf16 v[48:51], a[116:119], v[88:91], v[48:51]
    s_waitcnt lgkmcnt(8)
    s_add_u32 s52, s52, 129024
    v_mfma_f32_16x16x32_bf16 v[52:55], a[108:111], v[92:95], v[52:55]
    v_mfma_f32_16x16x32_bf16 v[56:59], a[112:115], v[92:95], v[56:59]
    v_mfma_f32_16x16x32_bf16 v[60:63], a[116:119], v[92:95], v[60:63]
    s_waitcnt lgkmcnt(6)
    buffer_load_dwordx4 v9, s[8:11], s52 offen offset:2048 sc1 lds
    s_add_u32 s52, s52, 0x20800
    v_mfma_f32_16x16x32_bf16 v[16:19], a[120:123], v[64:67], v[16:19]
    s_add_u32 m0, m0, 4096
    ds_read_b64 v[80:81], v4 offset:22528
    ds_read_b64 v[82:83], v4 offset:22784
    v_mfma_f32_16x16x32_bf16 v[20:23], a[124:127], v[64:67], v[20:23]
    s_waitcnt vmcnt(15)
    v_cmp_gt_u32 vcc, 8, v12
    s_nop 0
    s_cbranch_vccnz L_slow6
L_back6:
    v_mfma_f32_16x16x32_bf16 v[24:27], a[128:131], v[64:67], v[24:27]
    s_waitcnt lgkmcnt(6)
    ds_read_b64 v[84:85], v5 offset:22528
    ds_read_b64 v[86:87], v5 offset:22784
    v_mfma_f32_16x16x32_bf16 v[28:31], a[120:123], v[68:71], v[28:31]
    buffer_load_dwordx4 v9, s[8:11], s52 offen offset:0 sc1 lds
    v_mfma_f32_16x16x32_bf16 v[32:35], a[124:127], v[68:71], v[32:35]
    s_add_u32 s52, s52, 129024
    ds_read_b64 v[88:89], v6 offset:22528
    ds_read_b64 v[90:91], v6 offset:22784
    v_mfma_f32_16x16x32_bf16 v[36:39], a[128:131], v[68:71], v[36:39]
    s_waitcnt lgkmcnt(8)
    ds_read_b64 v[92:93], v7 offset:22528
    ds_read_b64 v[94:95], v7 offset:22784
    v_mfma_f32_16x16x32_bf16 v[40:43], a[120:123], v[72:75], v[40:43]
    v_mfma_f32_16x16x32_bf16 v[44:47], a[124:127], v[72:75], v[44:47]
    buffer_load_dwordx4 v9, s[8:11], s52 offen offset:2048 sc1 lds
    s_add_u32 s52, s52, 0x20800
    v_mfma_f32_16x16x32_bf16 v[48:51], a[128:131], v[72:75], v[48:51]
    s_waitcnt lgkmcnt(8)
    s_add_u32 m0, m0, 4096
    v_mfma_f32_16x16x32_bf16 v[52:55], a[120:123], v[76:79], v[52:55]
    v_mfma_f32_16x16x32_bf16 v[56:59], a[124:127], v[76:79], v[56:59]
    v_mfma_f32_16x16x32_bf16 v[60:63], a[128:131], v[76:79], v[60:63]
    s_waitcnt lgkmcnt(6)
    buffer_load_dwordx4 v9, s[8:11], s52 offen offset:0 sc1 lds
    v_mfma_f32_16x16x32_bf16 v[16:19], a[132:135], v[80:83], v[16:19]
    s_add_u32 s52, s52, 129024
    ds_read_b64 v[64:65], v4 offset:24576
    ds_read_b64 v[66:67], v4 offset:24832
    v_mfma_f32_16x16x32_bf16 v[20:23], a[136:139], v[80:83], v[20:23]
    ds_read_b64 v[68:69], v5 offset:24576
    ds_read_b64 v[70:71], v5 offset:24832
    v_mfma_f32_16x16x32_bf16 v[24:27], a[140:143], v[80:83], v[24:27]
    s_waitcnt lgkmcnt(8)
    ds_read_b64 v[72:73], v6 offset:24576
    ds_read_b64 v[74:75], v6 offset:24832
    v_mfma_f32_16x16x32_bf16 v[28:31], a[132:135], v[84:87], v[28:31]
    buffer_load_dwordx4 v9, s[8:11], s52 offen offset:2048 sc1 lds
    s_add_u32 s52, s52, 0x20800
    v_mfma_f32_16x16x32_bf16 v[32:35], a[136:139], v[84:87], v[32:35]
    s_add_u32 m0, m0, 4096
    ds_read_b64 v[76:77], v7 offset:24576
    ds_read_b64 v[78:79], v7 offset:24832
    v_mfma_f32_16x16x32_bf16 v[36:39], a[140:143], v[84:87], v[36:39]
    s_waitcnt lgkmcnt(10)
    v_mfma_f32_16x16x32_bf16 v[40:43], a[132:135], v[88:91], v[40:43]
L_pg2460:
    s_cbranch_execz L_pg4248
    v_mfma_f32_16x16x32_bf16 v[44:47], a[136:139], v[88:91], v[44:47]
    buffer_load_dwordx4 v9, s[8:11], s52 offen offset:0 sc1 lds
    v_mfma_f32_16x16x32_bf16 v[48:51], a[140:143], v[88:91], v[48:51]
    s_waitcnt lgkmcnt(8)
    s_add_u32 s52, s52, 129024
    v_mfma_f32_16x16x32_bf16 v[52:55], a[132:135], v[92:95], v[52:55]
    v_mfma_f32_16x16x32_bf16 v[56:59], a[136:139], v[92:95], v[56:59]
    v_mfma_f32_16x16x32_bf16 v[60:63], a[140:143], v[92:95], v[60:63]
    s_waitcnt lgkmcnt(6)
    buffer_load_dwordx4 v9, s[8:11], s52 offen offset:2048 sc1 lds
    s_add_u32 s52, s52, 0xff720800
    v_mfma_f32_16x16x32_bf16 v[16:19], a[144:147], v[64:67], v[16:19]
    s_add_u32 m0, m0, 4096
    ds_read_b64 v[80:81], v4 offset:26624
    ds_read_b64 v[82:83], v4 offset:26880
    v_mfma_f32_16x16x32_bf16 v[20:23], a[148:151], v[64:67], v[20:23]
    ds_read_b64 v[84:85], v5 offset:26624
    ds_read_b64 v[86:87], v5 offset:26880
    v_mfma_f32_16x16x32_bf16 v[24:27], a[152:155], v[64:67], v[24:27]
    s_waitcnt lgkmcnt(8)
    ds_read_b64 v[88:89], v6 offset:26624
    ds_read_b64 v[90:91], v6 offset:26880
    v_mfma_f32_16x16x32_bf16 v[28:31], a[144:147], v[68:71], v[28:31]
    buffer_load_dwordx4 v9, s[8:11], s52 offen offset:0 sc1 lds
    v_mfma_f32_16x16x32_bf16 v[32:35], a[148:151], v[68:71], v[32:35]
    s_add_u32 s52, s52, 129024
    ds_read_b64 v[92:93], v7 offset:26624
    ds_read_b64 v[94:95], v7 offset:26880
    v_mfma_f32_16x16x32_bf16 v[36:39], a[152:155], v[68:71], v[36:39]
    s_waitcnt lgkmcnt(10)
    v_mfma_f32_16x16x32_bf16 v[40:43], a[144:147], v[72:75], v[40:43]
    v_mfma_f32_16x16x32_bf16 v[44:47], a[148:151], v[72:75], v[44:47]
    buffer_load_dwordx4 v9, s[8:11], s52 offen offset:2048 sc1 lds
    s_add_u32 s52, s52, 0x20800
    v_mfma_f32_16x16x32_bf16 v[48:51], a[152:155], v[72:75], v[48:51]
    s_waitcnt lgkmcnt(8)
    s_add_u32 m0, m0, 4096
    v_mfma_f32_16x16x32_bf16 v[52:55], a[144:147], v[76:79], v[52:55]
    v_mfma_f32_16x16x32_bf16 v[56:59], a[148:151], v[76:79], v[56:59]
    v_mfma_f32_16x16x32_bf16 v[60:63], a[152:155], v[76:79], v[60:63]
    s_waitcnt lgkmcnt(6)
    buffer_load_dwordx4 v9, s[8:11], s52 offen offset:0 sc1 lds
    v_mfma_f32_16x16x32_bf16 v[16:19], a[156:159], v[80:83], v[16:19]
    s_add_u32 s52, s52, 129024
    ds_read_b64 v[64:65], v4 offset:28672
    ds_read_b64 v[66:67], v4 offset:28928
    v_mfma_f32_16x16x32_bf16 v[20:23], a[160:163], v[80:83], v[20:23]
    ds_read_b64 v[68:69], v5 offset:28672
    ds_read_b64 v[70:71], v5 offset:28928
    v_mfma_f32_16x16x32_bf16 v[24:27], a[164:167], v[80:83], v[24:27]
    s_waitcnt lgkmcnt(8)
    ds_read_b64 v[72:73], v6 offset:28672
    ds_read_b64 v[74:75], v6 offset:28928
    v_mfma_f32_16x16x32_bf16 v[28:31], a[156:159], v[84:87], v[28:31]
    buffer_load_dwordx4 v9, s[8:11], s52 offen offset:2048 sc1 lds
    v_mfma_f32_16x16x32_bf16 v[32:35], a[160:163], v[84:87], v[32:35]
    ds_read_b64 v[76:77], v7 offset:28672
    ds_read_b64 v[78:79], v7 offset:28928
    v_mfma_f32_16x16x32_bf16 v[36:39], a[164:167], v[84:87], v[36:39]
    s_waitcnt lgkmcnt(10)
    v_mfma_f32_16x16x32_bf16 v[40:43], a[156:159], v[88:91], v[40:43]
    v_mfma_f32_16x16x32_bf16 v[44:47], a[160:163], v[88:91], v[44:47]
    buffer_load_dwordx4 v[96:99], v13, s[8:11], s84 offen offset:0 sc1
    v_mfma_f32_16x16x32_bf16 v[48:51], a[164:167], v[88:91], v[48:51]
    s_waitcnt lgkmcnt(8)
    v_mfma_f32_16x16x32_bf16 v[52:55], a[156:159], v[92:95], v[52:55]
    v_mfma_f32_16x16x32_bf16 v[56:59], a[160:163], v[92:95], v[56:59]
    v_mfma_f32_16x16x32_bf16 v[60:63], a[164:167], v[92:95], v[60:63]
    s_waitcnt lgkmcnt(6)
    buffer_load_dwordx4 v[100:103], v13, s[8:11], s85 offen offset:0 sc1
    v_mfma_f32_16x16x32_bf16 v[16:19], a[168:171], v[64:67], v[16:19]
    s_barrier
    ds_read_b64 v[80:81], v4 offset:30720
    v_mfma_f32_16x16x32_bf16 v[20:23], a[172:175], v[64:67], v[20:23]
    ds_read_b64 v[82:83], v4 offset:30976
    ds_read_b64 v[84:85], v5 offset:30720
    v_mfma_f32_16x16x32_bf16 v[24:27], a[176:179], v[64:67], v[24:27]
    s_waitcnt lgkmcnt(7)
    ds_read_b64 v[86:87], v5 offset:30976
    ds_read_b64 v[88:89], v6 offset:30720
    v_mfma_f32_16x16x32_bf16 v[28:31], a[168:171], v[68:71], v[28:31]
    buffer_load_dwordx4 v[104:107], v13, s[8:11], s86 offen offset:0 sc1
    v_mfma_f32_16x16x32_bf16 v[32:35], a[172:175], v[68:71], v[32:35]
    ds_read_b64 v[90:91], v6 offset:30976
    ds_read_b64 v[92:93], v7 offset:30720
    v_mfma_f32_16x16x32_bf16 v[36:39], a[176:179], v[68:71], v[36:39]
    s_waitcnt lgkmcnt(9)
    ds_read_b64 v[94:95], v7 offset:30976
    v_mfma_f32_16x16x32_bf16 v[40:43], a[168:171], v[72:75], v[40:43]
    v_mfma_f32_16x16x32_bf16 v[44:47], a[172:175], v[72:75], v[44:47]
    buffer_load_dwordx4 v[108:111], v13, s[8:11], s87 offen offset:0 sc1
    v_mfma_f32_16x16x32_bf16 v[48:51], a[176:179], v[72:75], v[48:51]
    s_waitcnt lgkmcnt(8)
    v_mfma_f32_16x16x32_bf16 v[52:55], a[168:171], v[76:79], v[52:55]
    v_mfma_f32_16x16x32_bf16 v[56:59], a[172:175], v[76:79], v[56:59]
    v_mfma_f32_16x16x32_bf16 v[60:63], a[176:179], v[76:79], v[60:63]
    s_waitcnt lgkmcnt(6)
    buffer_load_dwordx4 v[112:115], v13, s[8:11], s88 offen offset:0 sc1
    v_mfma_f32_16x16x32_bf16 v[16:19], a[180:183], v[80:83], v[16:19]
    ds_read_b64 v[64:65], v4 offset:32768
    ds_read_b64 v[66:67], v4 offset:33024
    v_mfma_f32_16x16x32_bf16 v[20:23], a[184:187], v[80:83], v[20:23]
    ds_read_b64 v[68:69], v5 offset:32768
    ds_read_b64 v[70:71], v5 offset:33024
    v_mfma_f32_16x16x32_bf16 v[24:27], a[188:191], v[80:83], v[24:27]
    s_waitcnt lgkmcnt(8)
    ds_read_b64 v[72:73], v6 offset:32768
    ds_read_b64 v[74:75], v6 offset:33024
    v_mfma_f32_16x16x32_bf16 v[28:31], a[180:183], v[84:87], v[28:31]
    buffer_load_dwordx4 v[116:119], v13, s[8:11], s84 offen offset:1024 sc1
    v_mfma_f32_16x16x32_bf16 v[32:35], a[184:187], v[84:87], v[32:35]
    ds_read_b64 v[76:77], v7 offset:32768
    ds_read_b64 v[78:79], v7 offset:33024
    v_mfma_f32_16x16x32_bf16 v[36:39], a[188:191], v[84:87], v[36:39]
    s_waitcnt lgkmcnt(10)
    v_mfma_f32_16x16x32_bf16 v[40:43], a[180:183], v[88:91], v[40:43]
    v_mfma_f32_16x16x32_bf16 v[44:47], a[184:187], v[88:91], v[44:47]
    buffer_load_dwordx4 v[120:123], v13, s[8:11], s85 offen offset:1024 sc1
    v_mfma_f32_16x16x32_bf16 v[48:51], a[188:191], v[88:91], v[48:51]
    s_waitcnt lgkmcnt(8)
    v_mfma_f32_16x16x32_bf16 v[52:55], a[180:183], v[92:95], v[52:55]
    v_mfma_f32_16x16x32_bf16 v[56:59], a[184:187], v[92:95], v[56:59]
    v_mfma_f32_16x16x32_bf16 v[60:63], a[188:191], v[92:95], v[60:63]
    s_waitcnt lgkmcnt(6)
    buffer_load_dwordx4 v[124:127], v13, s[8:11], s86 offen offset:1024 sc1
    v_mfma_f32_16x16x32_bf16 v[16:19], a[192:195], v[64:67], v[16:19]
    ds_read_b64 v[80:81], v4 offset:34816
    ds_read_b64 v[82:83], v4 offset:35072
    v_mfma_f32_16x16x32_bf16 v[20:23], a[196:199], v[64:67], v[20:23]
    ds_read_b64 v[84:85], v5 offset:34816
    ds_read_b64 v[86:87], v5 offset:35072
    v_mfma_f32_16x16x32_bf16 v[24:27], a[200:203], v[64:67], v[24:27]
    s_waitcnt lgkmcnt(8)
    ds_read_b64 v[88:89], v6 offset:34816
    ds_read_b64 v[90:91], v6 offset:35072
    v_mfma_f32_16x16x32_bf16 v[28:31], a[192:195], v[68:71], v[28:31]
    buffer_load_dwordx4 v[128:131], v13, s[8:11], s87 offen offset:1024 sc1
    v_mfma_f32_16x16x32_bf16 v[32:35], a[196:199], v[68:71], v[32:35]
    ds_read_b64 v[92:93], v7 offset:34816
    ds_read_b64 v[94:95], v7 offset:35072
    v_mfma_f32_16x16x32_bf16 v[36:39], a[200:203], v[68:71], v[36:39]
    s_waitcnt lgkmcnt(10)
    v_mfma_f32_16x16x32_bf16 v[40:43], a[192:195], v[72:75], v[40:43]
    v_mfma_f32_16x16x32_bf16 v[44:47], a[196:199], v[72:75], v[44:47]
    buffer_load_dwordx4 v[132:135], v13, s[8:11], s88 offen offset:1024 sc1
    v_mfma_f32_16x16x32_bf16 v[48:51], a[200:203], v[72:75], v[48:51]
    s_waitcnt lgkmcnt(8)
    v_mfma_f32_16x16x32_bf16 v[52:55], a[192:195], v[76:79], v[52:55]
    v_mfma_f32_16x16x32_bf16 v[56:59], a[196:199], v[76:79], v[56:59]
    v_mfma_f32_16x16x32_bf16 v[60:63], a[200:203], v[76:79], v[60:63]
    s_waitcnt lgkmcnt(6)
    buffer_load_dwordx4 v[136:139], v13, s[8:11], s84 offen offset:2048 sc1
    v_mfma_f32_16x16x32_bf16 v[16:19], a[204:207], v[80:83], v[16:19]
    ds_read_b64 v[64:65], v4 offset:36864
    ds_read_b64 v[66:67], v4 offset:37120
    v_mfma_f32_16x16x32_bf16 v[20:23], a[208:211], v[80:83], v[20:23]
    ds_read_b64 v[68:69], v5 offset:36864
    ds_read_b64 v[70:71], v5 offset:37120
    v_mfma_f32_16x16x32_bf16 v[24:27], a[212:215], v[80:83], v[24:27]
    s_waitcnt lgkmcnt(8)
    ds_read_b64 v[72:73], v6 offset:36864
    ds_read_b64 v[74:75], v6 offset:37120
    v_mfma_f32_16x16x32_bf16 v[28:31], a[204:207], v[84:87], v[28:31]
    buffer_load_dwordx4 v[140:143], v13, s[8:11], s85 offen offset:2048 sc1
    v_mfma_f32_16x16x32_bf16 v[32:35], a[208:211], v[84:87], v[32:35]
    ds_read_b64 v[76:77], v7 offset:36864
    ds_read_b64 v[78:79], v7 offset:37120
    v_mfma_f32_16x16x32_bf16 v[36:39], a[212:215], v[84:87], v[36:39]
    s_waitcnt lgkmcnt(10)
    v_mfma_f32_16x16x32_bf16 v[40:43], a[204:207], v[88:91], v[40:43]
    v_mfma_f32_16x16x32_bf16 v[44:47], a[208:211], v[88:91], v[44:47]
    buffer_load_dwordx4 v[144:147], v13, s[8:11], s86 offen offset:2048 sc1
    v_mfma_f32_16x16x32_bf16 v[48:51], a[212:215], v[88:91], v[48:51]
    s_waitcnt lgkmcnt(8)
    v_mfma_f32_16x16x32_bf16 v[52:55], a[204:207], v[92:95], v[52:55]
    v_mfma_f32_16x16x32_bf16 v[56:59], a[208:211], v[92:95], v[56:59]
    v_mfma_f32_16x16x32_bf16 v[60:63], a[212:215], v[92:95], v[60:63]
    s_waitcnt lgkmcnt(6)
    buffer_load_dwordx4 v[148:151], v13, s[8:11], s87 offen offset:2048 sc1
    v_mfma_f32_16x16x32_bf16 v[16:19], a[216:219], v[64:67], v[16:19]
    s_waitcnt vmcnt(38)
    ds_read_b64 v[80:81], v4 offset:38912
    ds_read_b64 v[82:83], v4 offset:39168
    v_mfma_f32_16x16x32_bf16 v[20:23], a[220:223], v[64:67], v[20:23]
    s_waitcnt vmcnt(37)
    ds_read_b64 v[84:85], v5 offset:38912
    ds_read_b64 v[86:87], v5 offset:39168
    v_mfma_f32_16x16x32_bf16 v[24:27], a[224:227], v[64:67], v[24:27]
    s_waitcnt lgkmcnt(8)
    ds_read_b64 v[88:89], v6 offset:38912
    ds_read_b64 v[90:91], v6 offset:39168
    v_mfma_f32_16x16x32_bf16 v[28:31], a[216:219], v[68:71], v[28:31]
    buffer_load_dwordx4 v[152:155], v13, s[8:11], s88 offen offset:2048 sc1
    v_mfma_f32_16x16x32_bf16 v[32:35], a[220:223], v[68:71], v[32:35]
    ds_read_b64 v[92:93], v7 offset:38912
    ds_read_b64 v[94:95], v7 offset:39168
    v_mfma_f32_16x16x32_bf16 v[36:39], a[224:227], v[68:71], v[36:39]
    s_waitcnt lgkmcnt(10)
    v_add_u32 v4, 81920, v4
    v_add_u32 v5, 81920, v5
    v_mfma_f32_16x16x32_bf16 v[40:43], a[216:219], v[72:75], v[40:43]
    v_add_u32 v6, 81920, v6
    v_add_u32 v7, 81920, v7
    v_mfma_f32_16x16x32_bf16 v[44:47], a[220:223], v[72:75], v[44:47]
    buffer_load_dwordx4 v[156:159], v13, s[8:11], s84 offen offset:3072 sc1
    v_mfma_f32_16x16x32_bf16 v[48:51], a[224:227], v[72:75], v[48:51]
    s_waitcnt lgkmcnt(8)
    v_mfma_f32_16x16x32_bf16 v[52:55], a[216:219], v[76:79], v[52:55]
    v_mfma_f32_16x16x32_bf16 v[56:59], a[220:223], v[76:79], v[56:59]
    v_mfma_f32_16x16x32_bf16 v[60:63], a[224:227], v[76:79], v[60:63]
    s_waitcnt vmcnt(32) lgkmcnt(6)
    buffer_load_dwordx4 v[160:163], v13, s[8:11], s85 offen offset:3072 sc1
    v_mfma_f32_16x16x32_bf16 v[16:19], a[228:231], v[80:83], v[16:19]
    s_waitcnt vmcnt(32)
    s_barrier
    v_mfma_f32_16x16x32_bf16 v[20:23], a[232:235], v[80:83], v[20:23]
    s_waitcnt vmcnt(31)
    ds_read_b64 v[64:65], v4 offset:0
    ds_read_b64 v[66:67], v4 offset:256
    v_mfma_f32_16x16x32_bf16 v[24:27], a[236:239], v[80:83], v[24:27]
    s_waitcnt lgkmcnt(6)
    ds_read_b64 v[68:69], v5 offset:0
    ds_read_b64 v[70:71], v5 offset:256
    v_mfma_f32_16x16x32_bf16 v[28:31], a[228:231], v[84:87], v[28:31]
    buffer_load_dwordx4 v[164:167], v13, s[8:11], s86 offen offset:3072 sc1
    v_mfma_f32_16x16x32_bf16 v[32:35], a[232:235], v[84:87], v[32:35]
    ds_read_b64 v[72:73], v6 offset:0
    ds_read_b64 v[74:75], v6 offset:256
    v_mfma_f32_16x16x32_bf16 v[36:39], a[236:239], v[84:87], v[36:39]
    s_waitcnt lgkmcnt(8)
    ds_read_b64 v[76:77], v7 offset:0
    ds_read_b64 v[78:79], v7 offset:256
    v_mfma_f32_16x16x32_bf16 v[40:43], a[228:231], v[88:91], v[40:43]
    v_mfma_f32_16x16x32_bf16 v[44:47], a[232:235], v[88:91], v[44:47]
    buffer_load_dwordx4 v[168:171], v13, s[8:11], s87 offen offset:3072 sc1
    v_mfma_f32_16x16x32_bf16 v[48:51], a[236:239], v[88:91], v[48:51]
    s_waitcnt lgkmcnt(8)
    v_mfma_f32_16x16x32_bf16 v[52:55], a[228:231], v[92:95], v[52:55]
    v_mfma_f32_16x16x32_bf16 v[56:59], a[232:235], v[92:95], v[56:59]
    v_mfma_f32_16x16x32_bf16 v[60:63], a[236:239], v[92:95], v[60:63]
    s_waitcnt lgkmcnt(6)
    buffer_load_dwordx4 v[172:175], v13, s[8:11], s88 offen offset:3072 sc1
    v_mfma_f32_16x16x32_bf16 v[208:211], a[0:3], v[64:67], 0
    ds_read_b64 v[80:81], v4 offset:2048
    ds_read_b64 v[82:83], v4 offset:2304
    v_mfma_f32_16x16x32_bf16 v[212:215], a[4:7], v[64:67], 0
    ds_read_b64 v[84:85], v5 offset:2048
    ds_read_b64 v[86:87], v5 offset:2304
    v_mfma_f32_16x16x32_bf16 v[216:219], a[8:11], v[64:67], 0
    s_waitcnt lgkmcnt(8)
    ds_read_b64 v[88:89], v6 offset:2048
    ds_read_b64 v[90:91], v6 offset:2304
    v_mfma_f32_16x16x32_bf16 v[220:223], a[0:3], v[68:71], 0
    buffer_load_dwordx4 v[176:179], v14, s[8:11], s84 offen offset:0 sc1
    v_max_f32_e64 v16, 0, v16
    v_mfma_f32_16x16x32_bf16 v[224:227], a[4:7], v[68:71], 0
    v_max_f32 v17, 0, v17
    v_mul_f32 v16, v16, v18
    v_mfma_f32_16x16x32_bf16 v[228:231], a[8:11], v[68:71], 0
    s_waitcnt lgkmcnt(8)
    ds_read_b64 v[92:93], v7 offset:2048
    v_mul_f32 v17, v17, v19
    v_mfma_f32_16x16x32_bf16 v[232:235], a[0:3], v[72:75], 0
    ds_read_b64 v[94:95], v7 offset:2304
    v_cvt_pk_bf16_f32 v16, v16, v17
    v_mfma_f32_16x16x32_bf16 v[236:239], a[4:7], v[72:75], 0
    v_max_f32 v28, 0, v28
    v_max_f32 v29, 0, v29
    v_mfma_f32_16x16x32_bf16 v[240:243], a[8:11], v[72:75], 0
    s_waitcnt lgkmcnt(8)
    v_mul_f32 v28, v28, v30
    v_mul_f32_e64 v29, v29, v31
    v_mfma_f32_16x16x32_bf16 v[244:247], a[0:3], v[76:79], 0
    buffer_load_dwordx4 v[180:183], v14, s[8:11], s85 offen offset:0 sc1
    v_mfma_f32_16x16x32_bf16 v[248:251], a[4:7], v[76:79], 0
    v_cvt_pk_bf16_f32 v17, v28, v29
    v_max_f32_e64 v40, 0, v40
    v_mfma_f32_16x16x32_bf16 v[252:255], a[8:11], v[76:79], 0
    s_waitcnt lgkmcnt(6)
    v_max_f32 v41, 0, v41
    v_mul_f32_e64 v40, v40, v42
    v_mfma_f32_16x16x32_bf16 v[208:211], a[12:15], v[80:83], v[208:211]
    ds_read_b64 v[64:65], v4 offset:4096
    v_mul_f32_e64 v41, v41, v43
    v_mfma_f32_16x16x32_bf16 v[212:215], a[16:19], v[80:83], v[212:215]
    ds_read_b64 v[66:67], v4 offset:4352
    v_cvt_pk_bf16_f32 v18, v40, v41
    v_mfma_f32_16x16x32_bf16 v[216:219], a[20:23], v[80:83], v[216:219]
    s_waitcnt lgkmcnt(6)
    ds_read_b64 v[68:69], v5 offset:4096
    v_max_f32 v52, 0, v52
    v_mfma_f32_16x16x32_bf16 v[220:223], a[12:15], v[84:87], v[220:223]
    ds_read_b64 v[70:71], v5 offset:4352
    v_max_f32_e64 v53, 0, v53
    v_mfma_f32_16x16x32_bf16 v[224:227], a[16:19], v[84:87], v[224:227]
    buffer_load_dwordx4 v[184:187], v14, s[8:11], s86 offen offset:0 sc1
    v_mfma_f32_16x16x32_bf16 v[228:231], a[20:23], v[84:87], v[228:231]
    s_waitcnt lgkmcnt(6)
    ds_read_b64 v[72:73], v6 offset:4096
    v_mul_f32 v52, v52, v54
    v_mfma_f32_16x16x32_bf16 v[232:235], a[12:15], v[88:91], v[232:235]
    ds_read_b64 v[74:75], v6 offset:4352
    v_mul_f32_e64 v53, v53, v55
    v_mfma_f32_16x16x32_bf16 v[236:239], a[16:19], v[88:91], v[236:239]
    ds_read_b64 v[76:77], v7 offset:4096
    v_cvt_pk_bf16_f32 v19, v52, v53
    v_mfma_f32_16x16x32_bf16 v[240:243], a[20:23], v[88:91], v[240:243]
    s_waitcnt lgkmcnt(7)
    ds_read_b64 v[78:79], v7 offset:4352
    v_max_f32 v20, 0, v20
    v_mfma_f32_16x16x32_bf16 v[244:247], a[12:15], v[92:95], v[244:247]
    v_max_f32_e64 v21, 0, v21
    v_mfma_f32_16x16x32_bf16 v[248:251], a[16:19], v[92:95], v[248:251]
    v_permlane32_swap_b32_e64 v16, v18
    v_mfma_f32_16x16x32_bf16 v[252:255], a[20:23], v[92:95], v[252:255]
    s_waitcnt lgkmcnt(6)
    v_mul_f32 v20, v20, v22
    v_mul_f32_e64 v21, v21, v23
    v_mfma_f32_16x16x32_bf16 v[208:211], a[24:27], v[64:67], v[208:211]
    buffer_load_dwordx4 v[188:191], v14, s[8:11], s87 offen offset:0 sc1
    v_mfma_f32_16x16x32_bf16 v[212:215], a[28:31], v[64:67], v[212:215]
    v_permlane32_swap_b32_e64 v17, v19
    v_mfma_f32_16x16x32_bf16 v[216:219], a[32:35], v[64:67], v[216:219]
    s_waitcnt lgkmcnt(4)
    ds_read_b64 v[80:81], v4 offset:6144
    v_cvt_pk_bf16_f32 v20, v20, v21
    v_mfma_f32_16x16x32_bf16 v[220:223], a[24:27], v[68:71], v[220:223]
    ds_read_b64 v[82:83], v4 offset:6400
    v_max_f32 v32, 0, v32
    v_mfma_f32_16x16x32_bf16 v[224:227], a[28:31], v[68:71], v[224:227]
    ds_read_b64 v[84:85], v5 offset:6144
    ds_read_b64 v[86:87], v5 offset:6400
    v_mfma_f32_16x16x32_bf16 v[228:231], a[32:35], v[68:71], v[228:231]
    s_waitcnt lgkmcnt(6)
    v_permlane16_swap_b32 v16, v17
    v_mfma_f32_16x16x32_bf16 v[232:235], a[24:27], v[72:75], v[232:235]
    ds_read_b64 v[88:89], v6 offset:6144
    v_max_f32_e64 v33, 0, v33
    v_mfma_f32_16x16x32_bf16 v[236:239], a[28:31], v[72:75], v[236:239]
    ds_read_b64 v[90:91], v6 offset:6400
    v_mul_f32_e64 v32, v32, v34
    v_mfma_f32_16x16x32_bf16 v[240:243], a[32:35], v[72:75], v[240:243]
    s_waitcnt lgkmcnt(6)
    v_permlane16_swap_b32 v18, v19
    v_mfma_f32_16x16x32_bf16 v[244:247], a[24:27], v[76:79], v[244:247]
    ds_read_b64 v[92:93], v7 offset:6144
    v_mul_f32_e64 v33, v33, v35
    v_mfma_f32_16x16x32_bf16 v[248:251], a[28:31], v[76:79], v[248:251]
    ds_read_b64 v[94:95], v7 offset:6400
    v_cvt_pk_bf16_f32 v21, v32, v33
    v_mfma_f32_16x16x32_bf16 v[252:255], a[32:35], v[76:79], v[252:255]
    s_waitcnt lgkmcnt(6)
    buffer_load_dwordx4 v[192:195], v14, s[8:11], s88 offen offset:0 sc1
    v_mfma_f32_16x16x32_bf16 v[208:211], a[36:39], v[80:83], v[208:211]
    buffer_store_dwordx4 v[16:19], v8, s[8:11], s53 offen sc1
    v_mfma_f32_16x16x32_bf16 v[212:215], a[40:43], v[80:83], v[212:215]
    v_max_f32 v44, 0, v44
    v_max_f32_e64 v45, 0, v45
    v_mfma_f32_16x16x32_bf16 v[216:219], a[44:47], v[80:83], v[216:219]
    s_waitcnt lgkmcnt(4)
    ds_read_b64 v[64:65], v4 offset:8192
    v_mul_f32 v44, v44, v46
    v_mfma_f32_16x16x32_bf16 v[220:223], a[36:39], v[84:87], v[220:223]
    ds_read_b64 v[66:67], v4 offset:8448
    v_mul_f32_e64 v45, v45, v47
    v_mfma_f32_16x16x32_bf16 v[224:227], a[40:43], v[84:87], v[224:227]
    ds_read_b64 v[68:69], v5 offset:8192
    v_cvt_pk_bf16_f32 v22, v44, v45
    v_mfma_f32_16x16x32_bf16 v[228:231], a[44:47], v[84:87], v[228:231]
    s_waitcnt lgkmcnt(5)
    ds_read_b64 v[70:71], v5 offset:8448
    v_max_f32 v56, 0, v56
    v_mfma_f32_16x16x32_bf16 v[232:235], a[36:39], v[88:91], v[232:235]
    buffer_load_dwordx4 v[196:199], v14, s[8:11], s84 offen offset:1024 sc1
    v_mfma_f32_16x16x32_bf16 v[236:239], a[40:43], v[88:91], v[236:239]
    v_max_f32 v57, 0, v57
    v_mul_f32 v56, v56, v58
    v_mfma_f32_16x16x32_bf16 v[240:243], a[44:47], v[88:91], v[240:243]
    s_waitcnt lgkmcnt(4)
    ds_read_b64 v[72:73], v6 offset:8192
    ds_read_b64 v[74:75], v6 offset:8448
    v_mfma_f32_16x16x32_bf16 v[244:247], a[36:39], v[92:95], v[244:247]
    v_mul_f32 v57, v57, v59
    v_cvt_pk_bf16_f32 v23, v56, v57
    v_mfma_f32_16x16x32_bf16 v[248:251], a[40:43], v[92:95], v[248:251]
    ds_read_b64 v[76:77], v7 offset:8192
    ds_read_b64 v[78:79], v7 offset:8448
    v_mfma_f32_16x16x32_bf16 v[252:255], a[44:47], v[92:95], v[252:255]
    s_waitcnt lgkmcnt(6)
    v_max_f32 v24, 0, v24
    v_max_f32_e64 v25, 0, v25
    v_mfma_f32_16x16x32_bf16 v[208:211], a[48:51], v[64:67], v[208:211]
    v_permlane32_swap_b32_e64 v20, v22
    v_mfma_f32_16x16x32_bf16 v[212:215], a[52:55], v[64:67], v[212:215]
    ds_read_b64 v[80:81], v4 offset:10240
    v_mul_f32_e64 v24, v24, v26
    v_mfma_f32_16x16x32_bf16 v[216:219], a[56:59], v[64:67], v[216:219]
    s_waitcnt lgkmcnt(5)
    buffer_load_dwordx4 v[200:203], v14, s[8:11], s85 offen offset:1024 sc1
    v_mfma_f32_16x16x32_bf16 v[220:223], a[48:51], v[68:71], v[220:223]
    v_mul_f32 v25, v25, v27
    v_permlane32_swap_b32_e64 v21, v23
    v_mfma_f32_16x16x32_bf16 v[224:227], a[52:55], v[68:71], v[224:227]
    v_cvt_pk_bf16_f32 v24, v24, v25
    v_max_f32_e64 v36, 0, v36
    v_mfma_f32_16x16x32_bf16 v[228:231], a[56:59], v[68:71], v[228:231]
    s_waitcnt lgkmcnt(3)
    ds_read_b64 v[82:83], v4 offset:10496
    ds_read_b64 v[84:85], v5 offset:10240
    v_mfma_f32_16x16x32_bf16 v[232:235], a[48:51], v[72:75], v[232:235]
    v_permlane16_swap_b32 v20, v21
    v_mfma_f32_16x16x32_bf16 v[236:239], a[52:55], v[72:75], v[236:239]
    ds_read_b64 v[86:87], v5 offset:10496
    v_max_f32_e64 v37, 0, v37
    v_mfma_f32_16x16x32_bf16 v[240:243], a[56:59], v[72:75], v[240:243]
    s_waitcnt lgkmcnt(4)
    ds_read_b64 v[88:89], v6 offset:10240
    v_mul_f32 v36, v36, v38
    v_mfma_f32_16x16x32_bf16 v[244:247], a[48:51], v[76:79], v[244:247]
    ds_read_b64 v[90:91], v6 offset:10496
    v_permlane16_swap_b32_e64 v22, v23
    v_mfma_f32_16x16x32_bf16 v[248:251], a[52:55], v[76:79], v[248:251]
    ds_read_b64 v[92:93], v7 offset:10240
    v_mul_f32_e64 v37, v37, v39
    v_mfma_f32_16x16x32_bf16 v[252:255], a[56:59], v[76:79], v[252:255]
    s_waitcnt lgkmcnt(5)
    ds_read_b64 v[94:95], v7 offset:10496
    buffer_load_dwordx4 v[204:207], v14, s[8:11], s86 offen offset:1024 sc1
    v_cvt_pk_bf16_f32 v25, v36, v37
    v_mfma_f32_16x16x32_bf16 v[208:211], a[60:63], v[80:83], v[208:211]
    buffer_store_dwordx4 v[20:23], v8, s[8:11], s69 offen sc1
    v_mfma_f32_16x16x32_bf16 v[212:215], a[64:67], v[80:83], v[212:215]
    s_waitcnt vmcnt(37)
    s_barrier
    v_max_f32 v48, 0, v48
    v_mfma_f32_16x16x32_bf16 v[216:219], a[68:71], v[80:83], v[216:219]
    s_waitcnt lgkmcnt(4)
    v_max_f32 v49, 0, v49
    v_mul_f32_e64 v48, v48, v50
    v_mfma_f32_16x16x32_bf16 v[220:223], a[60:63], v[84:87], v[220:223]
    ds_read_b64 v[64:65], v4 offset:12288
    v_mul_f32_e64 v49, v49, v51
    v_mfma_f32_16x16x32_bf16 v[224:227], a[64:67], v[84:87], v[224:227]
    ds_read_b64 v[66:67], v4 offset:12544
    v_cvt_pk_bf16_f32 v26, v48, v49
    v_mfma_f32_16x16x32_bf16 v[228:231], a[68:71], v[84:87], v[228:231]
    s_waitcnt lgkmcnt(4)
    ds_read_b64 v[68:69], v5 offset:12288
    v_max_f32 v60, 0, v60
    v_mfma_f32_16x16x32_bf16 v[232:235], a[60:63], v[88:91], v[232:235]
    ds_read_b64 v[70:71], v5 offset:12544
    v_max_f32_e64 v61, 0, v61
    v_mfma_f32_16x16x32_bf16 v[236:239], a[64:67], v[88:91], v[236:239]
    buffer_load_dwordx4 a[0:3], v14, s[8:11], s87 offen offset:1024 sc1
    v_mfma_f32_16x16x32_bf16 v[240:243], a[68:71], v[88:91], v[240:243]
    s_waitcnt lgkmcnt(4)
    ds_read_b64 v[72:73], v6 offset:12288
    v_mul_f32 v60, v60, v62
    v_mfma_f32_16x16x32_bf16 v[244:247], a[60:63], v[92:95], v[244:247]
    ds_read_b64 v[74:75], v6 offset:12544
    v_mul_f32_e64 v61, v61, v63
    v_mfma_f32_16x16x32_bf16 v[248:251], a[64:67], v[92:95], v[248:251]
    ds_read_b64 v[76:77], v7 offset:12288
    v_cvt_pk_bf16_f32 v27, v60, v61
    v_mfma_f32_16x16x32_bf16 v[252:255], a[68:71], v[92:95], v[252:255]
    s_waitcnt lgkmcnt(5)
    ds_read_b64 v[78:79], v7 offset:12544
    v_permlane32_swap_b32 v24, v26
    v_mfma_f32_16x16x32_bf16 v[208:211], a[72:75], v[64:67], v[208:211]
    v_permlane32_swap_b32_e64 v25, v27
    v_mfma_f32_16x16x32_bf16 v[212:215], a[76:79], v[64:67], v[212:215]
    s_nop 0
    v_permlane16_swap_b32 v24, v25
    v_mfma_f32_16x16x32_bf16 v[216:219], a[80:83], v[64:67], v[216:219]
    s_waitcnt lgkmcnt(4)
    v_permlane16_swap_b32 v26, v27
    v_mfma_f32_16x16x32_bf16 v[220:223], a[72:75], v[68:71], v[220:223]
    buffer_load_dwordx4 a[4:7], v14, s[8:11], s88 offen offset:1024 sc1
    buffer_store_dwordx4 v[24:27], v8, s[8:11], s70 offen sc1
    v_mfma_f32_16x16x32_bf16 v[224:227], a[76:79], v[68:71], v[224:227]
    ds_read_b64 v[80:81], v4 offset:14336
    ds_read_b64 v[82:83], v4 offset:14592
    v_mfma_f32_16x16x32_bf16 v[228:231], a[80:83], v[68:71], v[228:231]
    s_waitcnt lgkmcnt(4)
    ds_read_b64 v[84:85], v5 offset:14336
    ds_read_b64 v[86:87], v5 offset:14592
    v_mfma_f32_16x16x32_bf16 v[232:235], a[72:75], v[72:75], v[232:235]
    ds_read_b64 v[88:89], v6 offset:14336
    ds_read_b64 v[90:91], v6 offset:14592
    v_mfma_f32_16x16x32_bf16 v[236:239], a[76:79], v[72:75], v[236:239]
    buffer_load_dwordx4 a[8:11], v14, s[8:11], s84 offen offset:2048 sc1
    v_mfma_f32_16x16x32_bf16 v[240:243], a[80:83], v[72:75], v[240:243]
    s_waitcnt lgkmcnt(6)
    ds_read_b64 v[92:93], v7 offset:14336
    ds_read_b64 v[94:95], v7 offset:14592
    v_mfma_f32_16x16x32_bf16 v[244:247], a[72:75], v[76:79], v[244:247]
    v_mfma_f32_16x16x32_bf16 v[248:251], a[76:79], v[76:79], v[248:251]
    v_mfma_f32_16x16x32_bf16 v[252:255], a[80:83], v[76:79], v[252:255]
    s_waitcnt lgkmcnt(6)
    buffer_load_dwordx4 a[12:15], v14, s[8:11], s85 offen offset:2048 sc1
    v_mfma_f32_16x16x32_bf16 v[208:211], a[84:87], v[80:83], v[208:211]
    ds_read_b64 v[64:65], v4 offset:16384
    ds_read_b64 v[66:67], v4 offset:16640
    v_mfma_f32_16x16x32_bf16 v[212:215], a[88:91], v[80:83], v[212:215]
    ds_read_b64 v[68:69], v5 offset:16384
    ds_read_b64 v[70:71], v5 offset:16640
    v_mfma_f32_16x16x32_bf16 v[216:219], a[92:95], v[80:83], v[216:219]
    s_waitcnt lgkmcnt(8)
    ds_read_b64 v[72:73], v6 offset:16384
    ds_read_b64 v[74:75], v6 offset:16640
    v_mfma_f32_16x16x32_bf16 v[220:223], a[84:87], v[84:87], v[220:223]
    buffer_load_dwordx4 a[16:19], v14, s[8:11], s86 offen offset:2048 sc1
    v_mfma_f32_16x16x32_bf16 v[224:227], a[88:91], v[84:87], v[224:227]
    ds_read_b64 v[76:77], v7 offset:16384
    ds_read_b64 v[78:79], v7 offset:16640
    v_mfma_f32_16x16x32_bf16 v[228:231], a[92:95], v[84:87], v[228:231]
    s_waitcnt lgkmcnt(10)
    v_mfma_f32_16x16x32_bf16 v[232:235], a[84:87], v[88:91], v[232:235]
    v_mfma_f32_16x16x32_bf16 v[236:239], a[88:91], v[88:91], v[236:239]
    buffer_load_dwordx4 a[20:23], v14, s[8:11], s87 offen offset:2048 sc1
    v_mfma_f32_16x16x32_bf16 v[240:243], a[92:95], v[88:91], v[240:243]
    s_waitcnt lgkmcnt(8)
    v_mfma_f32_16x16x32_bf16 v[244:247], a[84:87], v[92:95], v[244:247]
    v_mfma_f32_16x16x32_bf16 v[248:251], a[88:91], v[92:95], v[248:251]
    v_mfma_f32_16x16x32_bf16 v[252:255], a[92:95], v[92:95], v[252:255]
    s_waitcnt lgkmcnt(6)
    buffer_load_dwordx4 a[24:27], v14, s[8:11], s88 offen offset:2048 sc1
    v_mfma_f32_16x16x32_bf16 v[208:211], a[96:99], v[64:67], v[208:211]
    ds_read_b64 v[80:81], v4 offset:18432
    ds_read_b64 v[82:83], v4 offset:18688
    v_mfma_f32_16x16x32_bf16 v[212:215], a[100:103], v[64:67], v[212:215]
    ds_read_b64 v[84:85], v5 offset:18432
    ds_read_b64 v[86:87], v5 offset:18688
    v_mfma_f32_16x16x32_bf16 v[216:219], a[104:107], v[64:67], v[216:219]
    s_waitcnt lgkmcnt(8)
    ds_read_b64 v[88:89], v6 offset:18432
    ds_read_b64 v[90:91], v6 offset:18688
    v_mfma_f32_16x16x32_bf16 v[220:223], a[96:99], v[68:71], v[220:223]
    buffer_load_dwordx4 a[28:31], v14, s[8:11], s84 offen offset:3072 sc1
    v_mfma_f32_16x16x32_bf16 v[224:227], a[100:103], v[68:71], v[224:227]
    ds_read_b64 v[92:93], v7 offset:18432
    ds_read_b64 v[94:95], v7 offset:18688
    v_mfma_f32_16x16x32_bf16 v[228:231], a[104:107], v[68:71], v[228:231]
    s_waitcnt lgkmcnt(10)
    v_mfma_f32_16x16x32_bf16 v[232:235], a[96:99], v[72:75], v[232:235]
    v_mfma_f32_16x16x32_bf16 v[236:239], a[100:103], v[72:75], v[236:239]
    buffer_load_dwordx4 a[32:35], v14, s[8:11], s85 offen offset:3072 sc1
    v_mfma_f32_16x16x32_bf16 v[240:243], a[104:107], v[72:75], v[240:243]
    s_waitcnt lgkmcnt(8)
    v_mfma_f32_16x16x32_bf16 v[244:247], a[96:99], v[76:79], v[244:247]
    v_mfma_f32_16x16x32_bf16 v[248:251], a[100:103], v[76:79], v[248:251]
    v_mfma_f32_16x16x32_bf16 v[252:255], a[104:107], v[76:79], v[252:255]
    s_waitcnt lgkmcnt(6)
    v_mfma_f32_16x16x32_bf16 v[208:211], a[108:111], v[80:83], v[208:211]
    buffer_load_dwordx4 a[36:39], v14, s[8:11], s86 offen offset:3072 sc1
    v_mfma_f32_16x16x32_bf16 v[212:215], a[112:115], v[80:83], v[212:215]
    ds_read_b64 v[64:65], v4 offset:20480
    ds_read_b64 v[66:67], v4 offset:20736
    v_mfma_f32_16x16x32_bf16 v[216:219], a[116:119], v[80:83], v[216:219]
    s_waitcnt lgkmcnt(6)
    ds_read_b64 v[68:69], v5 offset:20480
    ds_read_b64 v[70:71], v5 offset:20736
    v_mfma_f32_16x16x32_bf16 v[220:223], a[108:111], v[84:87], v[220:223]
L_pg3023:
    s_cbranch_execz L_hopr4
    ds_read_b64 v[72:73], v6 offset:20480
    ds_read_b64 v[74:75], v6 offset:20736
    v_mfma_f32_16x16x32_bf16 v[224:227], a[112:115], v[84:87], v[224:227]
    buffer_load_dwordx4 a[40:43], v14, s[8:11], s87 offen offset:3072 sc1
    v_mfma_f32_16x16x32_bf16 v[228:231], a[116:119], v[84:87], v[228:231]
    s_waitcnt lgkmcnt(8)
    ds_read_b64 v[76:77], v7 offset:20480
    ds_read_b64 v[78:79], v7 offset:20736
    v_mfma_f32_16x16x32_bf16 v[232:235], a[108:111], v[88:91], v[232:235]
    v_mfma_f32_16x16x32_bf16 v[236:239], a[112:115], v[88:91], v[236:239]
    v_mfma_f32_16x16x32_bf16 v[240:243], a[116:119], v[88:91], v[240:243]
    s_waitcnt lgkmcnt(8)
    v_mfma_f32_16x16x32_bf16 v[244:247], a[108:111], v[92:95], v[244:247]
    buffer_load_dwordx4 a[44:47], v14, s[8:11], s88 offen offset:3072 sc1
    v_mfma_f32_16x16x32_bf16 v[248:251], a[112:115], v[92:95], v[248:251]
    v_mfma_f32_16x16x32_bf16 v[252:255], a[116:119], v[92:95], v[252:255]
    s_waitcnt lgkmcnt(6)
    v_mfma_f32_16x16x32_bf16 v[208:211], a[120:123], v[64:67], v[208:211]
    ds_read_b64 v[80:81], v4 offset:22528
    ds_read_b64 v[82:83], v4 offset:22784
    v_mfma_f32_16x16x32_bf16 v[212:215], a[124:127], v[64:67], v[212:215]
    buffer_load_dwordx4 a[48:51], v15, s[8:11], s84 offen offset:0 sc1
    v_mfma_f32_16x16x32_bf16 v[216:219], a[128:131], v[64:67], v[216:219]
    s_waitcnt lgkmcnt(6)
    ds_read_b64 v[84:85], v5 offset:22528
    ds_read_b64 v[86:87], v5 offset:22784
    v_mfma_f32_16x16x32_bf16 v[220:223], a[120:123], v[68:71], v[220:223]
    ds_read_b64 v[88:89], v6 offset:22528
    ds_read_b64 v[90:91], v6 offset:22784
    v_mfma_f32_16x16x32_bf16 v[224:227], a[124:127], v[68:71], v[224:227]
    ds_read_b64 v[92:93], v7 offset:22528
    ds_read_b64 v[94:95], v7 offset:22784
    v_mfma_f32_16x16x32_bf16 v[228:231], a[128:131], v[68:71], v[228:231]
    s_waitcnt lgkmcnt(10)
    v_mfma_f32_16x16x32_bf16 v[232:235], a[120:123], v[72:75], v[232:235]
    buffer_load_dwordx4 a[52:55], v15, s[8:11], s85 offen offset:0 sc1
    v_mfma_f32_16x16x32_bf16 v[236:239], a[124:127], v[72:75], v[236:239]
    s_waitcnt vmcnt(12)
    v_mfma_f32_16x16x32_bf16 v[240:243], a[128:131], v[72:75], v[240:243]
    s_waitcnt lgkmcnt(8)
    v_mfma_f32_16x16x32_bf16 v[244:247], a[120:123], v[76:79], v[244:247]
    buffer_store_dword v14, v3, s[8:11], s54 offen sc1
    s_add_u32 s54, s54, 262144
    v_mfma_f32_16x16x32_bf16 v[248:251], a[124:127], v[76:79], v[248:251]
    s_add_u32 s53, s53, 393216
    s_add_u32 s69, s69, 393216
    s_add_u32 s70, s70, 393216
    v_mfma_f32_16x16x32_bf16 v[252:255], a[128:131], v[76:79], v[252:255]
    s_waitcnt lgkmcnt(6)
    v_mfma_f32_16x16x32_bf16 v[208:211], a[132:135], v[80:83], v[208:211]
    ds_read_b64 v[64:65], v4 offset:24576
    ds_read_b64 v[66:67], v4 offset:24832
    v_mfma_f32_16x16x32_bf16 v[212:215], a[136:139], v[80:83], v[212:215]
    buffer_load_dwordx4 a[56:59], v15, s[8:11], s86 offen offset:0 sc1
    v_mfma_f32_16x16x32_bf16 v[216:219], a[140:143], v[80:83], v[216:219]
    s_waitcnt lgkmcnt(6)
    ds_read_b64 v[68:69], v5 offset:24576
    ds_read_b64 v[70:71], v5 offset:24832
    v_mfma_f32_16x16x32_bf16 v[220:223], a[132:135], v[84:87], v[220:223]
    ds_read_b64 v[72:73], v6 offset:24576
    ds_read_b64 v[74:75], v6 offset:24832
    v_mfma_f32_16x16x32_bf16 v[224:227], a[136:139], v[84:87], v[224:227]
    ds_read_b64 v[76:77], v7 offset:24576
    ds_read_b64 v[78:79], v7 offset:24832
    v_mfma_f32_16x16x32_bf16 v[228:231], a[140:143], v[84:87], v[228:231]
    s_waitcnt lgkmcnt(10)
    buffer_load_dwordx4 a[60:63], v15, s[8:11], s87 offen offset:0 sc1
    v_mfma_f32_16x16x32_bf16 v[232:235], a[132:135], v[88:91], v[232:235]
    v_mfma_f32_16x16x32_bf16 v[236:239], a[136:139], v[88:91], v[236:239]
    v_mfma_f32_16x16x32_bf16 v[240:243], a[140:143], v[88:91], v[240:243]
    s_waitcnt lgkmcnt(8)
    v_mfma_f32_16x16x32_bf16 v[244:247], a[132:135], v[92:95], v[244:247]
    buffer_load_dwordx4 a[64:67], v15, s[8:11], s88 offen offset:0 sc1
    v_mfma_f32_16x16x32_bf16 v[248:251], a[136:139], v[92:95], v[248:251]
    v_mfma_f32_16x16x32_bf16 v[252:255], a[140:143], v[92:95], v[252:255]
    s_waitcnt lgkmcnt(6)
    v_mfma_f32_16x16x32_bf16 v[208:211], a[144:147], v[64:67], v[208:211]
    s_barrier
    ds_read_b64 v[80:81], v4 offset:26624
    v_mfma_f32_16x16x32_bf16 v[212:215], a[148:151], v[64:67], v[212:215]
    buffer_load_dwordx4 a[68:71], v15, s[8:11], s84 offen offset:1024 sc1
    v_mfma_f32_16x16x32_bf16 v[216:219], a[152:155], v[64:67], v[216:219]
    s_waitcnt lgkmcnt(5)
    ds_read_b64 v[82:83], v4 offset:26880
    ds_read_b64 v[84:85], v5 offset:26624
    v_mfma_f32_16x16x32_bf16 v[220:223], a[144:147], v[68:71], v[220:223]
    ds_read_b64 v[86:87], v5 offset:26880
    ds_read_b64 v[88:89], v6 offset:26624
    v_mfma_f32_16x16x32_bf16 v[224:227], a[148:151], v[68:71], v[224:227]
    ds_read_b64 v[90:91], v6 offset:26880
    ds_read_b64 v[92:93], v7 offset:26624
    v_mfma_f32_16x16x32_bf16 v[228:231], a[152:155], v[68:71], v[228:231]
    s_waitcnt lgkmcnt(9)
    buffer_load_dwordx4 a[72:75], v15, s[8:11], s85 offen offset:1024 sc1
    v_mfma_f32_16x16x32_bf16 v[232:235], a[144:147], v[72:75], v[232:235]
    ds_read_b64 v[94:95], v7 offset:26880
    v_mfma_f32_16x16x32_bf16 v[236:239], a[148:151], v[72:75], v[236:239]
    v_mfma_f32_16x16x32_bf16 v[240:243], a[152:155], v[72:75], v[240:243]
    s_waitcnt lgkmcnt(8)
    v_mfma_f32_16x16x32_bf16 v[244:247], a[144:147], v[76:79], v[244:247]
    buffer_load_dwordx4 a[76:79], v15, s[8:11], s86 offen offset:1024 sc1
    v_mfma_f32_16x16x32_bf16 v[248:251], a[148:151], v[76:79], v[248:251]
    v_mfma_f32_16x16x32_bf16 v[252:255], a[152:155], v[76:79], v[252:255]
    s_waitcnt lgkmcnt(6)
    v_mfma_f32_16x16x32_bf16 v[208:211], a[156:159], v[80:83], v[208:211]
    ds_read_b64 v[64:65], v4 offset:28672
    ds_read_b64 v[66:67], v4 offset:28928
    v_mfma_f32_16x16x32_bf16 v[212:215], a[160:163], v[80:83], v[212:215]
    buffer_load_dwordx4 a[80:83], v15, s[8:11], s87 offen offset:1024 sc1
    v_mfma_f32_16x16x32_bf16 v[216:219], a[164:167], v[80:83], v[216:219]
    s_waitcnt lgkmcnt(6)
    ds_read_b64 v[68:69], v5 offset:28672
    ds_read_b64 v[70:71], v5 offset:28928
    v_mfma_f32_16x16x32_bf16 v[220:223], a[156:159], v[84:87], v[220:223]
    ds_read_b64 v[72:73], v6 offset:28672
    ds_read_b64 v[74:75], v6 offset:28928
    v_mfma_f32_16x16x32_bf16 v[224:227], a[160:163], v[84:87], v[224:227]
    ds_read_b64 v[76:77], v7 offset:28672
    ds_read_b64 v[78:79], v7 offset:28928
    v_mfma_f32_16x16x32_bf16 v[228:231], a[164:167], v[84:87], v[228:231]
    s_waitcnt lgkmcnt(10)
    v_mfma_f32_16x16x32_bf16 v[232:235], a[156:159], v[88:91], v[232:235]
    buffer_load_dwordx4 a[84:87], v15, s[8:11], s88 offen offset:1024 sc1
    v_mfma_f32_16x16x32_bf16 v[236:239], a[160:163], v[88:91], v[236:239]
    v_mfma_f32_16x16x32_bf16 v[240:243], a[164:167], v[88:91], v[240:243]
    s_waitcnt lgkmcnt(8)
    v_mfma_f32_16x16x32_bf16 v[244:247], a[156:159], v[92:95], v[244:247]
    v_mfma_f32_16x16x32_bf16 v[248:251], a[160:163], v[92:95], v[248:251]
    buffer_load_dwordx4 a[88:91], v15, s[8:11], s84 offen offset:2048 sc1
    v_mfma_f32_16x16x32_bf16 v[252:255], a[164:167], v[92:95], v[252:255]
    s_waitcnt lgkmcnt(6)
    v_mfma_f32_16x16x32_bf16 v[208:211], a[168:171], v[64:67], v[208:211]
    ds_read_b64 v[80:81], v4 offset:30720
    ds_read_b64 v[82:83], v4 offset:30976
    v_mfma_f32_16x16x32_bf16 v[212:215], a[172:175], v[64:67], v[212:215]
    ds_read_b64 v[84:85], v5 offset:30720
    ds_read_b64 v[86:87], v5 offset:30976
    v_mfma_f32_16x16x32_bf16 v[216:219], a[176:179], v[64:67], v[216:219]
    s_waitcnt lgkmcnt(8)
    ds_read_b64 v[88:89], v6 offset:30720
    ds_read_b64 v[90:91], v6 offset:30976
    v_mfma_f32_16x16x32_bf16 v[220:223], a[168:171], v[68:71], v[220:223]
    buffer_load_dwordx4 a[92:95], v15, s[8:11], s85 offen offset:2048 sc1
    v_mfma_f32_16x16x32_bf16 v[224:227], a[172:175], v[68:71], v[224:227]
    ds_read_b64 v[92:93], v7 offset:30720
    ds_read_b64 v[94:95], v7 offset:30976
    v_mfma_f32_16x16x32_bf16 v[228:231], a[176:179], v[68:71], v[228:231]
    s_waitcnt lgkmcnt(10)
    v_mfma_f32_16x16x32_bf16 v[232:235], a[168:171], v[72:75], v[232:235]
    v_mfma_f32_16x16x32_bf16 v[236:239], a[172:175], v[72:75], v[236:239]
    buffer_load_dwordx4 a[96:99], v15, s[8:11], s86 offen offset:2048 sc1
    v_mfma_f32_16x16x32_bf16 v[240:243], a[176:179], v[72:75], v[240:243]
    s_waitcnt lgkmcnt(8)
    v_mfma_f32_16x16x32_bf16 v[244:247], a[168:171], v[76:79], v[244:247]
    v_mfma_f32_16x16x32_bf16 v[248:251], a[172:175], v[76:79], v[248:251]
    v_mfma_f32_16x16x32_bf16 v[252:255], a[176:179], v[76:79], v[252:255]
    s_waitcnt lgkmcnt(6)
    v_mfma_f32_16x16x32_bf16 v[208:211], a[180:183], v[80:83], v[208:211]
    buffer_load_dwordx4 a[100:103], v15, s[8:11], s87 offen offset:2048 sc1
    v_mfma_f32_16x16x32_bf16 v[212:215], a[184:187], v[80:83], v[212:215]
    ds_read_b64 v[64:65], v4 offset:32768
    ds_read_b64 v[66:67], v4 offset:33024
    v_mfma_f32_16x16x32_bf16 v[216:219], a[188:191], v[80:83], v[216:219]
    s_waitcnt lgkmcnt(6)
    ds_read_b64 v[68:69], v5 offset:32768
    ds_read_b64 v[70:71], v5 offset:33024
    v_mfma_f32_16x16x32_bf16 v[220:223], a[180:183], v[84:87], v[220:223]
    buffer_load_dword v12, v11, s[8:11], s55 offen sc1
    v_mfma_f32_16x16x32_bf16 v[224:227], a[184:187], v[84:87], v[224:227]
    ds_read_b64 v[72:73], v6 offset:32768
    ds_read_b64 v[74:75], v6 offset:33024
    v_mfma_f32_16x16x32_bf16 v[228:231], a[188:191], v[84:87], v[228:231]
    s_waitcnt lgkmcnt(8)
    ds_read_b64 v[76:77], v7 offset:32768
    ds_read_b64 v[78:79], v7 offset:33024
    v_mfma_f32_16x16x32_bf16 v[232:235], a[180:183], v[88:91], v[232:235]
    v_mfma_f32_16x16x32_bf16 v[236:239], a[184:187], v[88:91], v[236:239]
    buffer_load_dwordx4 a[104:107], v15, s[8:11], s88 offen offset:2048 sc1
    v_mfma_f32_16x16x32_bf16 v[240:243], a[188:191], v[88:91], v[240:243]
    s_waitcnt lgkmcnt(8)
    v_mfma_f32_16x16x32_bf16 v[244:247], a[180:183], v[92:95], v[244:247]
    v_mfma_f32_16x16x32_bf16 v[248:251], a[184:187], v[92:95], v[248:251]
    v_mfma_f32_16x16x32_bf16 v[252:255], a[188:191], v[92:95], v[252:255]
    s_waitcnt lgkmcnt(6)
    buffer_load_dwordx4 a[108:111], v15, s[8:11], s84 offen offset:3072 sc1
    v_mfma_f32_16x16x32_bf16 v[208:211], a[192:195], v[64:67], v[208:211]
    ds_read_b64 v[80:81], v4 offset:34816
    ds_read_b64 v[82:83], v4 offset:35072
    v_mfma_f32_16x16x32_bf16 v[212:215], a[196:199], v[64:67], v[212:215]
    ds_read_b64 v[84:85], v5 offset:34816
    ds_read_b64 v[86:87], v5 offset:35072
    v_mfma_f32_16x16x32_bf16 v[216:219], a[200:203], v[64:67], v[216:219]
    s_waitcnt lgkmcnt(8)
    ds_read_b64 v[88:89], v6 offset:34816
    ds_read_b64 v[90:91], v6 offset:35072
    v_mfma_f32_16x16x32_bf16 v[220:223], a[192:195], v[68:71], v[220:223]
    buffer_load_dwordx4 a[112:115], v15, s[8:11], s85 offen offset:3072 sc1
    v_mfma_f32_16x16x32_bf16 v[224:227], a[196:199], v[68:71], v[224:227]
    ds_read_b64 v[92:93], v7 offset:34816
    ds_read_b64 v[94:95], v7 offset:35072
    v_mfma_f32_16x16x32_bf16 v[228:231], a[200:203], v[68:71], v[228:231]
    s_waitcnt lgkmcnt(10)
    v_mfma_f32_16x16x32_bf16 v[232:235], a[192:195], v[72:75], v[232:235]
    v_mfma_f32_16x16x32_bf16 v[236:239], a[196:199], v[72:75], v[236:239]
    buffer_load_dwordx4 a[116:119], v15, s[8:11], s86 offen offset:3072 sc1
    v_mfma_f32_16x16x32_bf16 v[240:243], a[200:203], v[72:75], v[240:243]
    s_waitcnt lgkmcnt(8)
    v_mfma_f32_16x16x32_bf16 v[244:247], a[192:195], v[76:79], v[244:247]
    v_mfma_f32_16x16x32_bf16 v[248:251], a[196:199], v[76:79], v[248:251]
    v_mfma_f32_16x16x32_bf16 v[252:255], a[200:203], v[76:79], v[252:255]
    s_waitcnt lgkmcnt(6)
    buffer_load_dwordx4 a[120:123], v15, s[8:11], s87 offen offset:3072 sc1
    v_mfma_f32_16x16x32_bf16 v[208:211], a[204:207], v[80:83], v[208:211]
    ds_read_b64 v[64:65], v4 offset:36864
    ds_read_b64 v[66:67], v4 offset:37120
    v_mfma_f32_16x16x32_bf16 v[212:215], a[208:211], v[80:83], v[212:215]
    ds_read_b64 v[68:69], v5 offset:36864
    ds_read_b64 v[70:71], v5 offset:37120
    v_mfma_f32_16x16x32_bf16 v[216:219], a[212:215], v[80:83], v[216:219]
    s_waitcnt lgkmcnt(8)
    ds_read_b64 v[72:73], v6 offset:36864
    ds_read_b64 v[74:75], v6 offset:37120
    v_mfma_f32_16x16x32_bf16 v[220:223], a[204:207], v[84:87], v[220:223]
    buffer_load_dwordx4 a[124:127], v15, s[8:11], s88 offen offset:3072 sc1
    v_mfma_f32_16x16x32_bf16 v[224:227], a[208:211], v[84:87], v[224:227]
    ds_read_b64 v[76:77], v7 offset:36864
    ds_read_b64 v[78:79], v7 offset:37120
    v_mfma_f32_16x16x32_bf16 v[228:231], a[212:215], v[84:87], v[228:231]
    s_waitcnt lgkmcnt(10)
    v_mfma_f32_16x16x32_bf16 v[232:235], a[204:207], v[88:91], v[232:235]
    v_mfma_f32_16x16x32_bf16 v[236:239], a[208:211], v[88:91], v[236:239]
    v_mfma_f32_16x16x32_bf16 v[240:243], a[212:215], v[88:91], v[240:243]
    s_waitcnt lgkmcnt(8)
    v_mfma_f32_16x16x32_bf16 v[244:247], a[204:207], v[92:95], v[244:247]
    v_mfma_f32_16x16x32_bf16 v[248:251], a[208:211], v[92:95], v[248:251]
    v_mfma_f32_16x16x32_bf16 v[252:255], a[212:215], v[92:95], v[252:255]
    s_waitcnt lgkmcnt(6)
    v_mfma_f32_16x16x32_bf16 v[208:211], a[216:219], v[64:67], v[208:211]
    ds_read_b64 v[80:81], v4 offset:38912
    ds_read_b64 v[82:83], v4 offset:39168
    v_mfma_f32_16x16x32_bf16 v[212:215], a[220:223], v[64:67], v[212:215]
    ds_read_b64 v[84:85], v5 offset:38912
    ds_read_b64 v[86:87], v5 offset:39168
    v_mfma_f32_16x16x32_bf16 v[216:219], a[224:227], v[64:67], v[216:219]
    s_waitcnt lgkmcnt(8)
    ds_read_b64 v[88:89], v6 offset:38912
    ds_read_b64 v[90:91], v6 offset:39168
    v_mfma_f32_16x16x32_bf16 v[220:223], a[216:219], v[68:71], v[220:223]
    ds_read_b64 v[92:93], v7 offset:38912
    ds_read_b64 v[94:95], v7 offset:39168
    v_mfma_f32_16x16x32_bf16 v[224:227], a[220:223], v[68:71], v[224:227]
    v_mfma_f32_16x16x32_bf16 v[228:231], a[224:227], v[68:71], v[228:231]
    s_waitcnt lgkmcnt(10)
    v_mfma_f32_16x16x32_bf16 v[232:235], a[216:219], v[72:75], v[232:235]
    v_mfma_f32_16x16x32_bf16 v[236:239], a[220:223], v[72:75], v[236:239]
    v_mfma_f32_16x16x32_bf16 v[240:243], a[224:227], v[72:75], v[240:243]
    s_waitcnt lgkmcnt(8)
    v_mfma_f32_16x16x32_bf16 v[244:247], a[216:219], v[76:79], v[244:247]
    v_mfma_f32_16x16x32_bf16 v[248:251], a[220:223], v[76:79], v[248:251]
    v_mfma_f32_16x16x32_bf16 v[252:255], a[224:227], v[76:79], v[252:255]
    s_waitcnt lgkmcnt(6)
    v_mfma_f32_16x16x32_bf16 v[208:211], a[228:231], v[80:83], v[208:211]
    s_waitcnt vmcnt(6)
    v_cmp_eq_u32 vcc, 0, v12
    v_mfma_f32_16x16x32_bf16 v[212:215], a[232:235], v[80:83], v[212:215]
    s_cbranch_vccnz L_slow7
L_back7:
    v_mfma_f32_16x16x32_bf16 v[216:219], a[236:239], v[80:83], v[216:219]
    s_waitcnt lgkmcnt(4)
    buffer_load_dwordx4 a[128:131], v13, s[8:11], s56 offen offset:0 sc1
    v_mfma_f32_16x16x32_bf16 v[220:223], a[228:231], v[84:87], v[220:223]
    v_mfma_f32_16x16x32_bf16 v[224:227], a[232:235], v[84:87], v[224:227]
    v_mfma_f32_16x16x32_bf16 v[228:231], a[236:239], v[84:87], v[228:231]
    s_waitcnt lgkmcnt(2)
    v_mfma_f32_16x16x32_bf16 v[232:235], a[228:231], v[88:91], v[232:235]
    buffer_load_dwordx4 a[132:135], v13, s[8:11], s57 offen offset:0 sc1
    v_mfma_f32_16x16x32_bf16 v[236:239], a[232:235], v[88:91], v[236:239]
    v_mfma_f32_16x16x32_bf16 v[240:243], a[236:239], v[88:91], v[240:243]
    s_waitcnt lgkmcnt(0)
    v_mfma_f32_16x16x32_bf16 v[244:247], a[228:231], v[92:95], v[244:247]
    v_mfma_f32_16x16x32_bf16 v[248:251], a[232:235], v[92:95], v[248:251]
    buffer_load_dwordx4 a[136:139], v13, s[8:11], s56 offen offset:1024 sc1
    v_mfma_f32_16x16x32_bf16 v[252:255], a[236:239], v[92:95], v[252:255]
    v_max_f32_e64 v208, 0, v208
    buffer_load_dwordx4 a[140:143], v13, s[8:11], s57 offen offset:1024 sc1
    v_max_f32_e64 v209, 0, v209
    v_pk_mul_f32 v[208:209], v[208:209], v[210:211]
    v_cvt_pk_bf16_f32 v208, v208, v209
    v_max_f32 v220, 0, v220
    v_max_f32 v221, 0, v221
    v_pk_mul_f32 v[220:221], v[220:221], v[222:223]
    v_cvt_pk_bf16_f32 v209, v220, v221
    v_max_f32 v232, 0, v232
    v_max_f32 v233, 0, v233
    v_pk_mul_f32 v[232:233], v[232:233], v[234:235]
    v_cvt_pk_bf16_f32 v210, v232, v233
    v_max_f32_e64 v244, 0, v244
    buffer_load_dwordx4 a[144:147], v13, s[8:11], s56 offen offset:2048 sc1
    v_max_f32_e64 v245, 0, v245
    v_pk_mul_f32 v[244:245], v[244:245], v[246:247]
    v_cvt_pk_bf16_f32 v211, v244, v245
    v_max_f32 v212, 0, v212
    v_max_f32 v213, 0, v213
    v_permlane32_swap_b32_e64 v208, v210
    v_pk_mul_f32 v[212:213], v[212:213], v[214:215]
    v_cvt_pk_bf16_f32 v212, v212, v213
    v_permlane32_swap_b32 v209, v211
    v_max_f32 v224, 0, v224
    v_max_f32 v225, 0, v225
    v_permlane16_swap_b32 v208, v209
    v_pk_mul_f32 v[224:225], v[224:225], v[226:227]
    buffer_load_dwordx4 a[148:151], v13, s[8:11], s57 offen offset:2048 sc1
    v_cvt_pk_bf16_f32 v213, v224, v225
    v_permlane16_swap_b32 v210, v211
    v_max_f32 v236, 0, v236
    v_max_f32_e64 v237, 0, v237
    buffer_store_dwordx4 v[208:211], v8, s[8:11], s53 offen sc1
    v_pk_mul_f32 v[236:237], v[236:237], v[238:239]
    v_cvt_pk_bf16_f32 v214, v236, v237
    v_max_f32 v248, 0, v248
    v_max_f32 v249, 0, v249
    v_pk_mul_f32 v[248:249], v[248:249], v[250:251]
    v_cvt_pk_bf16_f32 v215, v248, v249
    v_max_f32_e64 v216, 0, v216
    buffer_load_dwordx4 a[152:155], v13, s[8:11], s56 offen offset:3072 sc1
    v_max_f32 v217, 0, v217
    v_permlane32_swap_b32 v212, v214
    v_pk_mul_f32 v[216:217], v[216:217], v[218:219]
    v_cvt_pk_bf16_f32 v216, v216, v217
    v_permlane32_swap_b32 v213, v215
    v_max_f32 v228, 0, v228
    v_max_f32 v229, 0, v229
    v_permlane16_swap_b32 v212, v213
    v_pk_mul_f32 v[228:229], v[228:229], v[230:231]
    v_cvt_pk_bf16_f32 v217, v228, v229
    v_permlane16_swap_b32 v214, v215
    v_max_f32 v240, 0, v240
    v_max_f32_e64 v241, 0, v241
    buffer_load_dwordx4 a[156:159], v13, s[8:11], s57 offen offset:3072 sc1
    buffer_store_dwordx4 v[212:215], v8, s[8:11], s69 offen sc1
    v_pk_mul_f32 v[240:241], v[240:241], v[242:243]
    v_cvt_pk_bf16_f32 v218, v240, v241
    v_max_f32 v252, 0, v252
    v_max_f32 v253, 0, v253
    v_pk_mul_f32 v[252:253], v[252:253], v[254:255]
    v_cvt_pk_bf16_f32 v219, v252, v253
    v_permlane32_swap_b32 v216, v218
    s_nop 0
    v_permlane32_swap_b32 v217, v219
    s_nop 1
    v_permlane16_swap_b32 v216, v217
    v_permlane16_swap_b32 v218, v219
    buffer_store_dwordx4 v[216:219], v8, s[8:11], s70 offen sc1
    s_waitcnt vmcnt(10)
    v_mfma_f32_16x16x32_bf16 v[16:19], v[96:99], a[128:131], 0
    s_waitcnt vmcnt(9)
    s_lshr_b32 s48, s3, 1
    s_mul_i32 s48, s48, 81920
    v_mfma_f32_16x16x32_bf16 v[20:23], v[96:99], a[132:135], 0
    buffer_load_dwordx4 a[160:163], v14, s[8:11], s56 offen offset:0 sc1
    v_mfma_f32_16x16x32_bf16 v[24:27], v[100:103], a[128:131], 0
    s_add_u32 s48, s48, s59
    s_sub_u32 s48, s48, 81920
    s_and_b32 s49, s3, 1
    v_mfma_f32_16x16x32_bf16 v[28:31], v[100:103], a[132:135], 0
    s_lshl_b32 s49, s49, 7
    v_xor_b32 v250, s49, v4
    v_add_u32 v250, s48, v250
    v_mfma_f32_16x16x32_bf16 v[32:35], v[104:107], a[128:131], 0
    v_cmp_eq_u32 vcc, 0, v2
    v_mov_b32 v248, -1
    v_mfma_f32_16x16x32_bf16 v[36:39], v[104:107], a[132:135], 0
    v_mov_b32 v249, 0xffff0000
    v_cndmask_b32_e64 v248, v248, v249, vcc
    v_mfma_f32_16x16x32_bf16 v[40:43], v[108:111], a[128:131], 0
    buffer_load_dwordx4 a[164:167], v14, s[8:11], s57 offen offset:0 sc1
    v_mfma_f32_16x16x32_bf16 v[44:47], v[108:111], a[132:135], 0
    v_mov_b32 v244, v3
    v_mov_b32 v245, v11
    v_mfma_f32_16x16x32_bf16 v[48:51], v[112:115], a[128:131], 0
    s_add_u32 s55, s55, 262144
    ds_read_b64 v[60:61], v250 offset:0
    ds_read_b64 v[62:63], v250 offset:256
    v_mfma_f32_16x16x32_bf16 v[52:55], v[112:115], a[132:135], 0
    s_waitcnt vmcnt(10)
    ds_read_b64 v[64:65], v250 offset:2048
    ds_read_b64 v[66:67], v250 offset:2304
    v_mfma_f32_16x16x32_bf16 v[16:19], v[116:119], a[136:139], v[16:19]
    s_waitcnt vmcnt(9)
    buffer_load_dwordx4 a[168:171], v14, s[8:11], s56 offen offset:1024 sc1
    v_mfma_f32_16x16x32_bf16 v[20:23], v[116:119], a[140:143], v[20:23]
    v_mfma_f32_16x16x32_bf16 v[24:27], v[120:123], a[136:139], v[24:27]
    s_mul_i32 s48, s3, 6144
    s_add_u32 s48, s48, s58
    v_add_u32 v4, s48, v13
    v_mfma_f32_16x16x32_bf16 v[28:31], v[120:123], a[140:143], v[28:31]
    v_lshrrev_b32 v251, 1, v2
    v_and_b32 v12, 1, v2
    v_mfma_f32_16x16x32_bf16 v[32:35], v[124:127], a[136:139], v[32:35]
    buffer_load_dwordx4 a[172:175], v14, s[8:11], s57 offen offset:1024 sc1
    v_mfma_f32_16x16x32_bf16 v[36:39], v[124:127], a[140:143], v[36:39]
    v_lshlrev_b32_e64 v5, 10, v251
    v_lshl_add_u32 v5, v12, 3, v5
    v_mfma_f32_16x16x32_bf16 v[40:43], v[128:131], a[136:139], v[40:43]
    v_lshl_add_u32 v5, v1, 4, v5
    s_lshl_b32 s48, s3, 8
    v_mfma_f32_16x16x32_bf16 v[44:47], v[128:131], a[140:143], v[44:47]
    s_add_u32 s48, s48, s58
    v_add_u32_e64 v5, s48, v5
    v_lshl_add_u32 v11, v1, 1, v251
    v_mfma_f32_16x16x32_bf16 v[48:51], v[132:135], a[136:139], v[48:51]
    buffer_load_dwordx4 a[176:179], v14, s[8:11], s56 offen offset:2048 sc1
    v_mfma_f32_16x16x32_bf16 v[52:55], v[132:135], a[140:143], v[52:55]
    s_waitcnt vmcnt(11)
    s_waitcnt lgkmcnt(3)
    v_and_b32_e64 v60, v248, v60
    ds_read_b64 v[68:69], v250 offset:4096
    v_mfma_f32_16x16x32_bf16 v[16:19], v[136:139], a[144:147], v[16:19]
    s_waitcnt vmcnt(10)
    ds_read_b64 v[70:71], v250 offset:4352
    ds_read_b64 v[72:73], v250 offset:6144
    v_mfma_f32_16x16x32_bf16 v[20:23], v[136:139], a[148:151], v[20:23]
    ds_read_b64 v[74:75], v250 offset:6400
    ds_read_b64 v[76:77], v250 offset:8192
    v_mfma_f32_16x16x32_bf16 v[24:27], v[140:143], a[144:147], v[24:27]
    ds_read_b64 v[78:79], v250 offset:8448
    v_lshlrev_b32 v11, 2, v11
    v_mfma_f32_16x16x32_bf16 v[28:31], v[140:143], a[148:151], v[28:31]
    s_waitcnt lgkmcnt(8)
    buffer_load_dwordx4 a[180:183], v14, s[8:11], s57 offen offset:2048 sc1
    v_mfma_f32_16x16x32_bf16 v[56:59], v[60:63], v[60:63], 0
    v_add_u32 v3, s63, v11
    v_lshl_add_u32 v11, v12, 13, v11
    v_mfma_f32_16x16x32_bf16 v[32:35], v[144:147], a[144:147], v[32:35]
    ds_read_b64 v[80:81], v250 offset:10240
    s_mul_i32 s49, s67, 5
    v_mfma_f32_16x16x32_bf16 v[36:39], v[144:147], a[148:151], v[36:39]
    s_waitcnt lgkmcnt(7)
    s_add_u32 s50, s49, s3
    v_lshlrev_b32 v251, 7, v251
    v_mfma_f32_16x16x32_bf16 v[56:59], v[64:67], v[64:67], v[56:59]
    buffer_load_dwordx4 a[184:187], v14, s[8:11], s56 offen offset:3072 sc1
    v_mfma_f32_16x16x32_bf16 v[40:43], v[148:151], a[144:147], v[40:43]
    v_xor_b32 v6, v251, v13
    s_lshl_b32 s48, s50, 10
    v_mfma_f32_16x16x32_bf16 v[44:47], v[148:151], a[148:151], v[44:47]
    s_waitcnt lgkmcnt(5)
    s_add_u32 s48, s48, s59
    ds_read_b64 v[82:83], v250 offset:10496
    ds_read_b64 v[84:85], v250 offset:12288
    v_mfma_f32_16x16x32_bf16 v[56:59], v[68:71], v[68:71], v[56:59]
    ds_read_b64 v[86:87], v250 offset:12544
    ds_read_b64 v[88:89], v250 offset:14336
    v_mfma_f32_16x16x32_bf16 v[48:51], v[152:155], a[144:147], v[48:51]
    v_add_u32_e64 v6, s48, v6
    buffer_load_dwordx4 a[188:191], v14, s[8:11], s57 offen offset:3072 sc1
    v_mfma_f32_16x16x32_bf16 v[52:55], v[152:155], a[148:151], v[52:55]
    s_waitcnt lgkmcnt(7)
    v_lshlrev_b32 v10, 4, v1
    v_lshl_add_u32 v8, v2, 15, v10
    v_mfma_f32_16x16x32_bf16 v[56:59], v[72:75], v[72:75], v[56:59]
    s_waitcnt vmcnt(11)
    v_lshl_add_u32 v10, v2, 2, v10
    s_lshl_b32 s48, s3, 6
    v_mfma_f32_16x16x32_bf16 v[16:19], v[156:159], a[152:155], v[16:19]
    s_waitcnt vmcnt(10)
    s_and_b32 s48, s48, 128
    v_xor_b32 v7, s48, v10
    v_mfma_f32_16x16x32_bf16 v[20:23], v[156:159], a[156:159], v[20:23]
    s_waitcnt lgkmcnt(5)
    buffer_load_dwordx4 a[192:195], v15, s[8:11], s56 offen offset:0 sc1
    v_mfma_f32_16x16x32_bf16 v[56:59], v[76:79], v[76:79], v[56:59]
    s_lshl_b32 s49, s49, 2
    ds_read_b64 v[90:91], v250 offset:14592
    ds_read_b64 v[60:61], v250 offset:16384
    v_mfma_f32_16x16x32_bf16 v[24:27], v[160:163], a[152:155], v[24:27]
    s_add_u32 s49, s49, s3
    s_add_u32 s49, s49, 16
    ds_read_b64 v[62:63], v250 offset:16640
    ds_read_b64 v[64:65], v250 offset:18432
    v_mfma_f32_16x16x32_bf16 v[28:31], v[160:163], a[156:159], v[28:31]
    s_waitcnt lgkmcnt(7)
    s_lshl_b32 s48, s49, 8
    s_add_u32 s48, s48, s59
    v_mfma_f32_16x16x32_bf16 v[56:59], v[80:83], v[80:83], v[56:59]
    buffer_load_dwordx4 a[196:199], v15, s[8:11], s57 offen offset:0 sc1
    v_mfma_f32_16x16x32_bf16 v[32:35], v[164:167], a[152:155], v[32:35]
    ds_read_b64 v[66:67], v250 offset:18688
    ds_read_b64 v[68:69], v250 offset:20480
    v_mfma_f32_16x16x32_bf16 v[36:39], v[164:167], a[156:159], v[36:39]
    s_waitcnt lgkmcnt(7)
    v_add_u32 v7, s48, v7
    s_lshl_b32 s48, s64, 2
    v_mfma_f32_16x16x32_bf16 v[56:59], v[84:87], v[84:87], v[56:59]
    s_add_u32 s48, s48, s66
    s_lshl_b32 s51, s48, 7
    s_add_u32 s100, s51, 147456
    v_mfma_f32_16x16x32_bf16 v[40:43], v[168:171], a[152:155], v[40:43]
    buffer_load_dwordx4 a[200:203], v15, s[8:11], s56 offen offset:1024 sc1
    v_mfma_f32_16x16x32_bf16 v[44:47], v[168:171], a[156:159], v[44:47]
    s_waitcnt lgkmcnt(5)
    ds_read_b64 v[70:71], v250 offset:20736
    ds_read_b64 v[72:73], v250 offset:22528
    v_mfma_f32_16x16x32_bf16 v[56:59], v[88:91], v[88:91], v[56:59]
    s_and_b32 s51, s48, 32
    s_add_u32 s48, s48, s51
    s_lshl_b32 s48, s48, 8
    v_mfma_f32_16x16x32_bf16 v[48:51], v[172:175], a[152:155], v[48:51]
    s_add_u32 s48, s48, 12582912
    ds_read_b64 v[74:75], v250 offset:22784
    ds_read_b64 v[76:77], v250 offset:24576
    v_mfma_f32_16x16x32_bf16 v[52:55], v[172:175], a[156:159], v[52:55]
    s_waitcnt lgkmcnt(7)
    buffer_load_dwordx4 a[204:207], v15, s[8:11], s57 offen offset:1024 sc1
    v_mfma_f32_16x16x32_bf16 v[56:59], v[60:63], v[60:63], v[56:59]
    s_waitcnt vmcnt(11)
    s_lshr_b32 s51, s50, 5
    s_mul_i32 s98, s51, 0xff380000
    v_mfma_f32_16x16x32_bf16 v[16:19], v[176:179], a[160:163], v[16:19]
    s_waitcnt vmcnt(10)
    s_lshr_b32 s51, s49, 7
    ds_read_b64 v[78:79], v250 offset:24832
    ds_read_b64 v[80:81], v250 offset:26624
    v_mfma_f32_16x16x32_bf16 v[20:23], v[176:179], a[164:167], v[20:23]
    s_waitcnt lgkmcnt(7)
    s_mul_i32 s99, s51, 0xff380000
    s_add_u32 s98, s98, s48
    v_mfma_f32_16x16x32_bf16 v[56:59], v[64:67], v[64:67], v[56:59]
    buffer_load_dwordx4 a[208:211], v15, s[8:11], s56 offen offset:2048 sc1
    v_mfma_f32_16x16x32_bf16 v[24:27], v[180:183], a[160:163], v[24:27]
    s_add_u32 s99, s99, s48
    ds_read_b64 v[82:83], v250 offset:26880
    ds_read_b64 v[84:85], v250 offset:28672
    v_mfma_f32_16x16x32_bf16 v[28:31], v[180:183], a[164:167], v[28:31]
    s_waitcnt lgkmcnt(7)
    s_lshr_b32 s48, s50, 1
    s_lshl_b32 s48, s48, 4
    v_mfma_f32_16x16x32_bf16 v[56:59], v[68:71], v[68:71], v[56:59]
    s_and_b32 s51, s50, 1
    s_add_u32 s48, s48, s51
    ds_read_b64 v[86:87], v250 offset:28928
    v_mfma_f32_16x16x32_bf16 v[32:35], v[184:187], a[160:163], v[32:35]
    ds_read_b64 v[88:89], v250 offset:30720
    buffer_load_dwordx4 a[212:215], v15, s[8:11], s57 offen offset:2048 sc1
    v_mfma_f32_16x16x32_bf16 v[36:39], v[184:187], a[164:167], v[36:39]
    s_waitcnt lgkmcnt(7)
    s_lshl_b32 s48, s48, 13
    v_mfma_f32_16x16x32_bf16 v[56:59], v[72:75], v[72:75], v[56:59]
    s_add_u32 s98, s98, s48
    s_lshr_b32 s48, s49, 3
    ds_read_b64 v[90:91], v250 offset:30976
    v_mfma_f32_16x16x32_bf16 v[40:43], v[188:191], a[160:163], v[40:43]
    ds_read_b64 v[60:61], v250 offset:32768
    s_lshl_b32 s48, s48, 2
    v_mfma_f32_16x16x32_bf16 v[44:47], v[188:191], a[164:167], v[44:47]
    s_waitcnt lgkmcnt(7)
    buffer_load_dwordx4 a[216:219], v15, s[8:11], s56 offen offset:3072 sc1
    buffer_store_dword v14, v244, s[8:11], s54 offen sc1
    v_mfma_f32_16x16x32_bf16 v[56:59], v[76:79], v[76:79], v[56:59]
    s_add_u32 s48, s48, s3
    s_lshl_b32 s48, s48, 2
    s_bfe_u32 s51, s49, 0x10002
    v_mfma_f32_16x16x32_bf16 v[48:51], v[192:195], a[160:163], v[48:51]
    s_add_u32 s48, s48, s51
    ds_read_b64 v[62:63], v250 offset:33024
    ds_read_b64 v[64:65], v250 offset:34816
    v_mfma_f32_16x16x32_bf16 v[52:55], v[192:195], a[164:167], v[52:55]
    s_waitcnt lgkmcnt(7)
    s_lshl_b32 s48, s48, 13
    s_add_u32 s99, s99, s48
    v_mfma_f32_16x16x32_bf16 v[56:59], v[80:83], v[80:83], v[56:59]
    s_waitcnt vmcnt(13)
    buffer_load_dwordx4 a[220:223], v15, s[8:11], s57 offen offset:3072 sc1
    v_mfma_f32_16x16x32_bf16 v[16:19], v[196:199], a[168:171], v[16:19]
    s_waitcnt vmcnt(13)
    s_add_u32 s56, s56, 393216
    ds_read_b64 v[66:67], v250 offset:35072
    ds_read_b64 v[68:69], v250 offset:36864
    v_mfma_f32_16x16x32_bf16 v[20:23], v[196:199], a[172:175], v[20:23]
    s_waitcnt lgkmcnt(7)
    ds_read_b64 v[70:71], v250 offset:37120
    ds_read_b64 v[72:73], v250 offset:38912
    v_mfma_f32_16x16x32_bf16 v[56:59], v[84:87], v[84:87], v[56:59]
    s_add_u32 s57, s57, 393216
    v_add_u32 v251, s50, v2
    v_cmp_eq_u32 vcc, 0, v251
    v_mfma_f32_16x16x32_bf16 v[24:27], v[200:203], a[168:171], v[24:27]
    s_mov_b32 s101, 0xffff0000
    ds_read_b64 v[74:75], v250 offset:39168
    v_cndmask_b32_e64 v12, 1.0, v251, vcc
    v_mfma_f32_16x16x32_bf16 v[28:31], v[200:203], a[172:175], v[28:31]
    s_waitcnt lgkmcnt(8)
    v_mfma_f32_16x16x32_bf16 v[56:59], v[88:91], v[88:91], v[56:59]
L_pg3616:
    s_cbranch_execz L_hopr4
    v_mfma_f32_16x16x32_bf16 v[32:35], v[204:207], a[168:171], v[32:35]
    ds_read_b128 v[240:243], v6
    ds_read_b32 v252, v7
    v_mfma_f32_16x16x32_bf16 v[36:39], v[204:207], a[172:175], v[36:39]
    s_waitcnt lgkmcnt(8)
    v_mfma_f32_16x16x32_bf16 v[56:59], v[60:63], v[60:63], v[56:59]
    v_mfma_f32_16x16x32_bf16 v[40:43], a[0:3], a[168:171], v[40:43]
    v_mfma_f32_16x16x32_bf16 v[44:47], a[0:3], a[172:175], v[44:47]
    s_waitcnt lgkmcnt(6)
    v_mfma_f32_16x16x32_bf16 v[56:59], v[64:67], v[64:67], v[56:59]
    v_mfma_f32_16x16x32_bf16 v[48:51], a[4:7], a[168:171], v[48:51]
    v_mfma_f32_16x16x32_bf16 v[52:55], a[4:7], a[172:175], v[52:55]
    s_waitcnt lgkmcnt(4)
    v_mfma_f32_16x16x32_bf16 v[56:59], v[68:71], v[68:71], v[56:59]
    s_waitcnt vmcnt(12)
    v_mfma_f32_16x16x32_bf16 v[16:19], a[8:11], a[176:179], v[16:19]
    s_waitcnt vmcnt(11)
    v_mfma_f32_16x16x32_bf16 v[20:23], a[8:11], a[180:183], v[20:23]
    s_waitcnt lgkmcnt(2)
    s_waitcnt lgkmcnt(1)
    v_lshlrev_b32 v232, 16, v240
    v_mfma_f32_16x16x32_bf16 v[56:59], v[72:75], v[72:75], v[56:59]
    v_and_b32 v233, s101, v240
    v_lshlrev_b32 v234, 16, v241
    v_mfma_f32_16x16x32_bf16 v[24:27], a[12:15], a[176:179], v[24:27]
    v_and_b32 v235, s101, v241
    v_lshlrev_b32 v236, 16, v242
    v_mfma_f32_16x16x32_bf16 v[28:31], a[12:15], a[180:183], v[28:31]
    v_and_b32 v237, s101, v242
    v_lshlrev_b32 v238, 16, v243
    v_mfma_f32_16x16x32_bf16 v[32:35], a[16:19], a[176:179], v[32:35]
    v_and_b32_e64 v239, s101, v243
    v_mfma_f32_16x16x32_bf16 v[36:39], a[16:19], a[180:183], v[36:39]
    s_waitcnt lgkmcnt(0)
    v_and_b32 v253, s101, v252
    v_lshlrev_b32 v252, 16, v252
    v_and_b32 v248, 3, v1
    v_mfma_f32_16x16x32_bf16 v[40:43], a[20:23], a[176:179], v[40:43]
    v_cmp_eq_u32_e64 vcc, 1, v248
    v_mfma_f32_16x16x32_bf16 v[44:47], a[20:23], a[180:183], v[44:47]
    s_nop 0
    v_cndmask_b32 v56, v56, v57, vcc
    v_cmp_eq_u32_e64 vcc, 2, v248
    v_mfma_f32_16x16x32_bf16 v[48:51], a[24:27], a[176:179], v[48:51]
    v_mfma_f32_16x16x32_bf16 v[52:55], a[24:27], a[180:183], v[52:55]
    s_waitcnt vmcnt(10)
    v_cndmask_b32 v56, v56, v58, vcc
    v_cmp_eq_u32_e64 vcc, 3, v248
    v_mfma_f32_16x16x32_bf16 v[16:19], a[28:31], a[184:187], v[16:19]
    s_waitcnt vmcnt(9)
    v_cndmask_b32 v56, v56, v59, vcc
    v_mov_b32 v249, 0x3727c5ac
    v_mfma_f32_16x16x32_bf16 v[20:23], a[28:31], a[188:191], v[20:23]
    v_fmac_f32 v249, 0x3acccccd, v56
    v_mfma_f32_16x16x32_bf16 v[24:27], a[32:35], a[184:187], v[24:27]
    v_rcp_f32_e64 v248, v249
    v_mfma_f32_16x16x32_bf16 v[28:31], a[32:35], a[188:191], v[28:31]
    s_lshl_b32 s48, s3, 6
    s_add_u32 s48, s48, s63
    v_bfe_u32 v250, v250, 3, 4
    v_mfma_f32_16x16x32_bf16 v[32:35], a[36:39], a[184:187], v[32:35]
    v_lshl_add_u32 v250, v250, 2, s48
    v_lshrrev_b32_e64 v56, 2, v1
    v_mfma_f32_16x16x32_bf16 v[36:39], a[36:39], a[188:191], v[36:39]
    v_cmp_eq_u32_e64 vcc, v56, v2
    v_add_u32 v56, 2048, v250
    v_mfma_f32_16x16x32_bf16 v[40:43], a[40:43], a[184:187], v[40:43]
    v_cndmask_b32_e64 v250, v56, v250, vcc
    v_mfma_f32_16x16x32_bf16 v[44:47], a[40:43], a[188:191], v[44:47]
    ds_write_b32 v250, v248 offset:32768
    ds_write_b32 v250, v249 offset:33024
    v_mfma_f32_16x16x32_bf16 v[48:51], a[44:47], a[184:187], v[48:51]
    v_mfma_f32_16x16x32_bf16 v[52:55], a[44:47], a[188:191], v[52:55]
    s_waitcnt vmcnt(8)
    v_mfma_f32_16x16x32_bf16 v[16:19], a[48:51], a[192:195], v[16:19]
    s_waitcnt vmcnt(7)
    buffer_load_dword v246, v245, s[8:11], s55 offen sc1
    v_mfma_f32_16x16x32_bf16 v[20:23], a[48:51], a[196:199], v[20:23]
    s_waitcnt vmcnt(7)
    v_mfma_f32_16x16x32_bf16 v[16:19], a[68:71], a[200:203], v[16:19]
    s_waitcnt vmcnt(6)
    v_mfma_f32_16x16x32_bf16 v[20:23], a[68:71], a[204:207], v[20:23]
    s_waitcnt vmcnt(5)
    s_lshl_b32 s48, s3, 11
    s_add_u32 s48, s48, 24576
    v_mfma_f32_16x16x32_bf16 v[16:19], a[88:91], a[208:211], v[16:19]
    s_waitcnt vmcnt(4)
    s_add_u32 s48, s48, s58
    v_add_u32_e64 v9, s48, v13
    v_mfma_f32_16x16x32_bf16 v[20:23], a[88:91], a[212:215], v[20:23]
    s_waitcnt vmcnt(3)
    v_mfma_f32_16x16x32_bf16 v[16:19], a[108:111], a[216:219], v[16:19]
    s_waitcnt vmcnt(1)
    v_mfma_f32_16x16x32_bf16 v[20:23], a[108:111], a[220:223], v[20:23]
    v_mfma_f32_16x16x32_bf16 v[24:27], a[52:55], a[192:195], v[24:27]
    v_mfma_f32_16x16x32_bf16 v[28:31], a[52:55], a[196:199], v[28:31]
    ds_write_b128 v9, v[16:19] offset:0
    v_mfma_f32_16x16x32_bf16 v[24:27], a[72:75], a[200:203], v[24:27]
    ds_write_b128 v9, v[20:23] offset:1024
    v_mfma_f32_16x16x32_bf16 v[28:31], a[72:75], a[204:207], v[28:31]
    s_add_u32 s48, s3, 1
    s_and_b32 s48, s48, 3
    s_mul_i32 s48, s48, 6144
    v_mfma_f32_16x16x32_bf16 v[24:27], a[92:95], a[208:211], v[24:27]
    s_add_u32 s48, s48, s58
    v_add_u32 v9, s48, v13
    v_mfma_f32_16x16x32_bf16 v[28:31], a[92:95], a[212:215], v[28:31]
    v_mfma_f32_16x16x32_bf16 v[24:27], a[112:115], a[216:219], v[24:27]
    v_mfma_f32_16x16x32_bf16 v[28:31], a[112:115], a[220:223], v[28:31]
    v_mfma_f32_16x16x32_bf16 v[32:35], a[56:59], a[192:195], v[32:35]
    v_mfma_f32_16x16x32_bf16 v[36:39], a[56:59], a[196:199], v[36:39]
    ds_write_b128 v9, v[24:27] offset:0
    v_mfma_f32_16x16x32_bf16 v[32:35], a[76:79], a[200:203], v[32:35]
    ds_write_b128 v9, v[28:31] offset:1024
    v_mfma_f32_16x16x32_bf16 v[36:39], a[76:79], a[204:207], v[36:39]
    s_add_u32 s48, s3, 2
    s_and_b32 s48, s48, 3
    s_mul_i32 s48, s48, 6144
    v_mfma_f32_16x16x32_bf16 v[32:35], a[96:99], a[208:211], v[32:35]
    s_add_u32 s48, s48, s58
    v_add_u32 v9, s48, v13
    v_mfma_f32_16x16x32_bf16 v[36:39], a[96:99], a[212:215], v[36:39]
    v_mfma_f32_16x16x32_bf16 v[32:35], a[116:119], a[216:219], v[32:35]
    v_mfma_f32_16x16x32_bf16 v[36:39], a[116:119], a[220:223], v[36:39]
    v_mfma_f32_16x16x32_bf16 v[40:43], a[60:63], a[192:195], v[40:43]
    v_mfma_f32_16x16x32_bf16 v[44:47], a[60:63], a[196:199], v[44:47]
    ds_write_b128 v9, v[32:35] offset:2048
    v_mfma_f32_16x16x32_bf16 v[40:43], a[80:83], a[200:203], v[40:43]
    ds_write_b128 v9, v[36:39] offset:3072
    v_mfma_f32_16x16x32_bf16 v[44:47], a[80:83], a[204:207], v[44:47]
    s_add_u32 s48, s3, 3
    s_and_b32 s48, s48, 3
    s_mul_i32 s48, s48, 6144
    v_mfma_f32_16x16x32_bf16 v[40:43], a[100:103], a[208:211], v[40:43]
    s_add_u32 s48, s48, s58
    s_waitcnt vmcnt(0)
    v_cmp_eq_u32_e64 vcc, 0, v246
    v_mfma_f32_16x16x32_bf16 v[44:47], a[100:103], a[212:215], v[44:47]
    s_cbranch_vccnz L_slow8
L_back8:
    v_add_u32 v9, s48, v13
    v_mfma_f32_16x16x32_bf16 v[40:43], a[120:123], a[216:219], v[40:43]
    buffer_load_dwordx4 a[224:227], v13, s[8:11], s56 offen offset:0 sc1
    v_mfma_f32_16x16x32_bf16 v[44:47], a[120:123], a[220:223], v[44:47]
    v_mfma_f32_16x16x32_bf16 v[48:51], a[64:67], a[192:195], v[48:51]
    v_mfma_f32_16x16x32_bf16 v[52:55], a[64:67], a[196:199], v[52:55]
    ds_write_b128 v9, v[40:43] offset:4096
    v_mfma_f32_16x16x32_bf16 v[48:51], a[84:87], a[200:203], v[48:51]
    buffer_load_dwordx4 a[228:231], v13, s[8:11], s57 offen offset:0 sc1
    v_mfma_f32_16x16x32_bf16 v[52:55], a[84:87], a[204:207], v[52:55]
    ds_write_b128 v9, v[44:47] offset:5120
    v_mfma_f32_16x16x32_bf16 v[48:51], a[104:107], a[208:211], v[48:51]
    v_mfma_f32_16x16x32_bf16 v[52:55], a[104:107], a[212:215], v[52:55]
    v_mfma_f32_16x16x32_bf16 v[48:51], a[124:127], a[216:219], v[48:51]
    buffer_load_dwordx4 a[232:235], v13, s[8:11], s56 offen offset:1024 sc1
    v_mfma_f32_16x16x32_bf16 v[52:55], a[124:127], a[220:223], v[52:55]
    buffer_load_dwordx4 a[236:239], v13, s[8:11], s57 offen offset:1024 sc1
    buffer_load_dwordx4 a[240:243], v13, s[8:11], s56 offen offset:2048 sc1
    v_lshl_add_u32 v9, v1, 3, s63
    s_lshl_b32 s60, s3, 8
    s_add_u32 s60, s60, s63
    s_waitcnt lgkmcnt(0)
    s_barrier
    ds_read_b128 v[208:211], v4 offset:0
    ds_read_b128 v[212:215], v4 offset:1024
    ds_read_b128 v[216:219], v4 offset:2048
    ds_read_b128 v[220:223], v4 offset:3072
    ds_read_b128 v[224:227], v4 offset:4096
    ds_read_b128 v[228:231], v4 offset:5120
    ds_read_b64 v[244:245], v5 offset:24576
    ds_read_b64 v[246:247], v5 offset:26624
    ds_read_b64 v[248:249], v5 offset:28672
    ds_read_b64 v[250:251], v5 offset:30720
    ds_read_b64 v[92:93], v9 offset:32768
    ds_read_b32 v94, v3 offset:32768
    buffer_load_dwordx4 a[244:247], v13, s[8:11], s57 offen offset:2048 sc1
    v_lshl_add_u32 v28, v0, 2, s60
    s_waitcnt lgkmcnt(9)
    v_pk_add_f32 v[208:209], v[208:209], v[216:217]
    v_pk_add_f32 v[210:211], v[210:211], v[218:219]
    s_waitcnt lgkmcnt(8)
    v_pk_add_f32 v[212:213], v[212:213], v[220:221]
    v_pk_add_f32 v[214:215], v[214:215], v[222:223]
    s_waitcnt lgkmcnt(7)
    v_pk_add_f32 v[208:209], v[208:209], v[224:225]
    v_pk_add_f32 v[210:211], v[210:211], v[226:227]
    buffer_load_dwordx4 a[248:251], v13, s[8:11], s56 offen offset:3072 sc1
    s_waitcnt lgkmcnt(6)
    v_pk_add_f32 v[212:213], v[212:213], v[228:229]
    v_pk_add_f32 v[214:215], v[214:215], v[230:231]
    v_pk_add_f32 v[208:209], v[208:209], v[48:49]
    v_pk_add_f32 v[210:211], v[210:211], v[50:51]
    v_pk_add_f32 v[212:213], v[212:213], v[52:53]
    v_pk_add_f32 v[214:215], v[214:215], v[54:55]
    s_waitcnt lgkmcnt(1)
    s_nop 0
    v_pk_fma_f32 v[232:233], v[208:209], v[92:93], v[232:233] op_sel_hi:[1,0,1]
    buffer_load_dwordx4 a[252:255], v13, s[8:11], s57 offen offset:3072 sc1
    v_pk_fma_f32 v[234:235], v[210:211], v[92:93], v[234:235] op_sel_hi:[1,0,1]
    v_pk_fma_f32 v[236:237], v[212:213], v[92:93], v[236:237] op_sel:[0,1,0]
    v_pk_fma_f32 v[238:239], v[214:215], v[92:93], v[238:239] op_sel:[0,1,0]
    v_cvt_pk_bf16_f32 v20, v232, v233
    v_cvt_pk_bf16_f32 v21, v234, v235
    v_cvt_pk_bf16_f32 v22, v236, v237
    v_cvt_pk_bf16_f32 v23, v238, v239
    v_pk_add_f32 v[244:245], v[244:245], v[246:247]
    buffer_load_dwordx4 a[128:131], v14, s[8:11], s56 offen offset:0 sc1
    v_pk_add_f32 v[248:249], v[248:249], v[250:251]
    v_pk_add_f32 v[244:245], v[244:245], v[248:249]
    s_waitcnt lgkmcnt(0)
    v_pk_fma_f32 v[252:253], v[244:245], v[94:95], v[252:253] op_sel_hi:[1,0,1]
    v_cvt_pk_bf16_f32 v24, v252, v253
    v_mul_f32 v252, v252, v252
    v_fmac_f32 v252, v253, v253
    v_mul_f32 v232, v12, v232
    buffer_load_dwordx4 a[132:135], v14, s[8:11], s57 offen offset:0 sc1
    v_mul_f32_e64 v236, v12, v236
    v_pk_mul_f32 v[232:233], v[232:233], v[232:233]
    v_pk_mul_f32 v[236:237], v[236:237], v[236:237]
    v_pk_fma_f32 v[232:233], v[234:235], v[234:235], v[232:233]
    v_pk_fma_f32 v[236:237], v[238:239], v[238:239], v[236:237]
    v_add_f32 v26, v232, v233
    v_add_f32 v27, v236, v237
    buffer_load_dwordx4 a[136:139], v14, s[8:11], s56 offen offset:1024 sc1
    s_nop 0
    v_permlane32_swap_b32 v26, v27
    v_add_f32 v26, v26, v252
    v_add_f32 v26, v26, v27
    v_mov_b32 v27, v26
    s_nop 1
    v_permlane16_swap_b32 v26, v27
    v_add_f32 v26, v26, v27
    ds_write_b32 v28, v26 offset:36864
    s_waitcnt vmcnt(10)
    v_mfma_f32_16x16x32_bf16 v[56:59], v[96:99], a[224:227], 0
    s_waitcnt vmcnt(9)
    s_add_u32 s58, s58, 81920
    v_add_u32 v4, 81920, v4
    v_mfma_f32_16x16x32_bf16 v[60:63], v[96:99], a[228:231], 0
    buffer_load_dwordx4 a[140:143], v14, s[8:11], s57 offen offset:1024 sc1
    v_mfma_f32_16x16x32_bf16 v[64:67], v[100:103], a[224:227], 0
    v_add_u32 v5, 81920, v5
    v_add_u32 v6, 81920, v6
    v_mfma_f32_16x16x32_bf16 v[68:71], v[100:103], a[228:231], 0
    v_add_u32 v7, 81920, v7
    v_mfma_f32_16x16x32_bf16 v[72:75], v[104:107], a[224:227], 0
    ds_read_b128 v[240:243], v6
    ds_read_b32 v252, v7
    v_mfma_f32_16x16x32_bf16 v[76:79], v[104:107], a[228:231], 0
    buffer_load_dwordx4 a[144:147], v14, s[8:11], s56 offen offset:2048 sc1
    v_mfma_f32_16x16x32_bf16 v[80:83], v[108:111], a[224:227], 0
    v_lshl_add_u32 v9, v1, 3, s63
    v_mfma_f32_16x16x32_bf16 v[84:87], v[108:111], a[228:231], 0
    s_waitcnt vmcnt(10)
    ds_read_b64 v[16:17], v9 offset:32896
    ds_read_b32 v18, v3 offset:32896
    v_mfma_f32_16x16x32_bf16 v[56:59], v[116:119], a[232:235], v[56:59]
    s_waitcnt vmcnt(9)
    s_and_b32 s60, s3, 1
    s_lshl_b32 s61, s60, 10
    v_mfma_f32_16x16x32_bf16 v[60:63], v[116:119], a[236:239], v[60:63]
    buffer_load_dwordx4 a[148:151], v14, s[8:11], s57 offen offset:2048 sc1
    v_mfma_f32_16x16x32_bf16 v[64:67], v[120:123], a[232:235], v[64:67]
    s_add_u32 s61, s61, s63
    v_lshl_add_u32 v29, v0, 2, s61
    s_lshl_b32 s61, s3, 19
    v_mfma_f32_16x16x32_bf16 v[68:71], v[120:123], a[236:239], v[68:71]
    s_and_b32 s61, s61, 0x100000
    s_add_u32 s60, s60, s61
    v_lshl_add_u32 v11, s60, 8, v11
    v_mfma_f32_16x16x32_bf16 v[72:75], v[124:127], a[232:235], v[72:75]
    v_mfma_f32_16x16x32_bf16 v[76:79], v[124:127], a[236:239], v[76:79]
    buffer_load_dwordx4 a[152:155], v14, s[8:11], s56 offen offset:3072 sc1
    v_mfma_f32_16x16x32_bf16 v[80:83], v[128:131], a[232:235], v[80:83]
    v_mfma_f32_16x16x32_bf16 v[84:87], v[128:131], a[236:239], v[84:87]
    s_waitcnt vmcnt(10)
    v_mfma_f32_16x16x32_bf16 v[56:59], v[136:139], a[240:243], v[56:59]
    s_waitcnt vmcnt(9)
    v_mfma_f32_16x16x32_bf16 v[60:63], v[136:139], a[244:247], v[60:63]
    buffer_load_dwordx4 a[156:159], v14, s[8:11], s57 offen offset:3072 sc1
    v_mfma_f32_16x16x32_bf16 v[64:67], v[140:143], a[240:243], v[64:67]
    v_mfma_f32_16x16x32_bf16 v[68:71], v[140:143], a[244:247], v[68:71]
    v_mfma_f32_16x16x32_bf16 v[72:75], v[144:147], a[240:243], v[72:75]
    v_mfma_f32_16x16x32_bf16 v[76:79], v[144:147], a[244:247], v[76:79]
    buffer_load_dwordx4 a[160:163], v15, s[8:11], s56 offen offset:0 sc1
    v_mfma_f32_16x16x32_bf16 v[80:83], v[148:151], a[240:243], v[80:83]
    v_mfma_f32_16x16x32_bf16 v[84:87], v[148:151], a[244:247], v[84:87]
    s_waitcnt vmcnt(10)
    v_mfma_f32_16x16x32_bf16 v[56:59], v[156:159], a[248:251], v[56:59]
    s_waitcnt vmcnt(9)
    v_mfma_f32_16x16x32_bf16 v[60:63], v[156:159], a[252:255], v[60:63]
    buffer_load_dwordx4 a[164:167], v15, s[8:11], s57 offen offset:0 sc1
    v_mfma_f32_16x16x32_bf16 v[64:67], v[160:163], a[248:251], v[64:67]
    v_mfma_f32_16x16x32_bf16 v[68:71], v[160:163], a[252:255], v[68:71]
    v_mfma_f32_16x16x32_bf16 v[72:75], v[164:167], a[248:251], v[72:75]
    v_mfma_f32_16x16x32_bf16 v[76:79], v[164:167], a[252:255], v[76:79]
    buffer_load_dwordx4 a[168:171], v15, s[8:11], s56 offen offset:1024 sc1
    v_mfma_f32_16x16x32_bf16 v[80:83], v[168:171], a[248:251], v[80:83]
    v_mfma_f32_16x16x32_bf16 v[84:87], v[168:171], a[252:255], v[84:87]
    s_waitcnt vmcnt(10)
    v_mfma_f32_16x16x32_bf16 v[56:59], v[176:179], a[128:131], v[56:59]
    s_waitcnt vmcnt(9)
    v_mfma_f32_16x16x32_bf16 v[60:63], v[176:179], a[132:135], v[60:63]
    buffer_load_dwordx4 a[172:175], v15, s[8:11], s57 offen offset:1024 sc1
    v_mfma_f32_16x16x32_bf16 v[64:67], v[180:183], a[128:131], v[64:67]
    v_mfma_f32_16x16x32_bf16 v[68:71], v[180:183], a[132:135], v[68:71]
    v_mfma_f32_16x16x32_bf16 v[72:75], v[184:187], a[128:131], v[72:75]
    v_mfma_f32_16x16x32_bf16 v[76:79], v[184:187], a[132:135], v[76:79]
    buffer_load_dwordx4 a[176:179], v15, s[8:11], s56 offen offset:2048 sc1
    v_mfma_f32_16x16x32_bf16 v[80:83], v[188:191], a[128:131], v[80:83]
    v_mfma_f32_16x16x32_bf16 v[84:87], v[188:191], a[132:135], v[84:87]
    s_waitcnt vmcnt(10)
    v_mfma_f32_16x16x32_bf16 v[56:59], v[196:199], a[136:139], v[56:59]
    s_waitcnt vmcnt(9)
    s_waitcnt lgkmcnt(3)
    v_lshlrev_b32_e64 v232, 16, v240
    v_mfma_f32_16x16x32_bf16 v[60:63], v[196:199], a[140:143], v[60:63]
    v_and_b32 v233, s101, v240
    v_lshlrev_b32 v234, 16, v241
    v_mfma_f32_16x16x32_bf16 v[64:67], v[200:203], a[136:139], v[64:67]
    buffer_load_dwordx4 a[180:183], v15, s[8:11], s57 offen offset:2048 sc1
    v_mfma_f32_16x16x32_bf16 v[68:71], v[200:203], a[140:143], v[68:71]
    v_and_b32 v235, s101, v241
    v_lshlrev_b32 v236, 16, v242
    v_mfma_f32_16x16x32_bf16 v[72:75], v[204:207], a[136:139], v[72:75]
    v_and_b32 v237, s101, v242
    v_lshlrev_b32 v238, 16, v243
    v_mfma_f32_16x16x32_bf16 v[76:79], v[204:207], a[140:143], v[76:79]
    v_and_b32_e64 v239, s101, v243
    v_mfma_f32_16x16x32_bf16 v[80:83], a[0:3], a[136:139], v[80:83]
    buffer_load_dwordx4 a[184:187], v15, s[8:11], s56 offen offset:3072 sc1
    v_mfma_f32_16x16x32_bf16 v[84:87], a[0:3], a[140:143], v[84:87]
    s_waitcnt vmcnt(10)
    s_waitcnt lgkmcnt(2)
    v_and_b32_e64 v253, s101, v252
    v_mfma_f32_16x16x32_bf16 v[56:59], a[8:11], a[144:147], v[56:59]
    s_waitcnt vmcnt(9)
    v_lshlrev_b32 v252, 16, v252
    v_mfma_f32_16x16x32_bf16 v[60:63], a[8:11], a[148:151], v[60:63]
    v_mfma_f32_16x16x32_bf16 v[64:67], a[12:15], a[144:147], v[64:67]
    buffer_load_dwordx4 a[188:191], v15, s[8:11], s57 offen offset:3072 sc1
    v_mfma_f32_16x16x32_bf16 v[68:71], a[12:15], a[148:151], v[68:71]
    v_and_b32_e64 v15, 0x39, v0
    v_bfe_u32 v14, v0, 1, 1
    v_mfma_f32_16x16x32_bf16 v[72:75], a[16:19], a[144:147], v[72:75]
    v_lshl_add_u32 v15, v14, 2, v15
    v_bfe_u32 v14, v0, 2, 1
    v_mfma_f32_16x16x32_bf16 v[76:79], a[16:19], a[148:151], v[76:79]
    v_lshl_add_u32 v15, v14, 1, v15
    v_lshlrev_b32_e64 v15, 4, v15
    v_mfma_f32_16x16x32_bf16 v[80:83], a[20:23], a[144:147], v[80:83]
    s_lshl_b32 s83, s65, 2
    s_add_u32 s83, s83, s3
    s_mul_i32 s83, s83, 61440
    v_mfma_f32_16x16x32_bf16 v[84:87], a[20:23], a[148:151], v[84:87]
    s_waitcnt vmcnt(9)
    s_add_u32 s83, s83, 23117824
    buffer_store_dwordx4 v[20:23], v8, s[8:11], s98 offen offset:0 sc1
    v_mfma_f32_16x16x32_bf16 v[56:59], a[28:31], a[152:155], v[56:59]
    s_waitcnt vmcnt(9)
    v_mfma_f32_16x16x32_bf16 v[60:63], a[28:31], a[156:159], v[60:63]
    v_mfma_f32_16x16x32_bf16 v[64:67], a[32:35], a[152:155], v[64:67]
    v_mfma_f32_16x16x32_bf16 v[68:71], a[32:35], a[156:159], v[68:71]
    buffer_store_dword v24, v10, s[8:11], s99 offen offset:0 sc1
    v_mfma_f32_16x16x32_bf16 v[72:75], a[36:39], a[152:155], v[72:75]
    v_mfma_f32_16x16x32_bf16 v[76:79], a[36:39], a[156:159], v[76:79]
    v_mfma_f32_16x16x32_bf16 v[80:83], a[40:43], a[152:155], v[80:83]
    v_mfma_f32_16x16x32_bf16 v[84:87], a[40:43], a[156:159], v[84:87]
    s_waitcnt vmcnt(9)
    buffer_load_dwordx4 a[192:195], v15, s[8:11], s83 offen offset:0 sc1
    v_mfma_f32_16x16x32_bf16 v[56:59], a[48:51], a[160:163], v[56:59]
    s_waitcnt vmcnt(9)
    v_mfma_f32_16x16x32_bf16 v[60:63], a[48:51], a[164:167], v[60:63]
    v_mfma_f32_16x16x32_bf16 v[64:67], a[52:55], a[160:163], v[64:67]
    v_mfma_f32_16x16x32_bf16 v[68:71], a[52:55], a[164:167], v[68:71]
    buffer_load_dwordx4 a[196:199], v15, s[8:11], s83 offen offset:1024 sc1
    v_mfma_f32_16x16x32_bf16 v[72:75], a[56:59], a[160:163], v[72:75]
    v_mfma_f32_16x16x32_bf16 v[76:79], a[56:59], a[164:167], v[76:79]
    v_mfma_f32_16x16x32_bf16 v[80:83], a[60:63], a[160:163], v[80:83]
    v_mfma_f32_16x16x32_bf16 v[84:87], a[60:63], a[164:167], v[84:87]
    s_waitcnt vmcnt(9)
    buffer_load_dwordx4 a[200:203], v15, s[8:11], s83 offen offset:2048 sc1
    v_mfma_f32_16x16x32_bf16 v[56:59], a[68:71], a[168:171], v[56:59]
    s_waitcnt vmcnt(9)
    v_mfma_f32_16x16x32_bf16 v[60:63], a[68:71], a[172:175], v[60:63]
    v_mfma_f32_16x16x32_bf16 v[64:67], a[72:75], a[168:171], v[64:67]
    v_mfma_f32_16x16x32_bf16 v[68:71], a[72:75], a[172:175], v[68:71]
    buffer_load_dwordx4 a[204:207], v15, s[8:11], s83 offen offset:3072 sc1
    v_mfma_f32_16x16x32_bf16 v[72:75], a[76:79], a[168:171], v[72:75]
    s_add_u32 s83, s83, 0x1000
    v_mfma_f32_16x16x32_bf16 v[76:79], a[76:79], a[172:175], v[76:79]
    v_mfma_f32_16x16x32_bf16 v[80:83], a[80:83], a[168:171], v[80:83]
    v_mfma_f32_16x16x32_bf16 v[84:87], a[80:83], a[172:175], v[84:87]
    s_waitcnt vmcnt(9)
    buffer_load_dwordx4 a[208:211], v15, s[8:11], s83 offen offset:0 sc1
    v_mfma_f32_16x16x32_bf16 v[56:59], a[88:91], a[176:179], v[56:59]
    s_waitcnt vmcnt(9)
    s_lshl_b32 s48, s3, 11
    s_add_u32 s48, s48, 24576
    v_mfma_f32_16x16x32_bf16 v[60:63], a[88:91], a[180:183], v[60:63]
    s_waitcnt vmcnt(8)
    s_add_u32 s48, s48, s58
    v_add_u32 v9, s48, v13
    v_mfma_f32_16x16x32_bf16 v[56:59], a[108:111], a[184:187], v[56:59]
    s_waitcnt vmcnt(7)
    v_mfma_f32_16x16x32_bf16 v[60:63], a[108:111], a[188:191], v[60:63]
    buffer_load_dwordx4 a[212:215], v15, s[8:11], s83 offen offset:1024 sc1
    v_mfma_f32_16x16x32_bf16 v[64:67], a[92:95], a[176:179], v[64:67]
    v_mfma_f32_16x16x32_bf16 v[68:71], a[92:95], a[180:183], v[68:71]
    ds_write_b128 v9, v[56:59] offset:0
    v_mfma_f32_16x16x32_bf16 v[64:67], a[112:115], a[184:187], v[64:67]
    ds_write_b128 v9, v[60:63] offset:1024
    s_add_u32 s48, s3, 1
    s_and_b32 s48, s48, 3
    v_mfma_f32_16x16x32_bf16 v[68:71], a[112:115], a[188:191], v[68:71]
    s_mul_i32 s48, s48, 6144
    buffer_load_dwordx4 a[216:219], v15, s[8:11], s83 offen offset:2048 sc1
    v_mfma_f32_16x16x32_bf16 v[72:75], a[96:99], a[176:179], v[72:75]
    s_add_u32 s48, s48, s58
    v_add_u32_e64 v9, s48, v13
    v_mfma_f32_16x16x32_bf16 v[76:79], a[96:99], a[180:183], v[76:79]
    ds_write_b128 v9, v[64:67] offset:0
    v_mfma_f32_16x16x32_bf16 v[72:75], a[116:119], a[184:187], v[72:75]
    ds_write_b128 v9, v[68:71] offset:1024
    s_add_u32 s48, s3, 2
    s_and_b32 s48, s48, 3
    v_mfma_f32_16x16x32_bf16 v[76:79], a[116:119], a[188:191], v[76:79]
    s_mul_i32 s48, s48, 6144
    buffer_load_dwordx4 a[220:223], v15, s[8:11], s83 offen offset:3072 sc1
    v_mfma_f32_16x16x32_bf16 v[80:83], a[100:103], a[176:179], v[80:83]
    s_add_u32 s48, s48, s58
    s_add_u32 s83, s83, 0xffff3000
    v_add_u32 v9, s48, v13
    v_mfma_f32_16x16x32_bf16 v[84:87], a[100:103], a[180:183], v[84:87]
    ds_write_b128 v9, v[72:75] offset:2048
    v_mfma_f32_16x16x32_bf16 v[80:83], a[120:123], a[184:187], v[80:83]
    ds_write_b128 v9, v[76:79] offset:3072
    s_add_u32 s48, s3, 3
    s_and_b32 s48, s48, 3
    v_mfma_f32_16x16x32_bf16 v[84:87], a[120:123], a[188:191], v[84:87]
    s_mul_i32 s48, s48, 6144
    s_add_u32 s48, s48, s58
    v_add_u32 v9, s48, v13
    v_mfma_f32_16x16x32_bf16 v[88:91], v[112:115], a[224:227], 0
    v_mfma_f32_16x16x32_bf16 v[92:95], v[112:115], a[228:231], 0
    ds_write_b128 v9, v[80:83] offset:4096
    v_mfma_f32_16x16x32_bf16 v[88:91], v[132:135], a[232:235], v[88:91]
    ds_write_b128 v9, v[84:87] offset:5120
    v_mfma_f32_16x16x32_bf16 v[92:95], v[132:135], a[236:239], v[92:95]
    v_mfma_f32_16x16x32_bf16 v[88:91], v[152:155], a[240:243], v[88:91]
    v_mfma_f32_16x16x32_bf16 v[92:95], v[152:155], a[244:247], v[92:95]
    v_mfma_f32_16x16x32_bf16 v[88:91], v[172:175], a[248:251], v[88:91]
    s_waitcnt lgkmcnt(0)
    s_barrier
    v_mfma_f32_16x16x32_bf16 v[92:95], v[172:175], a[252:255], v[92:95]
    ds_read_b128 v[208:211], v4 offset:0
    ds_read_b128 v[212:215], v4 offset:1024
    v_mfma_f32_16x16x32_bf16 v[88:91], v[192:195], a[128:131], v[88:91]
    ds_read_b128 v[216:219], v4 offset:2048
    ds_read_b128 v[220:223], v4 offset:3072
    v_mfma_f32_16x16x32_bf16 v[92:95], v[192:195], a[132:135], v[92:95]
    ds_read_b128 v[224:227], v4 offset:4096
    ds_read_b128 v[228:231], v4 offset:5120
    v_mfma_f32_16x16x32_bf16 v[88:91], a[4:7], a[136:139], v[88:91]
    ds_read_b64 v[244:245], v5 offset:24576
    ds_read_b64 v[246:247], v5 offset:26624
    v_mfma_f32_16x16x32_bf16 v[92:95], a[4:7], a[140:143], v[92:95]
    ds_read_b64 v[248:249], v5 offset:28672
    ds_read_b64 v[250:251], v5 offset:30720
    v_mfma_f32_16x16x32_bf16 v[88:91], a[24:27], a[144:147], v[88:91]
    s_waitcnt lgkmcnt(7)
    v_add_f32 v208, v208, v216
    v_add_f32_e64 v209, v209, v217
    v_mfma_f32_16x16x32_bf16 v[92:95], a[24:27], a[148:151], v[92:95]
    v_add_f32 v210, v210, v218
    v_add_f32 v211, v211, v219
    v_mfma_f32_16x16x32_bf16 v[88:91], a[44:47], a[152:155], v[88:91]
    s_waitcnt lgkmcnt(6)
    v_add_f32 v212, v212, v220
    v_add_f32_e64 v213, v213, v221
    v_mfma_f32_16x16x32_bf16 v[92:95], a[44:47], a[156:159], v[92:95]
    v_add_f32 v214, v214, v222
    v_add_f32 v215, v215, v223
    v_mfma_f32_16x16x32_bf16 v[88:91], a[64:67], a[160:163], v[88:91]
    s_waitcnt lgkmcnt(5)
    v_add_f32 v208, v208, v224
    v_add_f32_e64 v209, v209, v225
    v_mfma_f32_16x16x32_bf16 v[92:95], a[64:67], a[164:167], v[92:95]
    v_add_f32 v210, v210, v226
    v_add_f32 v211, v211, v227
    v_mfma_f32_16x16x32_bf16 v[88:91], a[84:87], a[168:171], v[88:91]
    s_waitcnt lgkmcnt(4)
    v_add_f32 v212, v212, v228
    v_add_f32_e64 v213, v213, v229
    v_mfma_f32_16x16x32_bf16 v[92:95], a[84:87], a[172:175], v[92:95]
    v_add_f32 v214, v214, v230
    v_add_f32 v215, v215, v231
    v_mfma_f32_16x16x32_bf16 v[88:91], a[104:107], a[176:179], v[88:91]
    v_fmac_f32 v232, v208, v16
    v_fmac_f32 v233, v209, v16
    v_mfma_f32_16x16x32_bf16 v[92:95], a[104:107], a[180:183], v[92:95]
    v_fmac_f32 v234, v210, v16
    v_fmac_f32 v235, v211, v16
    v_mfma_f32_16x16x32_bf16 v[88:91], a[124:127], a[184:187], v[88:91]
    v_fmac_f32 v236, v212, v17
    v_fmac_f32 v237, v213, v17
    v_mfma_f32_16x16x32_bf16 v[92:95], a[124:127], a[188:191], v[92:95]
    v_fmac_f32 v238, v214, v17
    v_fmac_f32 v239, v215, v17
    s_waitcnt lgkmcnt(2)
    v_add_f32 v244, v244, v246
    v_add_f32 v245, v245, v247
    s_waitcnt lgkmcnt(1)
    v_add_f32 v244, v244, v248
    v_add_f32 v245, v245, v249
    s_waitcnt lgkmcnt(0)
    v_add_f32 v244, v244, v250
    v_add_f32 v245, v245, v251
    v_fmac_f32 v252, v244, v18
    v_fmac_f32_e64 v253, v245, v18
    v_cvt_pk_bf16_f32 v246, v252, v253
    buffer_store_dword v246, v10, s[8:11], s99 offen offset:512 sc1
    v_mul_f32 v252, v252, v252
    v_fmac_f32 v252, v253, v253
    v_pk_fma_f32 v[232:233], v[88:89], v[16:17], v[232:233] op_sel_hi:[1,0,1]
    v_pk_fma_f32 v[234:235], v[90:91], v[16:17], v[234:235] op_sel_hi:[1,0,1]
    v_pk_fma_f32 v[236:237], v[92:93], v[16:17], v[236:237] op_sel:[0,1,0]
    v_pk_fma_f32 v[238:239], v[94:95], v[16:17], v[238:239] op_sel:[0,1,0]
    v_cvt_pk_bf16_f32 v240, v232, v233
    v_cvt_pk_bf16_f32 v241, v234, v235
    v_cvt_pk_bf16_f32 v242, v236, v237
    v_cvt_pk_bf16_f32 v243, v238, v239
    buffer_store_dwordx4 v[240:243], v8, s[8:11], s98 offen offset:512 sc1
    v_mul_f32 v232, v12, v232
    v_mul_f32 v236, v12, v236
    v_pk_mul_f32 v[232:233], v[232:233], v[232:233]
    v_pk_mul_f32 v[236:237], v[236:237], v[236:237]
    v_pk_fma_f32 v[232:233], v[234:235], v[234:235], v[232:233]
    v_pk_fma_f32 v[236:237], v[238:239], v[238:239], v[236:237]
    v_add_f32 v254, v232, v233
    v_add_f32 v255, v236, v237
    s_nop 1
    v_permlane32_swap_b32 v254, v255
    v_add_f32 v254, v254, v252
    v_add_f32 v254, v254, v255
    v_mov_b32 v255, v254
    s_nop 1
    v_permlane16_swap_b32 v254, v255
    v_add_f32 v254, v254, v255
    ds_write_b32 v28, v254 offset:37888
    s_waitcnt lgkmcnt(0)
    s_barrier
    ds_read2st64_b32 v[30:31], v29 offset0:144 offset1:145
    ds_read2st64_b32 v[32:33], v29 offset0:146 offset1:147
    s_waitcnt lgkmcnt(1)
    v_add_f32 v30, v30, v31
    s_waitcnt lgkmcnt(0)
    v_add_f32 v32, v32, v33
    v_add_f32_e64 v30, v30, v32
    buffer_atomic_add_f32 v30, v11, s[8:11], s100 offen sc1
    s_mov_b32 s68, 1
    s_add_u32 s97, s97, 524288
    v_lshlrev_b32 v12, 4, v0
    s_cmp_ge_u32 s2, 160
    s_cbranch_scc1 L_r3
    s_mov_b32 s91, 0x80008000
    buffer_load_dwordx4 a[0:3], v15, s[8:11], s83 offen offset:0 sc1
    s_lshl_b32 s90, s3, 4
    v_cvt_f32_u32 v3, v2
    v_add_u32 v11, s90, v1
    v_cvt_f32_u32_e64 v11, v11
    v_mul_f32 v5, 0x3c800000, v11
    v_mul_f32 v4, 0x41000000, v3
    v_mul_f32 v4, v4, v5
    v_cos_f32 v6, v4
    v_sin_f32 v8, v4
    v_add_f32 v4, v4, v5
    v_cos_f32 v7, v4
    v_sin_f32 v9, v4
    v_add_f32_e64 v4, v4, v5
    v_cvt_pk_bf16_f32 v128, v6, v7
    v_cvt_pk_bf16_f32 v132, v8, v9
    v_xor_b32_e64 v136, s91, v132
    buffer_load_dwordx4 a[4:7], v15, s[8:11], s83 offen offset:1024 sc1
    v_cos_f32 v6, v4
    v_sin_f32 v8, v4
    v_add_f32 v4, v4, v5
    v_cos_f32 v7, v4
    v_sin_f32 v9, v4
    v_add_f32 v4, v4, v5
    v_cvt_pk_bf16_f32 v129, v6, v7
    v_cvt_pk_bf16_f32 v133, v8, v9
    v_xor_b32 v137, s91, v133
    v_cos_f32 v6, v4
    v_sin_f32 v8, v4
    v_add_f32 v4, v4, v5
    v_cos_f32 v7, v4
    v_sin_f32 v9, v4
    v_add_f32_e64 v4, v4, v5
    v_cvt_pk_bf16_f32 v130, v6, v7
    buffer_load_dwordx4 a[8:11], v15, s[8:11], s83 offen offset:2048 sc1
    v_cvt_pk_bf16_f32 v134, v8, v9
    v_xor_b32 v138, s91, v134
    v_cos_f32 v6, v4
    v_sin_f32 v8, v4
    v_add_f32 v4, v4, v5
    v_cos_f32 v7, v4
    v_sin_f32 v9, v4
    v_add_f32_e64 v4, v4, v5
    v_cvt_pk_bf16_f32 v131, v6, v7
    v_cvt_pk_bf16_f32 v135, v8, v9
    v_xor_b32_e64 v139, s91, v135
    v_mul_f32 v5, 0x3a000000, v11
    v_mul_f32 v10, 0x41500000, v5
    v_mul_f32 v4, 4.0, v3
    v_mul_f32 v4, v4, v5
    v_cos_f32_e64 v224, v4
    buffer_load_dwordx4 a[12:15], v15, s[8:11], s83 offen offset:3072 sc1
    s_add_u32 s83, s83, 0x1000
    v_sin_f32 v232, v4
    v_add_f32 v4, v4, v5
    v_cos_f32 v225, v4
    v_sin_f32 v233, v4
    v_add_f32 v4, v4, v5
    v_cos_f32 v226, v4
    v_sin_f32 v234, v4
    v_add_f32 v4, v4, v5
    v_cos_f32 v227, v4
    v_sin_f32 v235, v4
    v_add_f32 v4, v4, v10
    v_cos_f32 v228, v4
    v_sin_f32 v236, v4
    v_add_f32 v4, v4, v5
L_pg4248:
    s_cbranch_execz L_hopr4
    v_cos_f32 v229, v4
    v_sin_f32_e64 v237, v4
    buffer_load_dwordx4 a[16:19], v15, s[8:11], s83 offen offset:0 sc1
    v_add_f32 v4, v4, v5
    v_cos_f32 v230, v4
    v_sin_f32 v238, v4
    v_add_f32 v4, v4, v5
    v_cos_f32 v231, v4
    v_sin_f32 v239, v4
    v_bfe_i32 v11, v1, 0, 1
    v_and_b32 v11, s91, v11
    v_xor_b32 v140, v11, v128
    v_xor_b32 v141, v11, v129
    v_xor_b32 v142, v11, v130
    v_xor_b32 v143, v11, v131
    v_xor_b32 v144, v11, v132
    v_xor_b32 v145, v11, v133
    v_xor_b32 v146, v11, v134
    v_xor_b32_e64 v147, v11, v135
    buffer_load_dwordx4 a[20:23], v15, s[8:11], s83 offen offset:1024 sc1
    v_xor_b32 v148, v11, v136
    v_xor_b32 v149, v11, v137
    v_xor_b32 v150, v11, v138
    v_xor_b32 v151, v11, v139
    v_cvt_f32_u32_e64 v11, v1
    v_mul_f32 v5, 0x3d000000, v11
    v_mul_f32 v4, 4.0, v3
    v_mul_f32 v4, v4, v5
    v_cos_f32 v6, v4
    v_sin_f32 v8, v4
    v_add_f32 v4, v4, v5
    v_cos_f32 v7, v4
    v_sin_f32 v9, v4
    v_add_f32 v4, v4, v5
    v_cvt_pk_bf16_f32 v152, v6, v7
    v_cvt_pk_bf16_f32 v156, v8, v9
    buffer_load_dwordx4 a[24:27], v15, s[8:11], s83 offen offset:2048 sc1
    v_xor_b32 v160, s91, v156
    v_cos_f32 v6, v4
    v_sin_f32 v8, v4
    v_add_f32 v4, v4, v5
    v_cos_f32 v7, v4
    v_sin_f32 v9, v4
    v_add_f32_e64 v4, v4, v5
    v_cvt_pk_bf16_f32 v153, v6, v7
    v_cvt_pk_bf16_f32 v157, v8, v9
    v_xor_b32_e64 v161, s91, v157
    v_bfe_i32 v11, v1, 0, 1
    v_and_b32 v11, s91, v11
    v_xor_b32 v154, v11, v152
    v_xor_b32 v155, v11, v153
    v_xor_b32 v158, v11, v156
    v_xor_b32_e64 v159, v11, v157
    buffer_load_dwordx4 a[28:31], v15, s[8:11], s83 offen offset:3072 sc1
    s_add_u32 s83, s83, 0x1000
    v_xor_b32 v162, v11, v160
    v_xor_b32 v163, v11, v161
    v_mov_b32 v11, 0x80000000
    v_xor_b32 v164, v11, v152
    v_xor_b32 v165, v11, v153
    v_xor_b32 v166, v11, v154
    v_xor_b32 v167, v11, v155
    v_xor_b32 v168, v11, v156
    v_xor_b32 v169, v11, v157
    v_xor_b32 v170, v11, v158
    v_xor_b32 v171, v11, v159
    v_xor_b32 v172, v11, v160
    v_xor_b32 v173, v11, v161
    v_xor_b32 v174, v11, v162
    v_xor_b32 v175, v11, v163
    s_add_u32 s48, s92, 80
    v_mov_b32_e64 v10, 1
    v_mul_u32_u24 v11, 4096, v0
    v_lshl_add_u32 v11, s3, 28, v11
    s_mov_b64 exec, 0xff
    s_waitcnt vmcnt(8) lgkmcnt(0)
    s_barrier
    buffer_atomic_add v10, v11, s[8:11], s48 offen sc1
    s_mov_b64 exec, -1
    s_mov_b32 s91, 0x80008000
    s_lshr_b32 s48, s73, 6
    s_and_b32 s48, s48, 0x380
    v_xor_b32_e64 v116, s48, v12
    buffer_load_dwordx4 v[112:115], v116, s[8:11], s73 offen offset:0 sc1
    s_lshl_b32 s90, s3, 4
    v_cvt_f32_u32 v3, v2
    v_lshl_add_u32 v10, v2, 2, s90
    v_cvt_f32_u32 v10, v10
    v_add_u32 v11, 0, v1
    v_cvt_f32_u32_e64 v11, v11
    v_mul_f32 v5, 0x3a000000, v11
    v_mul_f32 v4, v10, v5
    v_cos_f32 v240, v4
    v_sin_f32 v248, v4
    v_add_f32 v4, v4, v5
    v_cos_f32_e64 v241, v4
    buffer_load_dwordx4 v[116:119], v116, s[8:11], s73 offen offset:1024 sc1
    v_sin_f32 v249, v4
    v_add_f32 v4, v4, v5
    v_cos_f32 v242, v4
    v_sin_f32 v250, v4
    v_add_f32 v4, v4, v5
    v_cos_f32 v243, v4
    v_sin_f32 v251, v4
    v_add_u32 v11, 16, v1
    v_cvt_f32_u32_e64 v11, v11
    v_mul_f32 v5, 0x3a000000, v11
    v_mul_f32 v4, v10, v5
    v_cos_f32 v244, v4
    v_sin_f32 v252, v4
    s_lshr_b32 s48, s74, 6
    s_and_b32 s48, s48, 0x380
    v_xor_b32_e64 v124, s48, v12
    buffer_load_dwordx4 v[120:123], v124, s[8:11], s74 offen offset:0 sc1
    v_add_f32 v4, v4, v5
    v_cos_f32 v245, v4
    v_sin_f32 v253, v4
    v_add_f32 v4, v4, v5
    v_cos_f32 v246, v4
    v_sin_f32 v254, v4
    v_add_f32 v4, v4, v5
    v_cos_f32 v247, v4
    v_sin_f32 v255, v4
    s_lshl_b32 s89, s3, 5
    s_and_b32 s89, s89, 32
    s_add_u32 s89, s89, 0
    v_and_b32_e64 v11, 12, v1
    buffer_load_dwordx4 v[124:127], v124, s[8:11], s74 offen offset:1024 sc1
    v_add3_u32 v11, v11, v1, s89
    v_cvt_f32_u32_e64 v11, v11
    v_mul_f32 v5, 0x3c800000, v11
    v_mul_f32 v10, 0x41500000, v5
    v_mul_f32 v4, 4.0, v3
    v_mul_f32 v4, v4, v5
    v_cos_f32 v6, v4
    v_sin_f32 v8, v4
    v_add_f32 v4, v4, v5
    v_cos_f32 v7, v4
    v_sin_f32 v9, v4
    v_add_f32 v4, v4, v5
    v_cvt_pk_bf16_f32 v178, v6, v7
    buffer_load_dwordx4 a[32:35], v15, s[8:11], s83 offen offset:0 sc1
    v_cvt_pk_bf16_f32 v176, v8, v9
    v_xor_b32 v180, s91, v176
    v_cos_f32 v6, v4
    v_sin_f32 v8, v4
    v_add_f32 v4, v4, v5
    v_cos_f32 v7, v4
    v_sin_f32 v9, v4
    v_add_f32_e64 v4, v4, v10
    v_cvt_pk_bf16_f32 v179, v6, v7
    v_cvt_pk_bf16_f32 v177, v8, v9
    v_xor_b32 v181, s91, v177
    v_cos_f32 v6, v4
    v_sin_f32_e64 v8, v4
    buffer_load_dwordx4 a[36:39], v15, s[8:11], s83 offen offset:1024 sc1
    v_add_f32 v4, v4, v5
    v_cos_f32 v7, v4
    v_sin_f32 v9, v4
    v_add_f32 v4, v4, v5
    v_cvt_pk_bf16_f32 v184, v6, v7
    v_cvt_pk_bf16_f32 v182, v8, v9
    v_xor_b32 v186, s91, v182
    v_cos_f32 v6, v4
    v_sin_f32 v8, v4
    v_add_f32 v4, v4, v5
    v_cos_f32 v7, v4
    v_sin_f32 v9, v4
    v_add_f32_e64 v4, v4, v10
    buffer_load_dwordx4 a[40:43], v15, s[8:11], s83 offen offset:2048 sc1
    v_cvt_pk_bf16_f32 v185, v6, v7
    v_cvt_pk_bf16_f32 v183, v8, v9
    v_xor_b32_e64 v187, s91, v183
    v_bfe_i32 v11, v1, 0, 1
    v_and_b32 v11, s91, v11
    v_xor_b32 v188, v11, v176
    v_xor_b32 v189, v11, v177
    v_xor_b32 v190, v11, v178
    v_xor_b32 v191, v11, v179
    v_xor_b32 v192, v11, v180
    v_xor_b32 v193, v11, v181
    v_xor_b32 v194, v11, v182
    v_xor_b32_e64 v195, v11, v183
    buffer_load_dwordx4 a[44:47], v15, s[8:11], s83 offen offset:3072 sc1
    s_add_u32 s83, s83, 0x1000
    v_xor_b32 v196, v11, v184
    v_xor_b32 v197, v11, v185
    v_xor_b32 v198, v11, v186
    v_xor_b32 v199, v11, v187
    s_lshl_b32 s89, s3, 5
    s_and_b32 s89, s89, 32
    s_add_u32 s89, s89, 4
    v_and_b32 v11, 12, v1
    v_add3_u32 v11, v11, v1, s89
    v_cvt_f32_u32_e64 v11, v11
    v_mul_f32 v5, 0x3c800000, v11
    v_mul_f32 v10, 0x41500000, v5
    v_mul_f32_e64 v4, 4.0, v3
    buffer_load_dwordx4 a[48:51], v15, s[8:11], s83 offen offset:0 sc1
    v_mul_f32 v4, v4, v5
    v_cos_f32 v6, v4
    v_sin_f32 v8, v4
    v_add_f32 v4, v4, v5
    v_cos_f32 v7, v4
    v_sin_f32 v9, v4
    v_add_f32_e64 v4, v4, v5
    v_cvt_pk_bf16_f32 v202, v6, v7
    v_cvt_pk_bf16_f32 v200, v8, v9
    v_xor_b32 v204, s91, v200
    v_cos_f32 v6, v4
    v_sin_f32 v8, v4
    v_add_f32 v4, v4, v5
    buffer_load_dwordx4 a[52:55], v15, s[8:11], s83 offen offset:1024 sc1
    v_cos_f32 v7, v4
    v_sin_f32 v9, v4
    v_add_f32_e64 v4, v4, v10
    v_cvt_pk_bf16_f32 v203, v6, v7
    v_cvt_pk_bf16_f32 v201, v8, v9
    v_xor_b32 v205, s91, v201
    v_cos_f32 v6, v4
    v_sin_f32 v8, v4
    v_add_f32 v4, v4, v5
    v_cos_f32 v7, v4
    v_sin_f32 v9, v4
    v_add_f32_e64 v4, v4, v5
    v_cvt_pk_bf16_f32 v208, v6, v7
    buffer_load_dwordx4 a[56:59], v15, s[8:11], s83 offen offset:2048 sc1
    v_cvt_pk_bf16_f32 v206, v8, v9
    v_xor_b32 v210, s91, v206
    v_cos_f32 v6, v4
    v_sin_f32 v8, v4
    v_add_f32 v4, v4, v5
    v_cos_f32 v7, v4
    v_sin_f32 v9, v4
    v_add_f32_e64 v4, v4, v10
    v_cvt_pk_bf16_f32 v209, v6, v7
    v_cvt_pk_bf16_f32 v207, v8, v9
    v_xor_b32_e64 v211, s91, v207
    v_bfe_i32 v11, v1, 0, 1
    v_and_b32_e64 v11, s91, v11
    buffer_load_dwordx4 a[60:63], v15, s[8:11], s83 offen offset:3072 sc1
    s_add_u32 s83, s83, 0x1000
    v_xor_b32 v212, v11, v200
    v_xor_b32 v213, v11, v201
    v_xor_b32 v214, v11, v202
    v_xor_b32 v215, v11, v203
    v_xor_b32 v216, v11, v204
    v_xor_b32 v217, v11, v205
    v_xor_b32 v218, v11, v206
    v_xor_b32 v219, v11, v207
    v_xor_b32 v220, v11, v208
    v_xor_b32 v221, v11, v209
    v_xor_b32 v222, v11, v210
    v_xor_b32 v223, v11, v211
    v_lshlrev_b32 v12, 4, v0
    v_lshlrev_b32 v13, 3, v0
    s_cmp_ge_u32 s6, 128
    s_cselect_b32 s52, 0xff380000, 0
    s_cselect_b32 s53, 0x310000, 0
    s_lshl_b32 s48, s6, 2
    s_add_u32 s48, s48, s3
    s_lshl_b32 s48, s48, 12
    s_add_u32 s53, s53, s48
    s_add_u32 s53, s53, 16777216
    s_and_b32 s48, s6, 0xf8
    s_and_b32 s49, s6, 3
    s_lshl_b32 s49, s49, 1
    s_add_u32 s48, s48, s49
    s_lshl_b32 s48, s48, 2
    s_and_b32 s49, s3, 2
    s_add_u32 s49, s49, s3
    s_add_u32 s48, s48, s49
    s_lshl_b32 s48, s48, 12
    s_and_b32 s49, s6, 4
    s_lshl_b32 s49, s49, 11
    s_add_u32 s48, s48, s49
    s_add_u32 s52, s52, s48
    s_add_u32 s52, s52, 12582912
    s_lshl_b32 s54, s3, 11
    s_add_u32 s54, s54, s49
    s_add_u32 s54, s54, 147456
    s_cmp_eq_u32 s3, 1
    s_cbranch_scc1 L_wait_13p
    s_mov_b64 exec, 0
    s_cmp_eq_u32 s3, 0
    s_cbranch_scc1 L_pg4927
    s_cmp_eq_u32 s3, 2
    s_cbranch_scc1 L_hopr5
    s_branch L_hopr5
L_wait_13p:
    s_add_u32 s48, s93, 80
    v_mul_u32_u24 v11, 128, v0
    s_mov_b32 s7, 0x20000
    s_mov_b32 exec_lo, 0xffffffff
    s_mov_b32 exec_hi, 0
L_poll_14:
    buffer_load_dword v10, v11, s[8:11], s48 offen sc1
    s_sub_u32 s7, s7, 1
    s_cbranch_scc1 L_polld_15
    s_waitcnt vmcnt(0)
    v_cmp_gt_u32 vcc, 8, v10
    s_nop 0
    s_cbranch_vccnz L_poll_14
L_polld_15:
L_hopr5:
    s_mov_b64 exec, -1
L_wait_13:
    s_barrier
    buffer_load_dwordx2 v[16:17], v13, s[8:11], s54 offen offset:0 sc1
    buffer_load_dwordx2 v[18:19], v13, s[8:11], s54 offen offset:512 sc1
    buffer_load_dwordx2 v[20:21], v13, s[8:11], s54 offen offset:1024 sc1
    buffer_load_dwordx2 v[22:23], v13, s[8:11], s54 offen offset:1536 sc1
    buffer_load_dwordx4 v[96:99], v12, s[8:11], s52 offen offset:0 sc1
    buffer_load_dwordx4 v[100:103], v12, s[8:11], s52 offen offset:1024 sc1
    buffer_load_dwordx4 v[104:107], v12, s[8:11], s52 offen offset:2048 sc1
    buffer_load_dwordx4 v[108:111], v12, s[8:11], s52 offen offset:3072 sc1
    s_lshl_b32 s48, s3, 11
    v_add_u32 v13, s48, v12
    s_lshl_b32 s48, s3, 10
    v_add_u32 v3, s48, v12
    s_lshr_b32 s48, s3, 1
    s_lshl_b32 s48, s48, 12
    v_add_u32_e64 v11, s48, v12
    s_mov_b32 s56, 0x3acccccd
    v_mov_b32 v4, 0x3727c5ac
    s_mov_b32 s57, 0xffff0000
    s_waitcnt vmcnt(7)
    v_pk_fma_f32 v[16:17], v[16:17], s[56:57], v[4:5] op_sel_hi:[1,0,0]
    s_waitcnt vmcnt(6)
    v_pk_fma_f32 v[18:19], v[18:19], s[56:57], v[4:5] op_sel_hi:[1,0,0]
    s_waitcnt vmcnt(5)
    v_pk_fma_f32 v[20:21], v[20:21], s[56:57], v[4:5] op_sel_hi:[1,0,0]
    s_waitcnt vmcnt(4)
    v_pk_fma_f32 v[22:23], v[22:23], s[56:57], v[4:5] op_sel_hi:[1,0,0]
    v_rsq_f32 v16, v16
    v_rsq_f32 v17, v17
    v_rsq_f32 v18, v18
    v_rsq_f32 v19, v19
    v_rsq_f32 v20, v20
    v_rsq_f32 v21, v21
    v_rsq_f32 v22, v22
    v_rsq_f32 v23, v23
    s_waitcnt vmcnt(3)
    v_lshlrev_b32 v40, 16, v96
    v_lshlrev_b32 v41, 16, v98
    s_waitcnt vmcnt(2)
    v_lshlrev_b32 v42, 16, v100
    v_lshlrev_b32 v43, 16, v102
    s_waitcnt vmcnt(1)
    v_lshlrev_b32 v44, 16, v104
    v_lshlrev_b32 v45, 16, v106
    s_waitcnt vmcnt(0)
    v_lshlrev_b32 v46, 16, v108
    v_lshlrev_b32 v47, 16, v110
    v_pk_mul_f32 v[40:41], v[40:41], v[16:17]
    v_pk_mul_f32 v[42:43], v[42:43], v[18:19]
    v_pk_mul_f32 v[44:45], v[44:45], v[20:21]
    v_pk_mul_f32 v[46:47], v[46:47], v[22:23]
    v_cvt_pk_bf16_f32 v24, v40, v41
    v_cvt_pk_bf16_f32 v25, v42, v43
    v_cvt_pk_bf16_f32 v26, v44, v45
    v_cvt_pk_bf16_f32 v27, v46, v47
    v_and_b32 v24, s75, v24
    v_and_b32 v25, s75, v25
    v_and_b32 v26, s75, v26
    v_and_b32 v27, s75, v27
    ds_write_b128 v13, v[24:27] offset:0
    v_and_b32 v48, s57, v96
    v_and_b32 v49, s57, v98
    v_and_b32 v50, s57, v100
    v_and_b32 v51, s57, v102
    v_and_b32 v52, s57, v104
    v_and_b32 v53, s57, v106
    v_and_b32 v54, s57, v108
    v_and_b32 v55, s57, v110
    v_pk_mul_f32 v[48:49], v[48:49], v[16:17]
    v_pk_mul_f32 v[50:51], v[50:51], v[18:19]
    v_pk_mul_f32 v[52:53], v[52:53], v[20:21]
    v_pk_mul_f32 v[54:55], v[54:55], v[22:23]
    v_cvt_pk_bf16_f32 v28, v48, v49
    v_cvt_pk_bf16_f32 v29, v50, v51
    v_cvt_pk_bf16_f32 v30, v52, v53
    v_cvt_pk_bf16_f32 v31, v54, v55
    v_xor_b32 v28, s76, v28
    v_xor_b32 v29, s76, v29
    v_xor_b32 v30, s76, v30
    v_xor_b32 v31, s76, v31
    ds_write_b128 v13, v[28:31] offset:1024
    v_lshlrev_b32 v76, 16, v97
    v_lshlrev_b32 v77, 16, v99
    v_lshlrev_b32 v78, 16, v101
    v_lshlrev_b32 v79, 16, v103
    v_lshlrev_b32 v80, 16, v105
    v_lshlrev_b32 v81, 16, v107
    v_lshlrev_b32 v82, 16, v109
    v_lshlrev_b32 v83, 16, v111
    v_pk_mul_f32 v[76:77], v[76:77], v[16:17]
    v_pk_mul_f32 v[78:79], v[78:79], v[18:19]
    v_pk_mul_f32 v[80:81], v[80:81], v[20:21]
    v_pk_mul_f32 v[82:83], v[82:83], v[22:23]
    v_cvt_pk_bf16_f32 v60, v76, v77
    v_cvt_pk_bf16_f32 v61, v78, v79
    v_cvt_pk_bf16_f32 v62, v80, v81
    v_cvt_pk_bf16_f32 v63, v82, v83
    ds_write_b128 v13, v[60:63] offset:8192
    s_waitcnt lgkmcnt(1)
    s_barrier
    ds_read_b128 v[24:27], v12 offset:0
    ds_read_b128 v[28:31], v12 offset:1024
    ds_read_b128 v[32:35], v12 offset:2048
    ds_read_b128 v[36:39], v12 offset:3072
    v_and_b32 v84, s57, v97
    v_and_b32 v85, s57, v99
    v_and_b32 v86, s57, v101
    v_and_b32 v87, s57, v103
    v_and_b32 v88, s57, v105
    v_and_b32 v89, s57, v107
    v_and_b32 v90, s57, v109
    v_and_b32 v91, s57, v111
    v_pk_mul_f32 v[84:85], v[84:85], v[16:17]
    v_pk_mul_f32 v[86:87], v[86:87], v[18:19]
    v_pk_mul_f32 v[88:89], v[88:89], v[20:21]
    v_pk_mul_f32 v[90:91], v[90:91], v[22:23]
    v_cvt_pk_bf16_f32 v64, v84, v85
    v_cvt_pk_bf16_f32 v65, v86, v87
    v_cvt_pk_bf16_f32 v66, v88, v89
    v_cvt_pk_bf16_f32 v67, v90, v91
    v_xor_b32 v64, s78, v64
    v_xor_b32 v65, s78, v65
    v_xor_b32 v66, s78, v66
    v_xor_b32 v67, s78, v67
    ds_write_b128 v13, v[64:67] offset:9216
    ds_read_b128 v[60:63], v12 offset:4096
    ds_read_b128 v[64:67], v12 offset:5120
    ds_read_b128 v[68:71], v12 offset:6144
    ds_read_b128 v[72:75], v12 offset:7168
    s_waitcnt lgkmcnt(8)
    v_mfma_f32_16x16x32_bf16 v[40:43], v[24:27], v[128:131], 0
    buffer_load_dwordx4 a[64:67], v15, s[8:11], s83 offen offset:0 sc1
    v_mfma_f32_16x16x32_bf16 v[48:51], v[24:27], v[136:139], 0
    s_waitcnt lgkmcnt(7)
    v_mfma_f32_16x16x32_bf16 v[40:43], v[28:31], v[132:135], v[40:43]
    v_mfma_f32_16x16x32_bf16 v[48:51], v[28:31], v[128:131], v[48:51]
    s_waitcnt lgkmcnt(6)
    v_mfma_f32_16x16x32_bf16 v[40:43], v[32:35], v[140:143], v[40:43]
    v_mfma_f32_16x16x32_bf16 v[48:51], v[32:35], v[148:151], v[48:51]
    s_waitcnt lgkmcnt(5)
    v_mfma_f32_16x16x32_bf16 v[40:43], v[36:39], v[144:147], v[40:43]
    v_mfma_f32_16x16x32_bf16 v[48:51], v[36:39], v[140:143], v[48:51]
    s_waitcnt lgkmcnt(3)
    v_mfma_f32_16x16x32_bf16 v[44:47], v[60:63], v[128:131], 0
    s_waitcnt lgkmcnt(3)
    s_barrier
    v_mfma_f32_16x16x32_bf16 v[52:55], v[60:63], v[136:139], 0
    ds_read_b128 v[24:27], v12 offset:8192
    s_waitcnt lgkmcnt(3)
    v_mfma_f32_16x16x32_bf16 v[44:47], v[64:67], v[132:135], v[44:47]
    ds_read_b128 v[28:31], v12 offset:9216
    buffer_load_dwordx4 a[68:71], v15, s[8:11], s83 offen offset:1024 sc1
    v_mfma_f32_16x16x32_bf16 v[52:55], v[64:67], v[128:131], v[52:55]
    ds_read_b128 v[32:35], v12 offset:10240
    s_waitcnt lgkmcnt(4)
    v_mfma_f32_16x16x32_bf16 v[44:47], v[68:71], v[140:143], v[44:47]
    ds_read_b128 v[36:39], v12 offset:11264
    v_mfma_f32_16x16x32_bf16 v[52:55], v[68:71], v[148:151], v[52:55]
    s_waitcnt lgkmcnt(4)
    v_mfma_f32_16x16x32_bf16 v[44:47], v[72:75], v[144:147], v[44:47]
    v_mfma_f32_16x16x32_bf16 v[52:55], v[72:75], v[140:143], v[52:55]
    ds_read_b128 v[60:63], v12 offset:12288
    ds_read_b128 v[64:67], v12 offset:13312
    ds_read_b128 v[68:71], v12 offset:14336
    ds_read_b128 v[72:75], v12 offset:15360
    s_waitcnt lgkmcnt(7)
    v_mfma_f32_16x16x32_bf16 v[76:79], v[24:27], v[128:131], 0
    v_mfma_f32_16x16x32_bf16 v[84:87], v[24:27], v[136:139], 0
    v_mul_f32 v56, v40, v224
    buffer_load_dwordx4 a[72:75], v15, s[8:11], s83 offen offset:2048 sc1
    s_waitcnt lgkmcnt(6)
    v_mfma_f32_16x16x32_bf16 v[76:79], v[28:31], v[132:135], v[76:79]
    v_mul_f32 v58, v48, v224
    v_fma_f32 v56, v48, v232, v56
    v_mfma_f32_16x16x32_bf16 v[84:87], v[28:31], v[128:131], v[84:87]
    v_fma_f32 v58, -v40, v232, v58
    v_mul_f32 v57, v41, v225
    s_waitcnt lgkmcnt(5)
    v_mfma_f32_16x16x32_bf16 v[76:79], v[32:35], v[140:143], v[76:79]
    v_mul_f32_e64 v59, v49, v225
    v_fma_f32 v57, v49, v233, v57
    v_mfma_f32_16x16x32_bf16 v[84:87], v[32:35], v[148:151], v[84:87]
    v_fma_f32 v59, -v41, v233, v59
    v_cvt_pk_bf16_f32 v24, v56, v57
    v_cvt_pk_bf16_f32 v28, v58, v59
    s_waitcnt lgkmcnt(4)
    v_mfma_f32_16x16x32_bf16 v[76:79], v[36:39], v[144:147], v[76:79]
    buffer_load_dwordx4 a[76:79], v15, s[8:11], s83 offen offset:3072 sc1
    s_add_u32 s83, s83, 0x1000
    v_mul_f32 v56, v42, v226
    v_mul_f32_e64 v58, v50, v226
    v_mfma_f32_16x16x32_bf16 v[84:87], v[36:39], v[140:143], v[84:87]
    v_fma_f32 v56, v50, v234, v56
    v_fma_f32 v58, -v42, v234, v58
    s_waitcnt lgkmcnt(3)
    v_mfma_f32_16x16x32_bf16 v[80:83], v[60:63], v[128:131], 0
    v_mul_f32 v57, v43, v227
    v_mul_f32_e64 v59, v51, v227
    v_fma_f32 v57, v51, v235, v57
    v_mfma_f32_16x16x32_bf16 v[88:91], v[60:63], v[136:139], 0
    v_fma_f32 v59, -v43, v235, v59
    v_cvt_pk_bf16_f32 v25, v56, v57
    s_waitcnt lgkmcnt(2)
    v_mfma_f32_16x16x32_bf16 v[80:83], v[64:67], v[132:135], v[80:83]
    v_cvt_pk_bf16_f32 v29, v58, v59
    buffer_load_dwordx4 a[80:83], v15, s[8:11], s83 offen offset:0 sc1
    v_mul_f32 v56, v44, v228
    v_mfma_f32_16x16x32_bf16 v[88:91], v[64:67], v[128:131], v[88:91]
    v_mul_f32_e64 v58, v52, v228
    v_fma_f32 v56, v52, v236, v56
    s_waitcnt lgkmcnt(1)
    v_mfma_f32_16x16x32_bf16 v[80:83], v[68:71], v[140:143], v[80:83]
    v_fma_f32 v58, -v44, v236, v58
    v_mul_f32 v57, v45, v229
    v_mul_f32_e64 v59, v53, v229
    v_mfma_f32_16x16x32_bf16 v[88:91], v[68:71], v[148:151], v[88:91]
    v_fma_f32 v57, v53, v237, v57
    v_fma_f32 v59, -v45, v237, v59
    s_waitcnt lgkmcnt(0)
    v_mfma_f32_16x16x32_bf16 v[80:83], v[72:75], v[144:147], v[80:83]
    v_cvt_pk_bf16_f32 v26, v56, v57
    v_cvt_pk_bf16_f32 v30, v58, v59
    buffer_load_dwordx4 a[84:87], v15, s[8:11], s83 offen offset:1024 sc1
    v_mfma_f32_16x16x32_bf16 v[88:91], v[72:75], v[140:143], v[88:91]
    v_mul_f32 v56, v46, v230
    v_mul_f32_e64 v58, v54, v230
    v_fma_f32 v56, v54, v238, v56
    v_fma_f32 v58, -v46, v238, v58
    v_mul_f32 v57, v47, v231
    v_mul_f32 v59, v55, v231
    v_fma_f32 v57, v55, v239, v57
    v_fma_f32 v59, -v47, v239, v59
    v_cvt_pk_bf16_f32 v27, v56, v57
    v_cvt_pk_bf16_f32 v31, v58, v59
    v_mul_f32_e64 v92, v76, v224
    v_mfma_f32_16x16x32_bf16 v[40:43], v[152:155], v[24:27], 0
    v_mul_f32_e64 v94, v84, v224
    buffer_load_dwordx4 a[88:91], v15, s[8:11], s83 offen offset:2048 sc1
    v_fma_f32 v92, v84, v232, v92
    v_fma_f32 v94, -v76, v232, v94
    v_mfma_f32_16x16x32_bf16 v[48:51], v[160:163], v[24:27], 0
    v_mul_f32 v93, v77, v225
    v_mul_f32 v95, v85, v225
    v_fma_f32 v93, v85, v233, v93
    v_mfma_f32_16x16x32_bf16 v[40:43], v[156:159], v[28:31], v[40:43]
    v_fma_f32 v95, -v77, v233, v95
    v_cvt_pk_bf16_f32 v60, v92, v93
    v_cvt_pk_bf16_f32 v64, v94, v95
    v_mfma_f32_16x16x32_bf16 v[48:51], v[152:155], v[28:31], v[48:51]
    v_mul_f32 v92, v78, v226
    v_mul_f32 v94, v86, v226
    v_fma_f32 v92, v86, v234, v92
    buffer_load_dwordx4 a[92:95], v15, s[8:11], s83 offen offset:3072 sc1
    s_add_u32 s83, s83, 0x1000
    v_mfma_f32_16x16x32_bf16 v[44:47], v[164:167], v[24:27], 0
    v_fma_f32 v94, -v78, v234, v94
    v_mul_f32 v93, v79, v227
    v_mul_f32 v95, v87, v227
    v_mfma_f32_16x16x32_bf16 v[52:55], v[172:175], v[24:27], 0
    v_fma_f32 v93, v87, v235, v93
    v_fma_f32 v95, -v79, v235, v95
    v_cvt_pk_bf16_f32 v61, v92, v93
    v_mfma_f32_16x16x32_bf16 v[44:47], v[168:171], v[28:31], v[44:47]
    v_cvt_pk_bf16_f32 v65, v94, v95
    v_mul_f32 v92, v80, v228
    v_mul_f32 v94, v88, v228
    v_mfma_f32_16x16x32_bf16 v[52:55], v[164:167], v[28:31], v[52:55]
    v_fma_f32 v92, v88, v236, v92
    buffer_load_dwordx4 a[96:99], v15, s[8:11], s83 offen offset:0 sc1
    v_fma_f32 v94, -v80, v236, v94
    v_mul_f32 v93, v81, v229
    v_mul_f32 v95, v89, v229
    v_fma_f32 v93, v89, v237, v93
    v_fma_f32 v95, -v81, v237, v95
    v_cvt_pk_bf16_f32 v62, v92, v93
    v_cvt_pk_bf16_f32 v66, v94, v95
    v_pk_mul_f32 v[92:93], v[82:83], v[230:231]
    v_pk_mul_f32 v[94:95], v[90:91], v[230:231]
    v_pk_fma_f32 v[92:93], v[90:91], v[238:239], v[92:93]
    v_pk_fma_f32 v[94:95], v[82:83], v[238:239], v[94:95] neg_lo:[1,0,0] neg_hi:[1,0,0]
    v_cvt_pk_bf16_f32 v63, v92, v93
    v_cvt_pk_bf16_f32 v67, v94, v95
    v_lshlrev_b32_e64 v32, 16, v112
    buffer_load_dwordx4 a[100:103], v15, s[8:11], s83 offen offset:1024 sc1
    v_mfma_f32_16x16x32_bf16 v[76:79], v[152:155], v[60:63], 0
    v_and_b32 v34, s57, v112
    v_mul_f32 v56, v40, v32
    v_mul_f32_e64 v58, v48, v32
    v_mfma_f32_16x16x32_bf16 v[84:87], v[160:163], v[60:63], 0
    v_fma_f32 v56, -v48, v34, v56
    v_fma_f32 v58, v40, v34, v58
    v_lshlrev_b32_e64 v33, 16, v113
    v_mfma_f32_16x16x32_bf16 v[76:79], v[156:159], v[64:67], v[76:79]
    v_and_b32 v35, s57, v113
    v_mul_f32 v57, v41, v33
    v_mul_f32_e64 v59, v49, v33
    v_mfma_f32_16x16x32_bf16 v[84:87], v[152:155], v[64:67], v[84:87]
    v_fma_f32 v57, -v49, v35, v57
    v_fma_f32 v59, v41, v35, v59
    buffer_load_dwordx4 a[104:107], v15, s[8:11], s83 offen offset:2048 sc1
    v_cvt_pk_bf16_f32 v24, v56, v57
    v_mfma_f32_16x16x32_bf16 v[80:83], v[164:167], v[60:63], 0
    v_cvt_pk_bf16_f32 v28, v58, v59
    v_lshlrev_b32 v32, 16, v114
    v_and_b32 v34, s57, v114
    v_mfma_f32_16x16x32_bf16 v[88:91], v[172:175], v[60:63], 0
    v_mul_f32 v56, v42, v32
    v_mul_f32 v58, v50, v32
    v_fma_f32 v56, -v50, v34, v56
    v_mfma_f32_16x16x32_bf16 v[80:83], v[168:171], v[64:67], v[80:83]
    v_fma_f32 v58, v42, v34, v58
    v_lshlrev_b32 v33, 16, v115
    v_and_b32 v35, s57, v115
    v_mfma_f32_16x16x32_bf16 v[88:91], v[164:167], v[64:67], v[88:91]
    buffer_load_dwordx4 a[108:111], v15, s[8:11], s83 offen offset:3072 sc1
    s_add_u32 s83, s83, 0x1000
    v_mul_f32 v57, v43, v33
    v_mul_f32 v59, v51, v33
    v_fma_f32 v57, -v51, v35, v57
    v_fma_f32 v59, v43, v35, v59
    v_cvt_pk_bf16_f32 v25, v56, v57
    v_cvt_pk_bf16_f32 v29, v58, v59
    v_lshlrev_b32 v32, 16, v116
    v_and_b32 v34, s57, v116
    v_lshlrev_b32 v33, 16, v117
    v_and_b32 v35, s57, v117
    v_pk_mul_f32 v[56:57], v[44:45], v[32:33]
    v_pk_mul_f32 v[58:59], v[52:53], v[32:33]
    v_pk_fma_f32 v[56:57], v[52:53], v[34:35], v[56:57] neg_lo:[1,0,0] neg_hi:[1,0,0]
    v_pk_fma_f32 v[58:59], v[44:45], v[34:35], v[58:59]
    buffer_load_dwordx4 a[112:115], v15, s[8:11], s83 offen offset:0 sc1
    v_cvt_pk_bf16_f32 v26, v56, v57
    v_cvt_pk_bf16_f32 v30, v58, v59
    v_lshlrev_b32 v32, 16, v118
    v_and_b32 v34, s57, v118
    v_lshlrev_b32 v33, 16, v119
    v_and_b32 v35, s57, v119
    v_pk_mul_f32 v[56:57], v[46:47], v[32:33]
    v_pk_mul_f32 v[58:59], v[54:55], v[32:33]
    v_pk_fma_f32 v[56:57], v[54:55], v[34:35], v[56:57] neg_lo:[1,0,0] neg_hi:[1,0,0]
    v_pk_fma_f32 v[58:59], v[46:47], v[34:35], v[58:59]
    v_cvt_pk_bf16_f32 v27, v56, v57
    v_cvt_pk_bf16_f32 v31, v58, v59
    v_lshlrev_b32_e64 v68, 16, v120
    v_mfma_f32_16x16x32_bf16 v[40:43], v[24:27], v[152:155], 0
    buffer_load_dwordx4 a[116:119], v15, s[8:11], s83 offen offset:1024 sc1
    v_and_b32 v70, s57, v120
    v_mul_f32 v92, v76, v68
    v_mul_f32_e64 v94, v84, v68
    v_mfma_f32_16x16x32_bf16 v[48:51], v[24:27], v[156:159], 0
    v_fma_f32 v92, -v84, v70, v92
    v_fma_f32 v94, v76, v70, v94
    v_lshlrev_b32_e64 v69, 16, v121
    v_mfma_f32_16x16x32_bf16 v[40:43], v[28:31], v[160:163], v[40:43]
    v_and_b32 v71, s57, v121
    v_mul_f32 v93, v77, v69
    v_mul_f32_e64 v95, v85, v69
    v_mfma_f32_16x16x32_bf16 v[48:51], v[28:31], v[152:155], v[48:51]
    v_fma_f32 v93, -v85, v71, v93
    v_fma_f32 v95, v77, v71, v95
    buffer_load_dwordx4 a[120:123], v15, s[8:11], s83 offen offset:2048 sc1
    v_cvt_pk_bf16_f32 v60, v92, v93
    v_mfma_f32_16x16x32_bf16 v[44:47], v[24:27], v[164:167], 0
    v_cvt_pk_bf16_f32 v64, v94, v95
    v_lshlrev_b32 v68, 16, v122
    v_and_b32 v70, s57, v122
    v_mfma_f32_16x16x32_bf16 v[52:55], v[24:27], v[168:171], 0
    v_mul_f32 v92, v78, v68
    v_mul_f32 v94, v86, v68
    v_fma_f32 v92, -v86, v70, v92
    v_mfma_f32_16x16x32_bf16 v[44:47], v[28:31], v[172:175], v[44:47]
L_pg4927:
    s_cbranch_execz L_hopr5
    v_fma_f32 v94, v78, v70, v94
    v_lshlrev_b32 v69, 16, v123
    v_and_b32_e64 v71, s57, v123
    v_mfma_f32_16x16x32_bf16 v[52:55], v[28:31], v[164:167], v[52:55]
    buffer_load_dwordx4 a[124:127], v15, s[8:11], s83 offen offset:3072 sc1
    s_add_u32 s83, s83, 0x1000
    v_mul_f32 v93, v79, v69
    v_mul_f32 v95, v87, v69
    v_fma_f32 v93, -v87, v71, v93
    v_fma_f32 v95, v79, v71, v95
    v_cvt_pk_bf16_f32 v61, v92, v93
    v_cvt_pk_bf16_f32 v65, v94, v95
    v_lshlrev_b32 v68, 16, v124
    v_and_b32 v70, s57, v124
    v_lshlrev_b32 v69, 16, v125
    v_and_b32 v71, s57, v125
    v_pk_mul_f32 v[92:93], v[80:81], v[68:69]
    v_pk_mul_f32 v[94:95], v[88:89], v[68:69]
    v_pk_fma_f32 v[92:93], v[88:89], v[70:71], v[92:93] neg_lo:[1,0,0] neg_hi:[1,0,0]
    v_pk_fma_f32 v[94:95], v[80:81], v[70:71], v[94:95]
    buffer_load_dwordx4 a[128:131], v15, s[8:11], s83 offen offset:0 sc1
    v_cvt_pk_bf16_f32 v62, v92, v93
    v_cvt_pk_bf16_f32 v66, v94, v95
    v_lshlrev_b32 v68, 16, v126
    v_and_b32 v70, s57, v126
    v_lshlrev_b32 v69, 16, v127
    v_and_b32 v71, s57, v127
    v_pk_mul_f32 v[92:93], v[82:83], v[68:69]
    v_pk_mul_f32 v[94:95], v[90:91], v[68:69]
    v_pk_fma_f32 v[92:93], v[90:91], v[70:71], v[92:93] neg_lo:[1,0,0] neg_hi:[1,0,0]
    v_pk_fma_f32 v[94:95], v[82:83], v[70:71], v[94:95]
    v_cvt_pk_bf16_f32 v63, v92, v93
    v_cvt_pk_bf16_f32 v67, v94, v95
    v_mul_f32_e64 v56, v40, v240
    v_mfma_f32_16x16x32_bf16 v[76:79], v[60:63], v[152:155], 0
    buffer_load_dwordx4 a[132:135], v15, s[8:11], s83 offen offset:1024 sc1
    v_mul_f32_e64 v58, v48, v240
    v_fma_f32 v56, -v48, v248, v56
    v_fma_f32 v58, v40, v248, v58
    v_mfma_f32_16x16x32_bf16 v[84:87], v[60:63], v[156:159], 0
    v_mul_f32 v57, v41, v241
    v_mul_f32 v59, v49, v241
    v_fma_f32 v57, -v49, v249, v57
    v_mfma_f32_16x16x32_bf16 v[76:79], v[64:67], v[160:163], v[76:79]
    v_fma_f32 v59, v41, v249, v59
    v_cvt_pk_bf16_f32 v24, v56, v57
    v_cvt_pk_bf16_f32 v26, v58, v59
    v_mfma_f32_16x16x32_bf16 v[84:87], v[64:67], v[152:155], v[84:87]
    v_mul_f32 v56, v42, v242
    v_mul_f32 v58, v50, v242
    buffer_load_dwordx4 a[136:139], v15, s[8:11], s83 offen offset:2048 sc1
    v_fma_f32 v56, -v50, v250, v56
    v_mfma_f32_16x16x32_bf16 v[80:83], v[60:63], v[164:167], 0
    v_fma_f32 v58, v42, v250, v58
    v_mul_f32 v57, v43, v243
    v_mul_f32 v59, v51, v243
    v_mfma_f32_16x16x32_bf16 v[88:91], v[60:63], v[168:171], 0
    v_fma_f32 v57, -v51, v251, v57
    v_fma_f32 v59, v43, v251, v59
    v_cvt_pk_bf16_f32 v25, v56, v57
    v_mfma_f32_16x16x32_bf16 v[80:83], v[64:67], v[172:175], v[80:83]
    v_cvt_pk_bf16_f32 v27, v58, v59
    v_mul_f32 v56, v44, v244
    v_mul_f32 v58, v52, v244
    v_mfma_f32_16x16x32_bf16 v[88:91], v[64:67], v[164:167], v[88:91]
    v_fma_f32 v56, -v52, v252, v56
    buffer_load_dwordx4 a[140:143], v15, s[8:11], s83 offen offset:3072 sc1
    s_add_u32 s83, s83, 0x1000
    v_fma_f32 v58, v44, v252, v58
    v_mul_f32 v57, v45, v245
    v_mul_f32 v59, v53, v245
    v_fma_f32 v57, -v53, v253, v57
    v_fma_f32 v59, v45, v253, v59
    v_cvt_pk_bf16_f32 v28, v56, v57
    v_cvt_pk_bf16_f32 v30, v58, v59
    v_pk_mul_f32 v[56:57], v[46:47], v[246:247]
    v_pk_mul_f32 v[58:59], v[54:55], v[246:247]
    v_pk_fma_f32 v[56:57], v[54:55], v[254:255], v[56:57] neg_lo:[1,0,0] neg_hi:[1,0,0]
    v_pk_fma_f32 v[58:59], v[46:47], v[254:255], v[58:59]
    v_cvt_pk_bf16_f32 v29, v56, v57
    v_cvt_pk_bf16_f32 v31, v58, v59
    ds_write_b128 v3, v[24:27] offset:16384
    buffer_load_dwordx4 a[144:147], v15, s[8:11], s83 offen offset:0 sc1
    ds_write_b128 v3, v[28:31] offset:20480
    v_pk_mul_f32 v[92:93], v[76:77], v[240:241]
    v_pk_mul_f32 v[94:95], v[84:85], v[240:241]
    v_pk_fma_f32 v[92:93], v[84:85], v[248:249], v[92:93] neg_lo:[1,0,0] neg_hi:[1,0,0]
    v_pk_fma_f32 v[94:95], v[76:77], v[248:249], v[94:95]
    v_cvt_pk_bf16_f32 v60, v92, v93
    v_cvt_pk_bf16_f32 v62, v94, v95
    v_pk_mul_f32 v[92:93], v[78:79], v[242:243]
    v_pk_mul_f32 v[94:95], v[86:87], v[242:243]
    s_waitcnt lgkmcnt(0)
    s_barrier
    ds_read_b128 v[24:27], v11 offset:16384
    ds_read_b128 v[28:31], v11 offset:17408
    ds_read_b128 v[32:35], v11 offset:18432
    buffer_load_dwordx4 a[148:151], v15, s[8:11], s83 offen offset:1024 sc1
    ds_read_b128 v[36:39], v11 offset:19456
    v_pk_fma_f32 v[92:93], v[86:87], v[250:251], v[92:93] neg_lo:[1,0,0] neg_hi:[1,0,0]
    v_pk_fma_f32 v[94:95], v[78:79], v[250:251], v[94:95]
    v_cvt_pk_bf16_f32 v61, v92, v93
    v_cvt_pk_bf16_f32 v63, v94, v95
    v_pk_mul_f32 v[92:93], v[80:81], v[244:245]
    v_pk_mul_f32 v[94:95], v[88:89], v[244:245]
    v_pk_fma_f32 v[92:93], v[88:89], v[252:253], v[92:93] neg_lo:[1,0,0] neg_hi:[1,0,0]
    v_pk_fma_f32 v[94:95], v[80:81], v[252:253], v[94:95]
    v_cvt_pk_bf16_f32 v64, v92, v93
    v_cvt_pk_bf16_f32 v66, v94, v95
    v_pk_mul_f32 v[92:93], v[82:83], v[246:247]
    v_pk_mul_f32 v[94:95], v[90:91], v[246:247]
    v_pk_fma_f32 v[92:93], v[90:91], v[254:255], v[92:93] neg_lo:[1,0,0] neg_hi:[1,0,0]
    buffer_load_dwordx4 a[152:155], v15, s[8:11], s83 offen offset:2048 sc1
    v_pk_fma_f32 v[94:95], v[82:83], v[254:255], v[94:95]
    v_cvt_pk_bf16_f32 v65, v92, v93
    v_cvt_pk_bf16_f32 v67, v94, v95
    ds_write_b128 v3, v[60:63] offset:24576
    ds_write_b128 v3, v[64:67] offset:28672
    s_waitcnt lgkmcnt(5)
    v_mfma_f32_16x16x32_bf16 v[40:43], v[178:181], v[24:27], 0
    v_mfma_f32_16x16x32_bf16 v[48:51], v[176:179], v[24:27], 0
    v_mfma_f32_16x16x32_bf16 v[44:47], v[202:205], v[24:27], 0
    v_mfma_f32_16x16x32_bf16 v[52:55], v[200:203], v[24:27], 0
    s_waitcnt lgkmcnt(4)
    v_mfma_f32_16x16x32_bf16 v[40:43], v[184:187], v[28:31], v[40:43]
    v_mfma_f32_16x16x32_bf16 v[48:51], v[182:185], v[28:31], v[48:51]
    s_waitcnt lgkmcnt(0)
    s_barrier
    buffer_load_dwordx4 a[156:159], v15, s[8:11], s83 offen offset:3072 sc1
    s_add_u32 s83, s83, 0x1000
    ds_read_b128 v[60:63], v11 offset:24576
    ds_read_b128 v[64:67], v11 offset:25600
    ds_read_b128 v[68:71], v11 offset:26624
    ds_read_b128 v[72:75], v11 offset:27648
    v_mfma_f32_16x16x32_bf16 v[44:47], v[208:211], v[28:31], v[44:47]
    v_mfma_f32_16x16x32_bf16 v[52:55], v[206:209], v[28:31], v[52:55]
    v_mfma_f32_16x16x32_bf16 v[40:43], v[190:193], v[32:35], v[40:43]
    v_mfma_f32_16x16x32_bf16 v[48:51], v[188:191], v[32:35], v[48:51]
    v_mfma_f32_16x16x32_bf16 v[44:47], v[214:217], v[32:35], v[44:47]
    v_mfma_f32_16x16x32_bf16 v[52:55], v[212:215], v[32:35], v[52:55]
    v_mfma_f32_16x16x32_bf16 v[40:43], v[196:199], v[36:39], v[40:43]
    v_mfma_f32_16x16x32_bf16 v[48:51], v[194:197], v[36:39], v[48:51]
    v_mfma_f32_16x16x32_bf16 v[44:47], v[220:223], v[36:39], v[44:47]
    v_mfma_f32_16x16x32_bf16 v[52:55], v[218:221], v[36:39], v[52:55]
    buffer_load_dwordx4 a[160:163], v15, s[8:11], s83 offen offset:0 sc1
    v_lshlrev_b32 v56, 16, v96
    s_waitcnt lgkmcnt(3)
    v_mfma_f32_16x16x32_bf16 v[76:79], v[178:181], v[60:63], 0
    v_and_b32 v57, s57, v96
    v_fmac_f32 v56, s79, v40
    v_mfma_f32_16x16x32_bf16 v[84:87], v[176:179], v[60:63], 0
    v_fmac_f32_e64 v57, s80, v48
    v_cvt_pk_bf16_f32 v96, v56, v57
    v_lshlrev_b32_e64 v58, 16, v98
    v_mfma_f32_16x16x32_bf16 v[80:83], v[202:205], v[60:63], 0
    v_and_b32 v59, s57, v98
    v_fmac_f32 v58, s79, v41
    v_mfma_f32_16x16x32_bf16 v[88:91], v[200:203], v[60:63], 0
    v_fmac_f32_e64 v59, s80, v49
    v_cvt_pk_bf16_f32 v98, v58, v59
    buffer_load_dwordx4 a[164:167], v15, s[8:11], s83 offen offset:1024 sc1
    v_lshlrev_b32 v56, 16, v100
    s_waitcnt lgkmcnt(2)
    v_mfma_f32_16x16x32_bf16 v[76:79], v[184:187], v[64:67], v[76:79]
    v_and_b32 v57, s57, v100
    v_fmac_f32 v56, s79, v42
    v_mfma_f32_16x16x32_bf16 v[84:87], v[182:185], v[64:67], v[84:87]
    v_fmac_f32_e64 v57, s80, v50
    v_cvt_pk_bf16_f32 v100, v56, v57
    v_lshlrev_b32_e64 v58, 16, v102
    v_mfma_f32_16x16x32_bf16 v[80:83], v[208:211], v[64:67], v[80:83]
    v_and_b32 v59, s57, v102
    v_fmac_f32 v58, s79, v43
    v_mfma_f32_16x16x32_bf16 v[88:91], v[206:209], v[64:67], v[88:91]
    v_fmac_f32_e64 v59, s80, v51
    v_cvt_pk_bf16_f32 v102, v58, v59
    buffer_load_dwordx4 a[168:171], v15, s[8:11], s83 offen offset:2048 sc1
    v_lshlrev_b32 v56, 16, v104
    s_waitcnt lgkmcnt(1)
    v_mfma_f32_16x16x32_bf16 v[76:79], v[190:193], v[68:71], v[76:79]
    v_and_b32 v57, s57, v104
    v_fmac_f32 v56, s79, v44
    v_mfma_f32_16x16x32_bf16 v[84:87], v[188:191], v[68:71], v[84:87]
    v_fmac_f32_e64 v57, s80, v52
    v_cvt_pk_bf16_f32 v104, v56, v57
    v_lshlrev_b32_e64 v58, 16, v106
    v_mfma_f32_16x16x32_bf16 v[80:83], v[214:217], v[68:71], v[80:83]
    v_and_b32 v59, s57, v106
    v_fmac_f32 v58, s79, v45
    v_mfma_f32_16x16x32_bf16 v[88:91], v[212:215], v[68:71], v[88:91]
    v_fmac_f32_e64 v59, s80, v53
    v_cvt_pk_bf16_f32 v106, v58, v59
    buffer_load_dwordx4 a[172:175], v15, s[8:11], s83 offen offset:3072 sc1
    s_add_u32 s83, s83, 0x1000
    v_lshlrev_b32 v56, 16, v108
    s_waitcnt lgkmcnt(0)
    v_mfma_f32_16x16x32_bf16 v[76:79], v[196:199], v[72:75], v[76:79]
    v_and_b32 v57, s57, v108
    v_fmac_f32 v56, s79, v46
    v_mfma_f32_16x16x32_bf16 v[84:87], v[194:197], v[72:75], v[84:87]
    v_fmac_f32_e64 v57, s80, v54
    v_cvt_pk_bf16_f32 v108, v56, v57
    v_lshlrev_b32_e64 v58, 16, v110
    v_mfma_f32_16x16x32_bf16 v[80:83], v[220:223], v[72:75], v[80:83]
    v_and_b32 v59, s57, v110
    v_fmac_f32 v58, s79, v47
    v_mfma_f32_16x16x32_bf16 v[88:91], v[218:221], v[72:75], v[88:91]
    v_fmac_f32_e64 v59, s80, v55
    v_cvt_pk_bf16_f32 v110, v58, v59
    v_lshlrev_b32 v92, 16, v97
    v_and_b32 v93, s57, v97
    v_fmac_f32 v92, s81, v76
    v_fmac_f32 v93, s82, v84
    v_cvt_pk_bf16_f32 v97, v92, v93
    v_lshlrev_b32 v94, 16, v99
    v_and_b32 v95, s57, v99
    v_fmac_f32 v94, s81, v77
    v_fmac_f32 v95, s82, v85
    v_cvt_pk_bf16_f32 v99, v94, v95
    buffer_store_dwordx4 v[96:99], v12, s[8:11], s53 offen offset:0 sc1
    v_lshlrev_b32 v92, 16, v101
    v_and_b32 v93, s57, v101
    v_fmac_f32 v92, s81, v78
    v_fmac_f32 v93, s82, v86
    v_cvt_pk_bf16_f32 v101, v92, v93
    v_lshlrev_b32 v94, 16, v103
    v_and_b32 v95, s57, v103
    v_fmac_f32 v94, s81, v79
    v_fmac_f32 v95, s82, v87
    v_cvt_pk_bf16_f32 v103, v94, v95
    buffer_store_dwordx4 v[100:103], v12, s[8:11], s53 offen offset:1024 sc1
    v_lshlrev_b32 v92, 16, v105
    v_and_b32 v93, s57, v105
    v_fmac_f32 v92, s81, v80
    v_fmac_f32 v93, s82, v88
    v_cvt_pk_bf16_f32 v105, v92, v93
    v_lshlrev_b32 v94, 16, v107
    v_and_b32 v95, s57, v107
    v_fmac_f32 v94, s81, v81
    v_fmac_f32 v95, s82, v89
    v_cvt_pk_bf16_f32 v107, v94, v95
    buffer_store_dwordx4 v[104:107], v12, s[8:11], s53 offen offset:2048 sc1
    v_lshlrev_b32 v92, 16, v109
    v_and_b32 v93, s57, v109
    v_fmac_f32 v92, s81, v82
    v_fmac_f32 v93, s82, v90
    v_cvt_pk_bf16_f32 v109, v92, v93
    v_lshlrev_b32 v94, 16, v111
    v_and_b32 v95, s57, v111
    v_fmac_f32 v94, s81, v83
    v_fmac_f32 v95, s82, v91
    v_cvt_pk_bf16_f32 v111, v94, v95
    buffer_store_dwordx4 v[108:111], v12, s[8:11], s53 offen offset:3072 sc1
    s_add_u32 s48, s92, 96
    v_mov_b32_e64 v16, 1
    v_mul_u32_u24 v17, 4096, v0
    v_lshl_add_u32 v17, s3, 28, v17
    s_mov_b64 exec, 0xff
    s_waitcnt vmcnt(0) lgkmcnt(0)
    s_barrier
    buffer_atomic_add v16, v17, s[8:11], s48 offen sc1
    s_mov_b64 exec, -1
    s_nop 0
    buffer_load_dwordx4 a[176:179], v15, s[8:11], s83 offen offset:0 sc1
    buffer_load_dwordx4 a[180:183], v15, s[8:11], s83 offen offset:1024 sc1
    buffer_load_dwordx4 a[184:187], v15, s[8:11], s83 offen offset:2048 sc1
    buffer_load_dwordx4 a[188:191], v15, s[8:11], s83 offen offset:3072 sc1
    s_add_u32 s83, s83, 0x3000
    buffer_load_dwordx4 a[224:227], v15, s[8:11], s83 offen offset:0 sc1
    buffer_load_dwordx4 a[228:231], v15, s[8:11], s83 offen offset:1024 sc1
    buffer_load_dwordx4 a[232:235], v15, s[8:11], s83 offen offset:2048 sc1
    buffer_load_dwordx4 a[236:239], v15, s[8:11], s83 offen offset:3072 sc1
    s_add_u32 s83, s83, 0x1000
L_g1b:
    s_nop 1
L_pg5202:
    s_cbranch_execz L_hopr2
    s_and_b32 s48, s67, 3
    s_mul_i32 s48, s48, 491520
    s_add_u32 s48, s48, s71
    s_lshr_b32 s49, s67, 2
    s_lshl_b32 s50, s49, 21
    s_add_u32 s48, s48, s50
    s_lshr_b32 s50, s64, 3
    s_xor_b32 s49, s49, s50
    s_lshl_b32 s49, s49, 13
    s_add_u32 s48, s48, s49
    s_add_u32 s48, s48, 54525952
    s_add_u32 s84, s48, 393216
    s_add_u32 s49, s3, 1
    s_and_b32 s49, s49, 3
    s_mul_i32 s49, s49, 98304
    s_add_u32 s85, s48, s49
    s_add_u32 s49, s3, 2
    s_and_b32 s49, s49, 3
    s_mul_i32 s49, s49, 98304
    s_add_u32 s86, s48, s49
    s_add_u32 s49, s3, 3
    s_and_b32 s49, s49, 3
    s_mul_i32 s49, s49, 98304
    s_add_u32 s87, s48, s49
    s_add_u32 s49, s3, 4
    s_and_b32 s49, s49, 3
    s_mul_i32 s49, s49, 98304
    s_add_u32 s88, s48, s49
    v_mov_b32 v10, v15
    v_lshlrev_b32_e64 v13, 4, v0
    v_add_u32 v15, 16384, v13
    s_and_b32 s48, s3, 1
    s_lshl_b32 s48, s48, 13
    s_add_u32 s48, s48, 4096
    v_add_u32 v14, s48, v13
    v_lshrrev_b32 v9, 2, v0
    v_lshlrev_b32 v11, 7, v9
    v_and_b32 v9, 8, v9
    v_xor_b32 v9, v9, v1
    v_lshlrev_b32 v9, 4, v9
    v_lshl_add_u32 v9, v2, 14, v9
    s_lshl_b32 s48, s64, 10
    s_lshr_b32 s49, s3, 1
    s_lshl_b32 s50, s49, 8
    s_add_u32 s48, s48, s50
    s_and_b32 s50, s3, 1
    s_lshl_b32 s51, s50, 16
    s_add_u32 s48, s48, s51
    s_add_u32 s52, s48, 16777216
    s_mul_i32 s49, s49, 40960
    s_lshl_b32 s50, s50, 10
    s_add_u32 m0, s49, s50
    v_and_b32 v3, 1, v2
    v_lshl_add_u32 v3, v2, 2, v3
    v_lshlrev_b32 v3, 7, v3
    v_and_b32 v12, 7, v0
    v_lshl_add_u32 v3, v12, 4, v3
    v_and_or_b32 v4, v0, 8, v3
    v_xor_b32 v5, 128, v4
    v_add_u32 v6, 40960, v4
    v_add_u32 v7, 40960, v5
    v_bfe_u32 v3, v0, 3, 1
    v_and_or_b32 v3, v2, 2, v3
    v_mul_u32_u24 v3, 98304, v3
    v_and_b32 v12, 0xf0, v4
    v_add_u32_e64 v8, v12, v3
    s_lshl_b32 s48, s65, 2
    s_add_u32 s48, s48, s3
    s_lshl_b32 s49, s48, 7
    s_add_u32 s54, s49, s97
    s_bfe_u32 s50, s64, 0x20001
    s_lshl_b32 s49, s50, 21
    s_lshr_b32 s51, s64, 3
    s_xor_b32 s50, s50, s51
    s_and_b32 s50, s50, 1
    s_lshl_b32 s50, s50, 13
    s_add_u32 s49, s49, s50
    s_and_b32 s50, s64, 1
    s_mul_i32 s50, s50, 786432
    s_add_u32 s49, s49, s50
    s_add_u32 s49, s49, 46137344
    s_mul_i32 s48, s48, 3
    s_and_b32 s50, s48, 0xe0
    s_add_u32 s50, s50, s48
    s_lshl_b32 s50, s50, 8
    s_add_u32 s53, s50, s49
    s_add_u32 s48, s48, 1
    s_and_b32 s50, s48, 0xe0
    s_add_u32 s50, s50, s48
    s_lshl_b32 s50, s50, 8
    s_add_u32 s69, s50, s49
    s_add_u32 s48, s48, 1
    s_and_b32 s50, s48, 0xe0
    s_add_u32 s50, s50, s48
    s_lshl_b32 s50, s50, 8
    s_add_u32 s70, s50, s49
    s_mul_i32 s48, s66, 196608
    s_add_u32 s48, s48, s71
    s_add_u32 s100, s48, s49
    s_and_b32 s48, s67, 3
    s_mul_i32 s48, s48, 294912
    s_lshr_b32 s49, s67, 2
    s_lshl_b32 s50, s49, 21
    s_add_u32 s48, s48, s50
    s_xor_b32 s49, s49, s51
    s_lshl_b32 s49, s49, 13
    s_add_u32 s48, s48, s49
    s_add_u32 s48, s48, s71
    s_add_u32 s56, s48, 58720256
    s_add_u32 s57, s56, 98304
    s_lshl_b32 s48, s66, 3
    s_add_u32 s48, s48, s3
    s_lshl_b32 s48, s48, 11
    s_add_u32 s55, s48, s97
    s_mul_i32 s59, s66, 40960
    s_sub_u32 s58, 40960, s59
    s_mov_b32 s63, s58
    v_cmp_gt_u32 vcc, 2, v0
    v_mov_b32 v3, 1073741824
    v_lshlrev_b32 v12, 14, v0
    v_cndmask_b32_e64 v3, v3, v12, vcc
    s_cmp_eq_u32 s3, 1
    s_cbranch_scc1 L_wait_16p
    s_mov_b64 exec, 0
    s_cmp_eq_u32 s3, 0
    s_cbranch_scc1 L_pg5561
    s_cmp_eq_u32 s3, 2
    s_cbranch_scc1 L_pg6121
    s_branch L_pg6703
L_wait_16p:
    s_add_u32 s48, s93, 96
    v_mul_u32_u24 v17, 128, v0
    s_mov_b32 s7, 0x20000
    s_mov_b32 exec_lo, 0xfffff
    s_mov_b32 exec_hi, 0
L_poll_17:
    buffer_load_dword v16, v17, s[8:11], s48 offen sc1
    s_sub_u32 s7, s7, 1
    s_cbranch_scc1 L_polld_18
    s_waitcnt vmcnt(0)
    v_cmp_gt_u32_e64 vcc, 8, v16
    s_nop 0
    s_cbranch_vccnz L_poll_17
L_polld_18:
L_hopr6:
    s_mov_b64 exec, -1
L_wait_16:
    s_barrier
    buffer_load_dwordx4 v9, s[8:11], s52 offen offset:0 sc1 lds
    s_add_u32 s52, s52, 129024
    buffer_load_dwordx4 v9, s[8:11], s52 offen offset:2048 sc1 lds
    s_add_u32 s52, s52, 0x20800
    s_add_u32 m0, m0, 4096
    s_nop 0
    buffer_load_dwordx4 v9, s[8:11], s52 offen offset:0 sc1 lds
    s_add_u32 s52, s52, 129024
    buffer_load_dwordx4 v9, s[8:11], s52 offen offset:2048 sc1 lds
    s_add_u32 s52, s52, 0x20800
    s_add_u32 m0, m0, 4096
    s_nop 0
    buffer_load_dwordx4 v9, s[8:11], s52 offen offset:0 sc1 lds
    s_add_u32 s52, s52, 129024
    buffer_load_dwordx4 v9, s[8:11], s52 offen offset:2048 sc1 lds
    s_add_u32 s52, s52, 0x20800
    s_add_u32 m0, m0, 4096
    s_nop 0
    buffer_load_dwordx4 v9, s[8:11], s52 offen offset:0 sc1 lds
    s_add_u32 s52, s52, 129024
    buffer_load_dwordx4 v9, s[8:11], s52 offen offset:2048 sc1 lds
    s_add_u32 s52, s52, 0x20800
    s_add_u32 m0, m0, 4096
    s_waitcnt vmcnt(7)
    s_barrier
    s_nop 0
    ds_read_b64 v[64:65], v4 offset:0
    ds_read_b64 v[66:67], v4 offset:256
    ds_read_b64 v[68:69], v5 offset:0
    ds_read_b64 v[70:71], v5 offset:256
    ds_read_b64 v[72:73], v6 offset:0
    ds_read_b64 v[74:75], v6 offset:256
    ds_read_b64 v[76:77], v7 offset:0
    ds_read_b64 v[78:79], v7 offset:256
    s_waitcnt lgkmcnt(6)
    v_mfma_f32_16x16x32_bf16 v[16:19], a[0:3], v[64:67], 0
    buffer_load_dwordx4 v9, s[8:11], s52 offen offset:0 sc1 lds
    v_mfma_f32_16x16x32_bf16 v[20:23], a[4:7], v[64:67], 0
    s_waitcnt vmcnt(6)
    s_barrier
    ds_read_b64 v[80:81], v4 offset:2048
    v_mfma_f32_16x16x32_bf16 v[24:27], a[8:11], v[64:67], 0
    s_waitcnt lgkmcnt(5)
    s_add_u32 s52, s52, 129024
    ds_read_b64 v[82:83], v4 offset:2304
    v_mfma_f32_16x16x32_bf16 v[28:31], a[0:3], v[68:71], 0
    ds_read_b64 v[84:85], v5 offset:2048
    ds_read_b64 v[86:87], v5 offset:2304
    v_mfma_f32_16x16x32_bf16 v[32:35], a[4:7], v[68:71], 0
    buffer_load_dwordx4 v9, s[8:11], s52 offen offset:2048 sc1 lds
    v_mfma_f32_16x16x32_bf16 v[36:39], a[8:11], v[68:71], 0
    s_waitcnt lgkmcnt(6)
    s_add_u32 s52, s52, 0x20800
    ds_read_b64 v[88:89], v6 offset:2048
    v_mfma_f32_16x16x32_bf16 v[40:43], a[0:3], v[72:75], 0
    s_add_u32 m0, m0, 4096
    ds_read_b64 v[90:91], v6 offset:2304
    ds_read_b64 v[92:93], v7 offset:2048
    v_mfma_f32_16x16x32_bf16 v[44:47], a[4:7], v[72:75], 0
    ds_read_b64 v[94:95], v7 offset:2304
    v_mfma_f32_16x16x32_bf16 v[48:51], a[8:11], v[72:75], 0
    s_waitcnt lgkmcnt(8)
    buffer_load_dwordx4 v9, s[8:11], s52 offen offset:0 sc1 lds
    v_mfma_f32_16x16x32_bf16 v[52:55], a[0:3], v[76:79], 0
    s_add_u32 s52, s52, 129024
    v_mfma_f32_16x16x32_bf16 v[56:59], a[4:7], v[76:79], 0
    v_mfma_f32_16x16x32_bf16 v[60:63], a[8:11], v[76:79], 0
    s_waitcnt lgkmcnt(6)
    v_mfma_f32_16x16x32_bf16 v[16:19], a[12:15], v[80:83], v[16:19]
    buffer_load_dwordx4 v9, s[8:11], s52 offen offset:2048 sc1 lds
    v_mfma_f32_16x16x32_bf16 v[20:23], a[16:19], v[80:83], v[20:23]
    s_add_u32 s52, s52, 0x20800
    ds_read_b64 v[64:65], v4 offset:4096
    s_add_u32 m0, m0, 4096
    v_mfma_f32_16x16x32_bf16 v[24:27], a[20:23], v[80:83], v[24:27]
    s_waitcnt lgkmcnt(5)
    ds_read_b64 v[66:67], v4 offset:4352
    ds_read_b64 v[68:69], v5 offset:4096
    v_mfma_f32_16x16x32_bf16 v[28:31], a[12:15], v[84:87], v[28:31]
    ds_read_b64 v[70:71], v5 offset:4352
    ds_read_b64 v[72:73], v6 offset:4096
    v_mfma_f32_16x16x32_bf16 v[32:35], a[16:19], v[84:87], v[32:35]
    buffer_load_dwordx4 v9, s[8:11], s52 offen offset:0 sc1 lds
    v_mfma_f32_16x16x32_bf16 v[36:39], a[20:23], v[84:87], v[36:39]
    s_waitcnt lgkmcnt(7)
    s_add_u32 s52, s52, 129024
    ds_read_b64 v[74:75], v6 offset:4352
    v_mfma_f32_16x16x32_bf16 v[40:43], a[12:15], v[88:91], v[40:43]
    ds_read_b64 v[76:77], v7 offset:4096
    ds_read_b64 v[78:79], v7 offset:4352
    v_mfma_f32_16x16x32_bf16 v[44:47], a[16:19], v[88:91], v[44:47]
    v_mfma_f32_16x16x32_bf16 v[48:51], a[20:23], v[88:91], v[48:51]
    s_waitcnt lgkmcnt(8)
    buffer_load_dwordx4 v9, s[8:11], s52 offen offset:2048 sc1 lds
    v_mfma_f32_16x16x32_bf16 v[52:55], a[12:15], v[92:95], v[52:55]
    s_add_u32 s52, s52, 0x20800
    s_add_u32 m0, m0, 4096
    v_mfma_f32_16x16x32_bf16 v[56:59], a[16:19], v[92:95], v[56:59]
    v_mfma_f32_16x16x32_bf16 v[60:63], a[20:23], v[92:95], v[60:63]
    s_waitcnt lgkmcnt(6)
    v_mfma_f32_16x16x32_bf16 v[16:19], a[24:27], v[64:67], v[16:19]
    buffer_load_dwordx4 v9, s[8:11], s52 offen offset:0 sc1 lds
    v_mfma_f32_16x16x32_bf16 v[20:23], a[28:31], v[64:67], v[20:23]
    s_waitcnt vmcnt(9)
    s_barrier
    ds_read_b64 v[80:81], v4 offset:6144
    v_mfma_f32_16x16x32_bf16 v[24:27], a[32:35], v[64:67], v[24:27]
    s_waitcnt lgkmcnt(5)
    s_add_u32 s52, s52, 129024
    ds_read_b64 v[82:83], v4 offset:6400
    v_mfma_f32_16x16x32_bf16 v[28:31], a[24:27], v[68:71], v[28:31]
    ds_read_b64 v[84:85], v5 offset:6144
    ds_read_b64 v[86:87], v5 offset:6400
    v_mfma_f32_16x16x32_bf16 v[32:35], a[28:31], v[68:71], v[32:35]
    buffer_load_dwordx4 v9, s[8:11], s52 offen offset:2048 sc1 lds
    v_mfma_f32_16x16x32_bf16 v[36:39], a[32:35], v[68:71], v[36:39]
    s_waitcnt lgkmcnt(6)
    s_add_u32 s52, s52, 0x330800
    ds_read_b64 v[88:89], v6 offset:6144
    v_mfma_f32_16x16x32_bf16 v[40:43], a[24:27], v[72:75], v[40:43]
    s_add_u32 m0, m0, 4096
    ds_read_b64 v[90:91], v6 offset:6400
    ds_read_b64 v[92:93], v7 offset:6144
    v_mfma_f32_16x16x32_bf16 v[44:47], a[28:31], v[72:75], v[44:47]
    ds_read_b64 v[94:95], v7 offset:6400
    v_mfma_f32_16x16x32_bf16 v[48:51], a[32:35], v[72:75], v[48:51]
    s_waitcnt lgkmcnt(8)
    buffer_load_dwordx4 v9, s[8:11], s52 offen offset:0 sc1 lds
    v_mfma_f32_16x16x32_bf16 v[52:55], a[24:27], v[76:79], v[52:55]
    s_add_u32 s52, s52, 129024
    v_mfma_f32_16x16x32_bf16 v[56:59], a[28:31], v[76:79], v[56:59]
    v_mfma_f32_16x16x32_bf16 v[60:63], a[32:35], v[76:79], v[60:63]
    s_waitcnt lgkmcnt(6)
    v_mfma_f32_16x16x32_bf16 v[16:19], a[36:39], v[80:83], v[16:19]
    buffer_load_dwordx4 v9, s[8:11], s52 offen offset:2048 sc1 lds
    v_mfma_f32_16x16x32_bf16 v[20:23], a[40:43], v[80:83], v[20:23]
    s_add_u32 s52, s52, 0x20800
    ds_read_b64 v[64:65], v4 offset:8192
    s_add_u32 m0, m0, 4096
    v_mfma_f32_16x16x32_bf16 v[24:27], a[44:47], v[80:83], v[24:27]
    s_waitcnt lgkmcnt(5)
    ds_read_b64 v[66:67], v4 offset:8448
    ds_read_b64 v[68:69], v5 offset:8192
    v_mfma_f32_16x16x32_bf16 v[28:31], a[36:39], v[84:87], v[28:31]
    ds_read_b64 v[70:71], v5 offset:8448
    ds_read_b64 v[72:73], v6 offset:8192
    v_mfma_f32_16x16x32_bf16 v[32:35], a[40:43], v[84:87], v[32:35]
    buffer_load_dwordx4 v9, s[8:11], s52 offen offset:0 sc1 lds
    v_mfma_f32_16x16x32_bf16 v[36:39], a[44:47], v[84:87], v[36:39]
    s_waitcnt lgkmcnt(7)
    s_add_u32 s52, s52, 129024
    ds_read_b64 v[74:75], v6 offset:8448
    v_mfma_f32_16x16x32_bf16 v[40:43], a[36:39], v[88:91], v[40:43]
    ds_read_b64 v[76:77], v7 offset:8192
    ds_read_b64 v[78:79], v7 offset:8448
    v_mfma_f32_16x16x32_bf16 v[44:47], a[40:43], v[88:91], v[44:47]
    v_mfma_f32_16x16x32_bf16 v[48:51], a[44:47], v[88:91], v[48:51]
    s_waitcnt lgkmcnt(8)
    buffer_load_dwordx4 v9, s[8:11], s52 offen offset:2048 sc1 lds
    v_mfma_f32_16x16x32_bf16 v[52:55], a[36:39], v[92:95], v[52:55]
    s_sub_u32 s52, s52, 0x56f600
    s_add_u32 m0, m0, 45056
    v_mfma_f32_16x16x32_bf16 v[56:59], a[40:43], v[92:95], v[56:59]
    v_mfma_f32_16x16x32_bf16 v[60:63], a[44:47], v[92:95], v[60:63]
    s_waitcnt lgkmcnt(6)
    v_mfma_f32_16x16x32_bf16 v[16:19], a[48:51], v[64:67], v[16:19]
    buffer_load_dwordx4 v9, s[8:11], s52 offen offset:0 sc1 lds
    v_mfma_f32_16x16x32_bf16 v[20:23], a[52:55], v[64:67], v[20:23]
    s_add_u32 s52, s52, 129024
    ds_read_b64 v[80:81], v4 offset:10240
    ds_read_b64 v[82:83], v4 offset:10496
    v_mfma_f32_16x16x32_bf16 v[24:27], a[56:59], v[64:67], v[24:27]
    s_waitcnt lgkmcnt(6)
    ds_read_b64 v[84:85], v5 offset:10240
    ds_read_b64 v[86:87], v5 offset:10496
    v_mfma_f32_16x16x32_bf16 v[28:31], a[48:51], v[68:71], v[28:31]
    ds_read_b64 v[88:89], v6 offset:10240
    ds_read_b64 v[90:91], v6 offset:10496
    v_mfma_f32_16x16x32_bf16 v[32:35], a[52:55], v[68:71], v[32:35]
    buffer_load_dwordx4 v9, s[8:11], s52 offen offset:2048 sc1 lds
    v_mfma_f32_16x16x32_bf16 v[36:39], a[56:59], v[68:71], v[36:39]
    s_waitcnt lgkmcnt(8)
    s_add_u32 s52, s52, 0x20800
    s_add_u32 m0, m0, 4096
    v_mfma_f32_16x16x32_bf16 v[40:43], a[48:51], v[72:75], v[40:43]
    ds_read_b64 v[92:93], v7 offset:10240
    ds_read_b64 v[94:95], v7 offset:10496
    v_mfma_f32_16x16x32_bf16 v[44:47], a[52:55], v[72:75], v[44:47]
    v_mfma_f32_16x16x32_bf16 v[48:51], a[56:59], v[72:75], v[48:51]
    s_waitcnt lgkmcnt(8)
    buffer_load_dwordx4 v9, s[8:11], s52 offen offset:0 sc1 lds
    v_mfma_f32_16x16x32_bf16 v[52:55], a[48:51], v[76:79], v[52:55]
    s_add_u32 s52, s52, 129024
    v_mfma_f32_16x16x32_bf16 v[56:59], a[52:55], v[76:79], v[56:59]
    v_mfma_f32_16x16x32_bf16 v[60:63], a[56:59], v[76:79], v[60:63]
    s_waitcnt lgkmcnt(6)
    v_mfma_f32_16x16x32_bf16 v[16:19], a[60:63], v[80:83], v[16:19]
    buffer_load_dwordx4 v9, s[8:11], s52 offen offset:2048 sc1 lds
    v_mfma_f32_16x16x32_bf16 v[20:23], a[64:67], v[80:83], v[20:23]
    s_waitcnt vmcnt(14)
    s_barrier
    s_add_u32 s52, s52, 0x20800
    v_mfma_f32_16x16x32_bf16 v[24:27], a[68:71], v[80:83], v[24:27]
    s_waitcnt lgkmcnt(4)
    ds_read_b64 v[64:65], v4 offset:12288
    s_add_u32 m0, m0, 4096
    v_mfma_f32_16x16x32_bf16 v[28:31], a[60:63], v[84:87], v[28:31]
    s_add_u32 s98, s93, 2656
    ds_read_b64 v[66:67], v4 offset:12544
    ds_read_b64 v[68:69], v5 offset:12288
    v_mfma_f32_16x16x32_bf16 v[32:35], a[64:67], v[84:87], v[32:35]
L_pg5561:
    s_cbranch_execz L_pg7295
    ds_read_b64 v[70:71], v5 offset:12544
    v_min_u32 v240, 11, v0
    v_mfma_f32_16x16x32_bf16 v[36:39], a[68:71], v[84:87], v[36:39]
    s_waitcnt lgkmcnt(6)
    buffer_load_dwordx4 v9, s[8:11], s52 offen offset:0 sc1 lds
    v_mfma_f32_16x16x32_bf16 v[40:43], a[60:63], v[88:91], v[40:43]
    s_add_u32 s52, s52, 129024
    ds_read_b64 v[72:73], v6 offset:12288
    v_mul_u32_u24 v240, 128, v240
    v_mfma_f32_16x16x32_bf16 v[44:47], a[64:67], v[88:91], v[44:47]
    ds_read_b64 v[74:75], v6 offset:12544
    ds_read_b64 v[76:77], v7 offset:12288
    v_mfma_f32_16x16x32_bf16 v[48:51], a[68:71], v[88:91], v[48:51]
    s_waitcnt lgkmcnt(7)
    ds_read_b64 v[78:79], v7 offset:12544
    v_mfma_f32_16x16x32_bf16 v[52:55], a[60:63], v[92:95], v[52:55]
    buffer_load_dword v12, v240, s[8:11], s98 offen sc1
    v_mfma_f32_16x16x32_bf16 v[56:59], a[64:67], v[92:95], v[56:59]
    v_mfma_f32_16x16x32_bf16 v[60:63], a[68:71], v[92:95], v[60:63]
    s_waitcnt lgkmcnt(6)
    buffer_load_dwordx4 v9, s[8:11], s52 offen offset:2048 sc1 lds
    s_add_u32 s52, s52, 0x20800
    v_mfma_f32_16x16x32_bf16 v[16:19], a[72:75], v[64:67], v[16:19]
    s_add_u32 m0, m0, 4096
    ds_read_b64 v[80:81], v4 offset:14336
    ds_read_b64 v[82:83], v4 offset:14592
    v_mfma_f32_16x16x32_bf16 v[20:23], a[76:79], v[64:67], v[20:23]
    ds_read_b64 v[84:85], v5 offset:14336
    ds_read_b64 v[86:87], v5 offset:14592
    v_mfma_f32_16x16x32_bf16 v[24:27], a[80:83], v[64:67], v[24:27]
    s_waitcnt lgkmcnt(8)
    ds_read_b64 v[88:89], v6 offset:14336
    ds_read_b64 v[90:91], v6 offset:14592
    v_mfma_f32_16x16x32_bf16 v[28:31], a[72:75], v[68:71], v[28:31]
    buffer_load_dwordx4 v9, s[8:11], s52 offen offset:0 sc1 lds
    v_mfma_f32_16x16x32_bf16 v[32:35], a[76:79], v[68:71], v[32:35]
    s_add_u32 s52, s52, 129024
    ds_read_b64 v[92:93], v7 offset:14336
    ds_read_b64 v[94:95], v7 offset:14592
    v_mfma_f32_16x16x32_bf16 v[36:39], a[80:83], v[68:71], v[36:39]
    s_waitcnt lgkmcnt(10)
    v_mfma_f32_16x16x32_bf16 v[40:43], a[72:75], v[72:75], v[40:43]
    v_mfma_f32_16x16x32_bf16 v[44:47], a[76:79], v[72:75], v[44:47]
    buffer_load_dwordx4 v9, s[8:11], s52 offen offset:2048 sc1 lds
    s_add_u32 s52, s52, 0x20800
    v_mfma_f32_16x16x32_bf16 v[48:51], a[80:83], v[72:75], v[48:51]
    s_waitcnt lgkmcnt(8)
    s_add_u32 m0, m0, 4096
    v_mfma_f32_16x16x32_bf16 v[52:55], a[72:75], v[76:79], v[52:55]
    v_mfma_f32_16x16x32_bf16 v[56:59], a[76:79], v[76:79], v[56:59]
    v_mfma_f32_16x16x32_bf16 v[60:63], a[80:83], v[76:79], v[60:63]
    s_waitcnt lgkmcnt(6)
    buffer_load_dwordx4 v9, s[8:11], s52 offen offset:0 sc1 lds
    v_mfma_f32_16x16x32_bf16 v[16:19], a[84:87], v[80:83], v[16:19]
    s_add_u32 s52, s52, 129024
    ds_read_b64 v[64:65], v4 offset:16384
    ds_read_b64 v[66:67], v4 offset:16640
    v_mfma_f32_16x16x32_bf16 v[20:23], a[88:91], v[80:83], v[20:23]
    ds_read_b64 v[68:69], v5 offset:16384
    ds_read_b64 v[70:71], v5 offset:16640
    v_mfma_f32_16x16x32_bf16 v[24:27], a[92:95], v[80:83], v[24:27]
    s_waitcnt lgkmcnt(8)
    ds_read_b64 v[72:73], v6 offset:16384
    ds_read_b64 v[74:75], v6 offset:16640
    v_mfma_f32_16x16x32_bf16 v[28:31], a[84:87], v[84:87], v[28:31]
    buffer_load_dwordx4 v9, s[8:11], s52 offen offset:2048 sc1 lds
    s_add_u32 s52, s52, 0x20800
    v_mfma_f32_16x16x32_bf16 v[32:35], a[88:91], v[84:87], v[32:35]
    s_add_u32 m0, m0, 4096
    ds_read_b64 v[76:77], v7 offset:16384
    ds_read_b64 v[78:79], v7 offset:16640
    v_mfma_f32_16x16x32_bf16 v[36:39], a[92:95], v[84:87], v[36:39]
    s_waitcnt lgkmcnt(10)
    v_mfma_f32_16x16x32_bf16 v[40:43], a[84:87], v[88:91], v[40:43]
    v_mfma_f32_16x16x32_bf16 v[44:47], a[88:91], v[88:91], v[44:47]
    buffer_load_dwordx4 v9, s[8:11], s52 offen offset:0 sc1 lds
    v_mfma_f32_16x16x32_bf16 v[48:51], a[92:95], v[88:91], v[48:51]
    s_waitcnt lgkmcnt(8)
    s_add_u32 s52, s52, 129024
    v_mfma_f32_16x16x32_bf16 v[52:55], a[84:87], v[92:95], v[52:55]
    v_mfma_f32_16x16x32_bf16 v[56:59], a[88:91], v[92:95], v[56:59]
    v_mfma_f32_16x16x32_bf16 v[60:63], a[92:95], v[92:95], v[60:63]
    s_waitcnt lgkmcnt(6)
    buffer_load_dwordx4 v9, s[8:11], s52 offen offset:2048 sc1 lds
    s_add_u32 s52, s52, 0x20800
    v_mfma_f32_16x16x32_bf16 v[16:19], a[96:99], v[64:67], v[16:19]
    s_add_u32 m0, m0, 4096
    ds_read_b64 v[80:81], v4 offset:18432
    ds_read_b64 v[82:83], v4 offset:18688
    v_mfma_f32_16x16x32_bf16 v[20:23], a[100:103], v[64:67], v[20:23]
    ds_read_b64 v[84:85], v5 offset:18432
    ds_read_b64 v[86:87], v5 offset:18688
    v_mfma_f32_16x16x32_bf16 v[24:27], a[104:107], v[64:67], v[24:27]
    s_waitcnt lgkmcnt(8)
    ds_read_b64 v[88:89], v6 offset:18432
    ds_read_b64 v[90:91], v6 offset:18688
    v_mfma_f32_16x16x32_bf16 v[28:31], a[96:99], v[68:71], v[28:31]
    buffer_load_dwordx4 v9, s[8:11], s52 offen offset:0 sc1 lds
    v_mfma_f32_16x16x32_bf16 v[32:35], a[100:103], v[68:71], v[32:35]
    s_add_u32 s52, s52, 129024
    ds_read_b64 v[92:93], v7 offset:18432
    ds_read_b64 v[94:95], v7 offset:18688
    v_mfma_f32_16x16x32_bf16 v[36:39], a[104:107], v[68:71], v[36:39]
    s_waitcnt lgkmcnt(10)
    v_mfma_f32_16x16x32_bf16 v[40:43], a[96:99], v[72:75], v[40:43]
    v_mfma_f32_16x16x32_bf16 v[44:47], a[100:103], v[72:75], v[44:47]
    buffer_load_dwordx4 v9, s[8:11], s52 offen offset:2048 sc1 lds
    s_add_u32 s52, s52, 0x20800
    v_mfma_f32_16x16x32_bf16 v[48:51], a[104:107], v[72:75], v[48:51]
    s_waitcnt lgkmcnt(8)
    s_add_u32 m0, m0, 4096
    v_mfma_f32_16x16x32_bf16 v[52:55], a[96:99], v[76:79], v[52:55]
    v_mfma_f32_16x16x32_bf16 v[56:59], a[100:103], v[76:79], v[56:59]
    v_mfma_f32_16x16x32_bf16 v[60:63], a[104:107], v[76:79], v[60:63]
    s_waitcnt lgkmcnt(6)
    buffer_load_dwordx4 v9, s[8:11], s52 offen offset:0 sc1 lds
    v_mfma_f32_16x16x32_bf16 v[16:19], a[108:111], v[80:83], v[16:19]
    s_add_u32 s52, s52, 129024
    s_waitcnt vmcnt(21)
    s_barrier
    v_mfma_f32_16x16x32_bf16 v[20:23], a[112:115], v[80:83], v[20:23]
    ds_read_b64 v[64:65], v4 offset:20480
    ds_read_b64 v[66:67], v4 offset:20736
    v_mfma_f32_16x16x32_bf16 v[24:27], a[116:119], v[80:83], v[24:27]
    s_waitcnt lgkmcnt(6)
    ds_read_b64 v[68:69], v5 offset:20480
    ds_read_b64 v[70:71], v5 offset:20736
    v_mfma_f32_16x16x32_bf16 v[28:31], a[108:111], v[84:87], v[28:31]
    buffer_load_dwordx4 v9, s[8:11], s52 offen offset:2048 sc1 lds
    s_add_u32 s52, s52, 0x330800
    v_mfma_f32_16x16x32_bf16 v[32:35], a[112:115], v[84:87], v[32:35]
    s_add_u32 m0, m0, 4096
    ds_read_b64 v[72:73], v6 offset:20480
    ds_read_b64 v[74:75], v6 offset:20736
    v_mfma_f32_16x16x32_bf16 v[36:39], a[116:119], v[84:87], v[36:39]
    s_waitcnt lgkmcnt(8)
    ds_read_b64 v[76:77], v7 offset:20480
    ds_read_b64 v[78:79], v7 offset:20736
    v_mfma_f32_16x16x32_bf16 v[40:43], a[108:111], v[88:91], v[40:43]
    v_mfma_f32_16x16x32_bf16 v[44:47], a[112:115], v[88:91], v[44:47]
    buffer_load_dwordx4 v9, s[8:11], s52 offen offset:0 sc1 lds
    v_mfma_f32_16x16x32_bf16 v[48:51], a[116:119], v[88:91], v[48:51]
    s_waitcnt lgkmcnt(8)
    s_add_u32 s52, s52, 129024
    v_mfma_f32_16x16x32_bf16 v[52:55], a[108:111], v[92:95], v[52:55]
    v_mfma_f32_16x16x32_bf16 v[56:59], a[112:115], v[92:95], v[56:59]
    v_mfma_f32_16x16x32_bf16 v[60:63], a[116:119], v[92:95], v[60:63]
    s_waitcnt lgkmcnt(6)
    buffer_load_dwordx4 v9, s[8:11], s52 offen offset:2048 sc1 lds
    s_add_u32 s52, s52, 0x20800
    v_mfma_f32_16x16x32_bf16 v[16:19], a[120:123], v[64:67], v[16:19]
    s_add_u32 m0, m0, 4096
    ds_read_b64 v[80:81], v4 offset:22528
    ds_read_b64 v[82:83], v4 offset:22784
    v_mfma_f32_16x16x32_bf16 v[20:23], a[124:127], v[64:67], v[20:23]
    s_waitcnt vmcnt(13)
    v_cmp_gt_u32_e64 vcc, 8, v12
    s_nop 0
    s_cbranch_vccnz L_slow9
L_back9:
    v_mfma_f32_16x16x32_bf16 v[24:27], a[128:131], v[64:67], v[24:27]
    s_waitcnt lgkmcnt(6)
    ds_read_b64 v[84:85], v5 offset:22528
    ds_read_b64 v[86:87], v5 offset:22784
    v_mfma_f32_16x16x32_bf16 v[28:31], a[120:123], v[68:71], v[28:31]
    buffer_load_dwordx4 v9, s[8:11], s52 offen offset:0 sc1 lds
    v_mfma_f32_16x16x32_bf16 v[32:35], a[124:127], v[68:71], v[32:35]
    s_add_u32 s52, s52, 129024
    ds_read_b64 v[88:89], v6 offset:22528
    ds_read_b64 v[90:91], v6 offset:22784
    v_mfma_f32_16x16x32_bf16 v[36:39], a[128:131], v[68:71], v[36:39]
    s_waitcnt lgkmcnt(8)
    ds_read_b64 v[92:93], v7 offset:22528
    ds_read_b64 v[94:95], v7 offset:22784
    v_mfma_f32_16x16x32_bf16 v[40:43], a[120:123], v[72:75], v[40:43]
    v_mfma_f32_16x16x32_bf16 v[44:47], a[124:127], v[72:75], v[44:47]
    buffer_load_dwordx4 v9, s[8:11], s52 offen offset:2048 sc1 lds
    v_mfma_f32_16x16x32_bf16 v[48:51], a[128:131], v[72:75], v[48:51]
    s_waitcnt lgkmcnt(8)
    v_mfma_f32_16x16x32_bf16 v[52:55], a[120:123], v[76:79], v[52:55]
    v_mfma_f32_16x16x32_bf16 v[56:59], a[124:127], v[76:79], v[56:59]
    v_mfma_f32_16x16x32_bf16 v[60:63], a[128:131], v[76:79], v[60:63]
    s_waitcnt lgkmcnt(6)
    buffer_load_dwordx4 v[96:99], v13, s[8:11], s84 offen offset:0 sc1
    v_mfma_f32_16x16x32_bf16 v[16:19], a[132:135], v[80:83], v[16:19]
    ds_read_b64 v[64:65], v4 offset:24576
    ds_read_b64 v[66:67], v4 offset:24832
    v_mfma_f32_16x16x32_bf16 v[20:23], a[136:139], v[80:83], v[20:23]
    ds_read_b64 v[68:69], v5 offset:24576
    ds_read_b64 v[70:71], v5 offset:24832
    v_mfma_f32_16x16x32_bf16 v[24:27], a[140:143], v[80:83], v[24:27]
    s_waitcnt lgkmcnt(8)
    ds_read_b64 v[72:73], v6 offset:24576
    ds_read_b64 v[74:75], v6 offset:24832
    v_mfma_f32_16x16x32_bf16 v[28:31], a[132:135], v[84:87], v[28:31]
    buffer_load_dwordx4 v[100:103], v13, s[8:11], s85 offen offset:0 sc1
    v_mfma_f32_16x16x32_bf16 v[32:35], a[136:139], v[84:87], v[32:35]
    ds_read_b64 v[76:77], v7 offset:24576
    ds_read_b64 v[78:79], v7 offset:24832
    v_mfma_f32_16x16x32_bf16 v[36:39], a[140:143], v[84:87], v[36:39]
    s_waitcnt lgkmcnt(10)
    v_mfma_f32_16x16x32_bf16 v[40:43], a[132:135], v[88:91], v[40:43]
    v_mfma_f32_16x16x32_bf16 v[44:47], a[136:139], v[88:91], v[44:47]
    buffer_load_dwordx4 v[104:107], v13, s[8:11], s86 offen offset:0 sc1
    v_mfma_f32_16x16x32_bf16 v[48:51], a[140:143], v[88:91], v[48:51]
    s_waitcnt lgkmcnt(8)
    v_mfma_f32_16x16x32_bf16 v[52:55], a[132:135], v[92:95], v[52:55]
    v_mfma_f32_16x16x32_bf16 v[56:59], a[136:139], v[92:95], v[56:59]
    v_mfma_f32_16x16x32_bf16 v[60:63], a[140:143], v[92:95], v[60:63]
    s_waitcnt lgkmcnt(6)
    buffer_load_dwordx4 v[108:111], v13, s[8:11], s87 offen offset:0 sc1
    v_mfma_f32_16x16x32_bf16 v[16:19], a[144:147], v[64:67], v[16:19]
    ds_read_b64 v[80:81], v4 offset:26624
    ds_read_b64 v[82:83], v4 offset:26880
    v_mfma_f32_16x16x32_bf16 v[20:23], a[148:151], v[64:67], v[20:23]
    ds_read_b64 v[84:85], v5 offset:26624
    ds_read_b64 v[86:87], v5 offset:26880
    v_mfma_f32_16x16x32_bf16 v[24:27], a[152:155], v[64:67], v[24:27]
    s_waitcnt lgkmcnt(8)
    ds_read_b64 v[88:89], v6 offset:26624
    ds_read_b64 v[90:91], v6 offset:26880
    v_mfma_f32_16x16x32_bf16 v[28:31], a[144:147], v[68:71], v[28:31]
    buffer_load_dwordx4 v[112:115], v13, s[8:11], s88 offen offset:0 sc1
    v_mfma_f32_16x16x32_bf16 v[32:35], a[148:151], v[68:71], v[32:35]
    ds_read_b64 v[92:93], v7 offset:26624
    ds_read_b64 v[94:95], v7 offset:26880
    v_mfma_f32_16x16x32_bf16 v[36:39], a[152:155], v[68:71], v[36:39]
    s_waitcnt lgkmcnt(10)
    v_mfma_f32_16x16x32_bf16 v[40:43], a[144:147], v[72:75], v[40:43]
    v_mfma_f32_16x16x32_bf16 v[44:47], a[148:151], v[72:75], v[44:47]
    buffer_load_dwordx4 v[116:119], v13, s[8:11], s84 offen offset:1024 sc1
    v_mfma_f32_16x16x32_bf16 v[48:51], a[152:155], v[72:75], v[48:51]
    s_waitcnt lgkmcnt(8)
    v_mfma_f32_16x16x32_bf16 v[52:55], a[144:147], v[76:79], v[52:55]
    v_mfma_f32_16x16x32_bf16 v[56:59], a[148:151], v[76:79], v[56:59]
    v_mfma_f32_16x16x32_bf16 v[60:63], a[152:155], v[76:79], v[60:63]
    s_waitcnt lgkmcnt(6)
    buffer_load_dwordx4 v[120:123], v13, s[8:11], s85 offen offset:1024 sc1
    v_mfma_f32_16x16x32_bf16 v[16:19], a[156:159], v[80:83], v[16:19]
    ds_read_b64 v[64:65], v4 offset:28672
    ds_read_b64 v[66:67], v4 offset:28928
    v_mfma_f32_16x16x32_bf16 v[20:23], a[160:163], v[80:83], v[20:23]
    ds_read_b64 v[68:69], v5 offset:28672
    ds_read_b64 v[70:71], v5 offset:28928
    v_mfma_f32_16x16x32_bf16 v[24:27], a[164:167], v[80:83], v[24:27]
    s_waitcnt lgkmcnt(8)
    ds_read_b64 v[72:73], v6 offset:28672
    ds_read_b64 v[74:75], v6 offset:28928
    v_mfma_f32_16x16x32_bf16 v[28:31], a[156:159], v[84:87], v[28:31]
    buffer_load_dwordx4 v[124:127], v13, s[8:11], s86 offen offset:1024 sc1
    v_mfma_f32_16x16x32_bf16 v[32:35], a[160:163], v[84:87], v[32:35]
    ds_read_b64 v[76:77], v7 offset:28672
    ds_read_b64 v[78:79], v7 offset:28928
    v_mfma_f32_16x16x32_bf16 v[36:39], a[164:167], v[84:87], v[36:39]
    s_waitcnt lgkmcnt(10)
    v_mfma_f32_16x16x32_bf16 v[40:43], a[156:159], v[88:91], v[40:43]
    v_mfma_f32_16x16x32_bf16 v[44:47], a[160:163], v[88:91], v[44:47]
    buffer_load_dwordx4 v[128:131], v13, s[8:11], s87 offen offset:1024 sc1
    v_mfma_f32_16x16x32_bf16 v[48:51], a[164:167], v[88:91], v[48:51]
    s_waitcnt lgkmcnt(8)
    v_mfma_f32_16x16x32_bf16 v[52:55], a[156:159], v[92:95], v[52:55]
    v_mfma_f32_16x16x32_bf16 v[56:59], a[160:163], v[92:95], v[56:59]
    v_mfma_f32_16x16x32_bf16 v[60:63], a[164:167], v[92:95], v[60:63]
    s_waitcnt lgkmcnt(6)
    buffer_load_dwordx4 v[132:135], v13, s[8:11], s88 offen offset:1024 sc1
    v_mfma_f32_16x16x32_bf16 v[16:19], a[168:171], v[64:67], v[16:19]
    s_barrier
    ds_read_b64 v[80:81], v4 offset:30720
    v_mfma_f32_16x16x32_bf16 v[20:23], a[172:175], v[64:67], v[20:23]
    ds_read_b64 v[82:83], v4 offset:30976
    ds_read_b64 v[84:85], v5 offset:30720
    v_mfma_f32_16x16x32_bf16 v[24:27], a[176:179], v[64:67], v[24:27]
    s_waitcnt lgkmcnt(7)
    ds_read_b64 v[86:87], v5 offset:30976
    ds_read_b64 v[88:89], v6 offset:30720
    v_mfma_f32_16x16x32_bf16 v[28:31], a[168:171], v[68:71], v[28:31]
    buffer_load_dwordx4 v[136:139], v13, s[8:11], s84 offen offset:2048 sc1
    v_mfma_f32_16x16x32_bf16 v[32:35], a[172:175], v[68:71], v[32:35]
    ds_read_b64 v[90:91], v6 offset:30976
    ds_read_b64 v[92:93], v7 offset:30720
    v_mfma_f32_16x16x32_bf16 v[36:39], a[176:179], v[68:71], v[36:39]
    s_waitcnt lgkmcnt(9)
    ds_read_b64 v[94:95], v7 offset:30976
    v_mfma_f32_16x16x32_bf16 v[40:43], a[168:171], v[72:75], v[40:43]
    v_mfma_f32_16x16x32_bf16 v[44:47], a[172:175], v[72:75], v[44:47]
    buffer_load_dwordx4 v[140:143], v13, s[8:11], s85 offen offset:2048 sc1
    v_mfma_f32_16x16x32_bf16 v[48:51], a[176:179], v[72:75], v[48:51]
    s_waitcnt lgkmcnt(8)
    v_mfma_f32_16x16x32_bf16 v[52:55], a[168:171], v[76:79], v[52:55]
    v_mfma_f32_16x16x32_bf16 v[56:59], a[172:175], v[76:79], v[56:59]
    v_mfma_f32_16x16x32_bf16 v[60:63], a[176:179], v[76:79], v[60:63]
    s_waitcnt lgkmcnt(6)
    buffer_load_dwordx4 v[144:147], v13, s[8:11], s86 offen offset:2048 sc1
    v_mfma_f32_16x16x32_bf16 v[16:19], a[180:183], v[80:83], v[16:19]
    ds_read_b64 v[64:65], v4 offset:32768
    ds_read_b64 v[66:67], v4 offset:33024
    v_mfma_f32_16x16x32_bf16 v[20:23], a[184:187], v[80:83], v[20:23]
    ds_read_b64 v[68:69], v5 offset:32768
    ds_read_b64 v[70:71], v5 offset:33024
    v_mfma_f32_16x16x32_bf16 v[24:27], a[188:191], v[80:83], v[24:27]
    s_waitcnt lgkmcnt(8)
    ds_read_b64 v[72:73], v6 offset:32768
    ds_read_b64 v[74:75], v6 offset:33024
    v_mfma_f32_16x16x32_bf16 v[28:31], a[180:183], v[84:87], v[28:31]
    buffer_load_dwordx4 v[148:151], v13, s[8:11], s87 offen offset:2048 sc1
    v_mfma_f32_16x16x32_bf16 v[32:35], a[184:187], v[84:87], v[32:35]
    ds_read_b64 v[76:77], v7 offset:32768
    ds_read_b64 v[78:79], v7 offset:33024
    v_mfma_f32_16x16x32_bf16 v[36:39], a[188:191], v[84:87], v[36:39]
    s_waitcnt lgkmcnt(10)
    v_mfma_f32_16x16x32_bf16 v[40:43], a[180:183], v[88:91], v[40:43]
    v_mfma_f32_16x16x32_bf16 v[44:47], a[184:187], v[88:91], v[44:47]
    buffer_load_dwordx4 v[152:155], v13, s[8:11], s88 offen offset:2048 sc1
    v_mfma_f32_16x16x32_bf16 v[48:51], a[188:191], v[88:91], v[48:51]
    s_waitcnt lgkmcnt(8)
    v_mfma_f32_16x16x32_bf16 v[52:55], a[180:183], v[92:95], v[52:55]
    v_mfma_f32_16x16x32_bf16 v[56:59], a[184:187], v[92:95], v[56:59]
    v_mfma_f32_16x16x32_bf16 v[60:63], a[188:191], v[92:95], v[60:63]
    s_waitcnt lgkmcnt(6)
    buffer_load_dwordx4 v[156:159], v13, s[8:11], s84 offen offset:3072 sc1
    v_mfma_f32_16x16x32_bf16 v[16:19], a[192:195], v[64:67], v[16:19]
    ds_read_b64 v[80:81], v4 offset:34816
    ds_read_b64 v[82:83], v4 offset:35072
    v_mfma_f32_16x16x32_bf16 v[20:23], a[196:199], v[64:67], v[20:23]
    ds_read_b64 v[84:85], v5 offset:34816
    ds_read_b64 v[86:87], v5 offset:35072
    v_mfma_f32_16x16x32_bf16 v[24:27], a[200:203], v[64:67], v[24:27]
    s_waitcnt lgkmcnt(8)
    ds_read_b64 v[88:89], v6 offset:34816
    ds_read_b64 v[90:91], v6 offset:35072
    v_mfma_f32_16x16x32_bf16 v[28:31], a[192:195], v[68:71], v[28:31]
    buffer_load_dwordx4 v[160:163], v13, s[8:11], s85 offen offset:3072 sc1
    v_mfma_f32_16x16x32_bf16 v[32:35], a[196:199], v[68:71], v[32:35]
    ds_read_b64 v[92:93], v7 offset:34816
    ds_read_b64 v[94:95], v7 offset:35072
    v_mfma_f32_16x16x32_bf16 v[36:39], a[200:203], v[68:71], v[36:39]
    s_waitcnt lgkmcnt(10)
    v_mfma_f32_16x16x32_bf16 v[40:43], a[192:195], v[72:75], v[40:43]
    v_mfma_f32_16x16x32_bf16 v[44:47], a[196:199], v[72:75], v[44:47]
    buffer_load_dwordx4 v[164:167], v13, s[8:11], s86 offen offset:3072 sc1
    v_mfma_f32_16x16x32_bf16 v[48:51], a[200:203], v[72:75], v[48:51]
    s_waitcnt lgkmcnt(8)
    v_mfma_f32_16x16x32_bf16 v[52:55], a[192:195], v[76:79], v[52:55]
    v_mfma_f32_16x16x32_bf16 v[56:59], a[196:199], v[76:79], v[56:59]
    v_mfma_f32_16x16x32_bf16 v[60:63], a[200:203], v[76:79], v[60:63]
    s_waitcnt lgkmcnt(6)
    buffer_load_dwordx4 v[168:171], v13, s[8:11], s87 offen offset:3072 sc1
    v_mfma_f32_16x16x32_bf16 v[16:19], a[204:207], v[80:83], v[16:19]
    ds_read_b64 v[64:65], v4 offset:36864
    ds_read_b64 v[66:67], v4 offset:37120
    v_mfma_f32_16x16x32_bf16 v[20:23], a[208:211], v[80:83], v[20:23]
    ds_read_b64 v[68:69], v5 offset:36864
    ds_read_b64 v[70:71], v5 offset:37120
    v_mfma_f32_16x16x32_bf16 v[24:27], a[212:215], v[80:83], v[24:27]
    s_waitcnt lgkmcnt(8)
    ds_read_b64 v[72:73], v6 offset:36864
    ds_read_b64 v[74:75], v6 offset:37120
    v_mfma_f32_16x16x32_bf16 v[28:31], a[204:207], v[84:87], v[28:31]
    buffer_load_dwordx4 v[172:175], v13, s[8:11], s88 offen offset:3072 sc1
    v_mfma_f32_16x16x32_bf16 v[32:35], a[208:211], v[84:87], v[32:35]
    ds_read_b64 v[76:77], v7 offset:36864
    ds_read_b64 v[78:79], v7 offset:37120
    v_mfma_f32_16x16x32_bf16 v[36:39], a[212:215], v[84:87], v[36:39]
    s_waitcnt lgkmcnt(10)
    v_mfma_f32_16x16x32_bf16 v[40:43], a[204:207], v[88:91], v[40:43]
    v_mfma_f32_16x16x32_bf16 v[44:47], a[208:211], v[88:91], v[44:47]
    buffer_load_dwordx4 v[176:179], v14, s[8:11], s84 offen offset:0 sc1
    v_mfma_f32_16x16x32_bf16 v[48:51], a[212:215], v[88:91], v[48:51]
    s_waitcnt lgkmcnt(8)
    v_mfma_f32_16x16x32_bf16 v[52:55], a[204:207], v[92:95], v[52:55]
    v_mfma_f32_16x16x32_bf16 v[56:59], a[208:211], v[92:95], v[56:59]
    v_mfma_f32_16x16x32_bf16 v[60:63], a[212:215], v[92:95], v[60:63]
    s_waitcnt lgkmcnt(6)
    buffer_load_dwordx4 v[180:183], v14, s[8:11], s85 offen offset:0 sc1
    v_mfma_f32_16x16x32_bf16 v[16:19], a[216:219], v[64:67], v[16:19]
    ds_read_b64 v[80:81], v4 offset:38912
    ds_read_b64 v[82:83], v4 offset:39168
    v_mfma_f32_16x16x32_bf16 v[20:23], a[220:223], v[64:67], v[20:23]
    ds_read_b64 v[84:85], v5 offset:38912
    ds_read_b64 v[86:87], v5 offset:39168
    v_mfma_f32_16x16x32_bf16 v[24:27], a[224:227], v[64:67], v[24:27]
    s_waitcnt lgkmcnt(8)
    ds_read_b64 v[88:89], v6 offset:38912
    ds_read_b64 v[90:91], v6 offset:39168
    v_mfma_f32_16x16x32_bf16 v[28:31], a[216:219], v[68:71], v[28:31]
    buffer_load_dwordx4 v[184:187], v14, s[8:11], s86 offen offset:0 sc1
    v_mfma_f32_16x16x32_bf16 v[32:35], a[220:223], v[68:71], v[32:35]
    ds_read_b64 v[92:93], v7 offset:38912
    ds_read_b64 v[94:95], v7 offset:39168
    v_mfma_f32_16x16x32_bf16 v[36:39], a[224:227], v[68:71], v[36:39]
    s_waitcnt lgkmcnt(10)
    v_add_u32 v4, 81920, v4
    v_add_u32 v5, 81920, v5
    v_mfma_f32_16x16x32_bf16 v[40:43], a[216:219], v[72:75], v[40:43]
    v_add_u32 v6, 81920, v6
    v_add_u32 v7, 81920, v7
    v_mfma_f32_16x16x32_bf16 v[44:47], a[220:223], v[72:75], v[44:47]
    buffer_load_dwordx4 v[188:191], v14, s[8:11], s87 offen offset:0 sc1
    v_mfma_f32_16x16x32_bf16 v[48:51], a[224:227], v[72:75], v[48:51]
    s_waitcnt lgkmcnt(8)
    v_mfma_f32_16x16x32_bf16 v[52:55], a[216:219], v[76:79], v[52:55]
    v_mfma_f32_16x16x32_bf16 v[56:59], a[220:223], v[76:79], v[56:59]
    v_mfma_f32_16x16x32_bf16 v[60:63], a[224:227], v[76:79], v[60:63]
    s_waitcnt lgkmcnt(6)
    buffer_load_dwordx4 v[192:195], v14, s[8:11], s88 offen offset:0 sc1
    v_mfma_f32_16x16x32_bf16 v[16:19], a[228:231], v[80:83], v[16:19]
    s_waitcnt vmcnt(25)
    s_barrier
    ds_read_b64 v[64:65], v4 offset:0
    v_mfma_f32_16x16x32_bf16 v[20:23], a[232:235], v[80:83], v[20:23]
    ds_read_b64 v[66:67], v4 offset:256
    ds_read_b64 v[68:69], v5 offset:0
    v_mfma_f32_16x16x32_bf16 v[24:27], a[236:239], v[80:83], v[24:27]
    s_waitcnt lgkmcnt(7)
    ds_read_b64 v[70:71], v5 offset:256
    ds_read_b64 v[72:73], v6 offset:0
    v_mfma_f32_16x16x32_bf16 v[28:31], a[228:231], v[84:87], v[28:31]
    buffer_load_dwordx4 v[196:199], v14, s[8:11], s84 offen offset:1024 sc1
    v_mfma_f32_16x16x32_bf16 v[32:35], a[232:235], v[84:87], v[32:35]
    ds_read_b64 v[74:75], v6 offset:256
    ds_read_b64 v[76:77], v7 offset:0
    v_mfma_f32_16x16x32_bf16 v[36:39], a[236:239], v[84:87], v[36:39]
    s_waitcnt lgkmcnt(9)
    ds_read_b64 v[78:79], v7 offset:256
    v_mfma_f32_16x16x32_bf16 v[40:43], a[228:231], v[88:91], v[40:43]
    v_mfma_f32_16x16x32_bf16 v[44:47], a[232:235], v[88:91], v[44:47]
    buffer_load_dwordx4 v[200:203], v14, s[8:11], s85 offen offset:1024 sc1
    v_mfma_f32_16x16x32_bf16 v[48:51], a[236:239], v[88:91], v[48:51]
    s_waitcnt lgkmcnt(8)
    v_mfma_f32_16x16x32_bf16 v[52:55], a[228:231], v[92:95], v[52:55]
    v_mfma_f32_16x16x32_bf16 v[56:59], a[232:235], v[92:95], v[56:59]
    v_mfma_f32_16x16x32_bf16 v[60:63], a[236:239], v[92:95], v[60:63]
    s_waitcnt lgkmcnt(6)
    buffer_load_dwordx4 v[204:207], v14, s[8:11], s86 offen offset:1024 sc1
    v_mfma_f32_16x16x32_bf16 v[208:211], a[0:3], v[64:67], 0
    ds_read_b64 v[80:81], v4 offset:2048
    ds_read_b64 v[82:83], v4 offset:2304
    v_mfma_f32_16x16x32_bf16 v[212:215], a[4:7], v[64:67], 0
    ds_read_b64 v[84:85], v5 offset:2048
    ds_read_b64 v[86:87], v5 offset:2304
    v_mfma_f32_16x16x32_bf16 v[216:219], a[8:11], v[64:67], 0
    s_waitcnt lgkmcnt(8)
    ds_read_b64 v[88:89], v6 offset:2048
    ds_read_b64 v[90:91], v6 offset:2304
    v_mfma_f32_16x16x32_bf16 v[220:223], a[0:3], v[68:71], 0
    v_max_f32 v16, 0, v16
    v_max_f32 v17, 0, v17
    v_mfma_f32_16x16x32_bf16 v[224:227], a[4:7], v[68:71], 0
    ds_read_b64 v[92:93], v7 offset:2048
    v_mul_f32_e64 v16, v16, v18
    v_mfma_f32_16x16x32_bf16 v[228:231], a[8:11], v[68:71], 0
    s_waitcnt lgkmcnt(9)
    ds_read_b64 v[94:95], v7 offset:2304
    v_mul_f32 v17, v17, v19
    v_mfma_f32_16x16x32_bf16 v[232:235], a[0:3], v[72:75], 0
    v_cvt_pk_bf16_f32 v16, v16, v17
    v_max_f32_e64 v28, 0, v28
    v_mfma_f32_16x16x32_bf16 v[236:239], a[4:7], v[72:75], 0
    v_max_f32 v29, 0, v29
    v_mul_f32 v28, v28, v30
    v_mfma_f32_16x16x32_bf16 v[240:243], a[8:11], v[72:75], 0
    s_waitcnt lgkmcnt(8)
    v_mul_f32 v29, v29, v31
    v_cvt_pk_bf16_f32 v17, v28, v29
    v_mfma_f32_16x16x32_bf16 v[244:247], a[0:3], v[76:79], 0
    v_max_f32 v40, 0, v40
    v_max_f32 v41, 0, v41
    v_mfma_f32_16x16x32_bf16 v[248:251], a[4:7], v[76:79], 0
    buffer_load_dwordx4 a[0:3], v14, s[8:11], s87 offen offset:1024 sc1
    v_mfma_f32_16x16x32_bf16 v[252:255], a[8:11], v[76:79], 0
    s_waitcnt lgkmcnt(6)
    v_mul_f32 v40, v40, v42
    v_mul_f32_e64 v41, v41, v43
    v_mfma_f32_16x16x32_bf16 v[208:211], a[12:15], v[80:83], v[208:211]
    ds_read_b64 v[64:65], v4 offset:4096
    ds_read_b64 v[66:67], v4 offset:4352
    v_mfma_f32_16x16x32_bf16 v[212:215], a[16:19], v[80:83], v[212:215]
    ds_read_b64 v[68:69], v5 offset:4096
    v_cvt_pk_bf16_f32 v18, v40, v41
    v_mfma_f32_16x16x32_bf16 v[216:219], a[20:23], v[80:83], v[216:219]
    s_waitcnt lgkmcnt(7)
    ds_read_b64 v[70:71], v5 offset:4352
    v_max_f32 v52, 0, v52
    v_mfma_f32_16x16x32_bf16 v[220:223], a[12:15], v[84:87], v[220:223]
    ds_read_b64 v[72:73], v6 offset:4096
    v_max_f32_e64 v53, 0, v53
    v_mfma_f32_16x16x32_bf16 v[224:227], a[16:19], v[84:87], v[224:227]
    ds_read_b64 v[74:75], v6 offset:4352
    v_mul_f32_e64 v52, v52, v54
    v_mfma_f32_16x16x32_bf16 v[228:231], a[20:23], v[84:87], v[228:231]
    s_waitcnt lgkmcnt(8)
    ds_read_b64 v[76:77], v7 offset:4096
    v_mul_f32 v53, v53, v55
    v_mfma_f32_16x16x32_bf16 v[232:235], a[12:15], v[88:91], v[232:235]
    ds_read_b64 v[78:79], v7 offset:4352
    v_cvt_pk_bf16_f32 v19, v52, v53
    v_mfma_f32_16x16x32_bf16 v[236:239], a[16:19], v[88:91], v[236:239]
    v_max_f32 v20, 0, v20
    v_max_f32 v21, 0, v21
    v_mfma_f32_16x16x32_bf16 v[240:243], a[20:23], v[88:91], v[240:243]
    s_waitcnt lgkmcnt(8)
    v_permlane32_swap_b32 v16, v18
    v_mfma_f32_16x16x32_bf16 v[244:247], a[12:15], v[92:95], v[244:247]
    v_mul_f32 v20, v20, v22
    v_mul_f32 v21, v21, v23
    v_mfma_f32_16x16x32_bf16 v[248:251], a[16:19], v[92:95], v[248:251]
    buffer_load_dwordx4 a[4:7], v14, s[8:11], s88 offen offset:1024 sc1
    v_mfma_f32_16x16x32_bf16 v[252:255], a[20:23], v[92:95], v[252:255]
    s_waitcnt lgkmcnt(6)
    v_permlane32_swap_b32 v17, v19
    v_mfma_f32_16x16x32_bf16 v[208:211], a[24:27], v[64:67], v[208:211]
    ds_read_b64 v[80:81], v4 offset:6144
    v_cvt_pk_bf16_f32 v20, v20, v21
    v_mfma_f32_16x16x32_bf16 v[212:215], a[28:31], v[64:67], v[212:215]
    ds_read_b64 v[82:83], v4 offset:6400
    v_max_f32_e64 v32, 0, v32
    v_mfma_f32_16x16x32_bf16 v[216:219], a[32:35], v[64:67], v[216:219]
    s_waitcnt lgkmcnt(6)
    ds_read_b64 v[84:85], v5 offset:6144
    ds_read_b64 v[86:87], v5 offset:6400
    v_mfma_f32_16x16x32_bf16 v[220:223], a[24:27], v[68:71], v[220:223]
    v_permlane16_swap_b32 v16, v17
    v_mfma_f32_16x16x32_bf16 v[224:227], a[28:31], v[68:71], v[224:227]
    ds_read_b64 v[88:89], v6 offset:6144
    v_max_f32_e64 v33, 0, v33
    v_mfma_f32_16x16x32_bf16 v[228:231], a[32:35], v[68:71], v[228:231]
    s_waitcnt lgkmcnt(7)
    ds_read_b64 v[90:91], v6 offset:6400
    v_mul_f32 v32, v32, v34
    v_mfma_f32_16x16x32_bf16 v[232:235], a[24:27], v[72:75], v[232:235]
    v_permlane16_swap_b32_e64 v18, v19
    v_mfma_f32_16x16x32_bf16 v[236:239], a[28:31], v[72:75], v[236:239]
    ds_read_b64 v[92:93], v7 offset:6144
    v_mul_f32_e64 v33, v33, v35
    v_mfma_f32_16x16x32_bf16 v[240:243], a[32:35], v[72:75], v[240:243]
    s_waitcnt lgkmcnt(7)
    ds_read_b64 v[94:95], v7 offset:6400
    v_cvt_pk_bf16_f32 v21, v32, v33
    v_mfma_f32_16x16x32_bf16 v[244:247], a[24:27], v[76:79], v[244:247]
    buffer_store_dwordx4 v[16:19], v8, s[8:11], s53 offen sc1
    v_mfma_f32_16x16x32_bf16 v[248:251], a[28:31], v[76:79], v[248:251]
    v_max_f32 v44, 0, v44
    v_max_f32_e64 v45, 0, v45
    v_mfma_f32_16x16x32_bf16 v[252:255], a[32:35], v[76:79], v[252:255]
    s_waitcnt lgkmcnt(6)
    v_mul_f32 v44, v44, v46
    v_mul_f32_e64 v45, v45, v47
    v_mfma_f32_16x16x32_bf16 v[208:211], a[36:39], v[80:83], v[208:211]
    ds_read_b64 v[64:65], v4 offset:8192
    ds_read_b64 v[66:67], v4 offset:8448
    v_mfma_f32_16x16x32_bf16 v[212:215], a[40:43], v[80:83], v[212:215]
    buffer_load_dwordx4 a[8:11], v14, s[8:11], s84 offen offset:2048 sc1
    v_mfma_f32_16x16x32_bf16 v[216:219], a[44:47], v[80:83], v[216:219]
    s_waitcnt lgkmcnt(6)
    ds_read_b64 v[68:69], v5 offset:8192
    v_cvt_pk_bf16_f32 v22, v44, v45
    v_mfma_f32_16x16x32_bf16 v[220:223], a[36:39], v[84:87], v[220:223]
    ds_read_b64 v[70:71], v5 offset:8448
    v_max_f32 v56, 0, v56
    v_mfma_f32_16x16x32_bf16 v[224:227], a[40:43], v[84:87], v[224:227]
L_pg6121:
    s_cbranch_execz L_hopr6
    ds_read_b64 v[72:73], v6 offset:8192
    v_max_f32 v57, 0, v57
    v_mfma_f32_16x16x32_bf16 v[228:231], a[44:47], v[84:87], v[228:231]
    s_waitcnt lgkmcnt(7)
    ds_read_b64 v[74:75], v6 offset:8448
    v_mul_f32 v56, v56, v58
    v_mfma_f32_16x16x32_bf16 v[232:235], a[36:39], v[88:91], v[232:235]
    ds_read_b64 v[76:77], v7 offset:8192
    v_mul_f32_e64 v57, v57, v59
    v_mfma_f32_16x16x32_bf16 v[236:239], a[40:43], v[88:91], v[236:239]
    ds_read_b64 v[78:79], v7 offset:8448
    v_cvt_pk_bf16_f32 v23, v56, v57
    v_mfma_f32_16x16x32_bf16 v[240:243], a[44:47], v[88:91], v[240:243]
    s_waitcnt lgkmcnt(8)
    v_max_f32 v24, 0, v24
    v_max_f32_e64 v25, 0, v25
    v_mfma_f32_16x16x32_bf16 v[244:247], a[36:39], v[92:95], v[244:247]
    v_permlane32_swap_b32_e64 v20, v22
    v_mfma_f32_16x16x32_bf16 v[248:251], a[40:43], v[92:95], v[248:251]
    buffer_load_dwordx4 a[12:15], v14, s[8:11], s85 offen offset:2048 sc1
    v_mfma_f32_16x16x32_bf16 v[252:255], a[44:47], v[92:95], v[252:255]
    s_waitcnt lgkmcnt(6)
    v_mul_f32 v24, v24, v26
    v_mul_f32_e64 v25, v25, v27
    v_mfma_f32_16x16x32_bf16 v[208:211], a[48:51], v[64:67], v[208:211]
    v_permlane32_swap_b32_e64 v21, v23
    v_mfma_f32_16x16x32_bf16 v[212:215], a[52:55], v[64:67], v[212:215]
    ds_read_b64 v[80:81], v4 offset:10240
    v_cvt_pk_bf16_f32 v24, v24, v25
    v_mfma_f32_16x16x32_bf16 v[216:219], a[56:59], v[64:67], v[216:219]
    s_waitcnt lgkmcnt(5)
    ds_read_b64 v[82:83], v4 offset:10496
    v_max_f32 v36, 0, v36
    v_mfma_f32_16x16x32_bf16 v[220:223], a[48:51], v[68:71], v[220:223]
    ds_read_b64 v[84:85], v5 offset:10240
    ds_read_b64 v[86:87], v5 offset:10496
    v_mfma_f32_16x16x32_bf16 v[224:227], a[52:55], v[68:71], v[224:227]
    v_permlane16_swap_b32_e64 v20, v21
    v_mfma_f32_16x16x32_bf16 v[228:231], a[56:59], v[68:71], v[228:231]
    s_waitcnt lgkmcnt(6)
    ds_read_b64 v[88:89], v6 offset:10240
    v_max_f32 v37, 0, v37
    v_mfma_f32_16x16x32_bf16 v[232:235], a[48:51], v[72:75], v[232:235]
    ds_read_b64 v[90:91], v6 offset:10496
    v_mul_f32_e64 v36, v36, v38
    v_mfma_f32_16x16x32_bf16 v[236:239], a[52:55], v[72:75], v[236:239]
    v_permlane16_swap_b32_e64 v22, v23
    v_mfma_f32_16x16x32_bf16 v[240:243], a[56:59], v[72:75], v[240:243]
    s_waitcnt lgkmcnt(6)
    ds_read_b64 v[92:93], v7 offset:10240
    v_mul_f32 v37, v37, v39
    v_mfma_f32_16x16x32_bf16 v[244:247], a[48:51], v[76:79], v[244:247]
    ds_read_b64 v[94:95], v7 offset:10496
    v_cvt_pk_bf16_f32 v25, v36, v37
    v_mfma_f32_16x16x32_bf16 v[248:251], a[52:55], v[76:79], v[248:251]
    buffer_store_dwordx4 v[20:23], v8, s[8:11], s69 offen sc1
    v_mfma_f32_16x16x32_bf16 v[252:255], a[56:59], v[76:79], v[252:255]
    s_waitcnt lgkmcnt(6)
    v_max_f32 v48, 0, v48
    v_max_f32_e64 v49, 0, v49
    v_mfma_f32_16x16x32_bf16 v[208:211], a[60:63], v[80:83], v[208:211]
    ds_read_b64 v[64:65], v4 offset:12288
    v_mul_f32_e64 v48, v48, v50
    v_mfma_f32_16x16x32_bf16 v[212:215], a[64:67], v[80:83], v[212:215]
    buffer_load_dwordx4 a[16:19], v14, s[8:11], s86 offen offset:2048 sc1
    v_mfma_f32_16x16x32_bf16 v[216:219], a[68:71], v[80:83], v[216:219]
    s_waitcnt lgkmcnt(5)
    ds_read_b64 v[66:67], v4 offset:12544
    v_mul_f32 v49, v49, v51
    v_mfma_f32_16x16x32_bf16 v[220:223], a[60:63], v[84:87], v[220:223]
    ds_read_b64 v[68:69], v5 offset:12288
    v_cvt_pk_bf16_f32 v26, v48, v49
    v_mfma_f32_16x16x32_bf16 v[224:227], a[64:67], v[84:87], v[224:227]
    ds_read_b64 v[70:71], v5 offset:12544
    v_max_f32_e64 v60, 0, v60
    v_mfma_f32_16x16x32_bf16 v[228:231], a[68:71], v[84:87], v[228:231]
    s_waitcnt lgkmcnt(6)
    ds_read_b64 v[72:73], v6 offset:12288
    v_max_f32 v61, 0, v61
    v_mfma_f32_16x16x32_bf16 v[232:235], a[60:63], v[88:91], v[232:235]
    ds_read_b64 v[74:75], v6 offset:12544
    v_mul_f32_e64 v60, v60, v62
    v_mfma_f32_16x16x32_bf16 v[236:239], a[64:67], v[88:91], v[236:239]
    ds_read_b64 v[76:77], v7 offset:12288
    v_mul_f32_e64 v61, v61, v63
    v_mfma_f32_16x16x32_bf16 v[240:243], a[68:71], v[88:91], v[240:243]
    s_waitcnt lgkmcnt(7)
    ds_read_b64 v[78:79], v7 offset:12544
    v_cvt_pk_bf16_f32 v27, v60, v61
    v_mfma_f32_16x16x32_bf16 v[244:247], a[60:63], v[92:95], v[244:247]
    v_permlane32_swap_b32 v24, v26
    v_mfma_f32_16x16x32_bf16 v[248:251], a[64:67], v[92:95], v[248:251]
    v_permlane32_swap_b32_e64 v25, v27
    v_mfma_f32_16x16x32_bf16 v[252:255], a[68:71], v[92:95], v[252:255]
    s_waitcnt lgkmcnt(6)
    buffer_load_dwordx4 a[20:23], v14, s[8:11], s87 offen offset:2048 sc1
    v_mfma_f32_16x16x32_bf16 v[208:211], a[72:75], v[64:67], v[208:211]
    v_permlane16_swap_b32 v24, v25
    v_mfma_f32_16x16x32_bf16 v[212:215], a[76:79], v[64:67], v[212:215]
    v_permlane16_swap_b32_e64 v26, v27
    v_mfma_f32_16x16x32_bf16 v[216:219], a[80:83], v[64:67], v[216:219]
    s_waitcnt lgkmcnt(4)
    ds_read_b64 v[80:81], v4 offset:14336
    ds_read_b64 v[82:83], v4 offset:14592
    v_mfma_f32_16x16x32_bf16 v[220:223], a[72:75], v[68:71], v[220:223]
    buffer_store_dwordx4 v[24:27], v8, s[8:11], s70 offen sc1
    v_mfma_f32_16x16x32_bf16 v[224:227], a[76:79], v[68:71], v[224:227]
    ds_read_b64 v[84:85], v5 offset:14336
    ds_read_b64 v[86:87], v5 offset:14592
    v_mfma_f32_16x16x32_bf16 v[228:231], a[80:83], v[68:71], v[228:231]
    s_waitcnt lgkmcnt(6)
    ds_read_b64 v[88:89], v6 offset:14336
    ds_read_b64 v[90:91], v6 offset:14592
    v_mfma_f32_16x16x32_bf16 v[232:235], a[72:75], v[72:75], v[232:235]
    ds_read_b64 v[92:93], v7 offset:14336
    ds_read_b64 v[94:95], v7 offset:14592
    v_mfma_f32_16x16x32_bf16 v[236:239], a[76:79], v[72:75], v[236:239]
    v_mfma_f32_16x16x32_bf16 v[240:243], a[80:83], v[72:75], v[240:243]
    s_waitcnt lgkmcnt(8)
    v_mfma_f32_16x16x32_bf16 v[244:247], a[72:75], v[76:79], v[244:247]
    v_mfma_f32_16x16x32_bf16 v[248:251], a[76:79], v[76:79], v[248:251]
    buffer_load_dwordx4 a[24:27], v14, s[8:11], s88 offen offset:2048 sc1
    v_mfma_f32_16x16x32_bf16 v[252:255], a[80:83], v[76:79], v[252:255]
    s_waitcnt lgkmcnt(6)
    v_mfma_f32_16x16x32_bf16 v[208:211], a[84:87], v[80:83], v[208:211]
    ds_read_b64 v[64:65], v4 offset:16384
    ds_read_b64 v[66:67], v4 offset:16640
    v_mfma_f32_16x16x32_bf16 v[212:215], a[88:91], v[80:83], v[212:215]
    ds_read_b64 v[68:69], v5 offset:16384
    ds_read_b64 v[70:71], v5 offset:16640
    v_mfma_f32_16x16x32_bf16 v[216:219], a[92:95], v[80:83], v[216:219]
    s_waitcnt lgkmcnt(8)
    buffer_load_dwordx4 a[28:31], v14, s[8:11], s84 offen offset:3072 sc1
    v_mfma_f32_16x16x32_bf16 v[220:223], a[84:87], v[84:87], v[220:223]
    ds_read_b64 v[72:73], v6 offset:16384
    ds_read_b64 v[74:75], v6 offset:16640
    v_mfma_f32_16x16x32_bf16 v[224:227], a[88:91], v[84:87], v[224:227]
    ds_read_b64 v[76:77], v7 offset:16384
    ds_read_b64 v[78:79], v7 offset:16640
    v_mfma_f32_16x16x32_bf16 v[228:231], a[92:95], v[84:87], v[228:231]
    s_waitcnt lgkmcnt(10)
    v_mfma_f32_16x16x32_bf16 v[232:235], a[84:87], v[88:91], v[232:235]
    buffer_load_dwordx4 a[32:35], v14, s[8:11], s85 offen offset:3072 sc1
    v_mfma_f32_16x16x32_bf16 v[236:239], a[88:91], v[88:91], v[236:239]
    v_mfma_f32_16x16x32_bf16 v[240:243], a[92:95], v[88:91], v[240:243]
    s_waitcnt lgkmcnt(8)
    v_mfma_f32_16x16x32_bf16 v[244:247], a[84:87], v[92:95], v[244:247]
    v_mfma_f32_16x16x32_bf16 v[248:251], a[88:91], v[92:95], v[248:251]
    buffer_load_dwordx4 a[36:39], v14, s[8:11], s86 offen offset:3072 sc1
    v_mfma_f32_16x16x32_bf16 v[252:255], a[92:95], v[92:95], v[252:255]
    s_waitcnt lgkmcnt(6)
    v_mfma_f32_16x16x32_bf16 v[208:211], a[96:99], v[64:67], v[208:211]
    ds_read_b64 v[80:81], v4 offset:18432
    ds_read_b64 v[82:83], v4 offset:18688
    v_mfma_f32_16x16x32_bf16 v[212:215], a[100:103], v[64:67], v[212:215]
    ds_read_b64 v[84:85], v5 offset:18432
    ds_read_b64 v[86:87], v5 offset:18688
    v_mfma_f32_16x16x32_bf16 v[216:219], a[104:107], v[64:67], v[216:219]
    s_waitcnt lgkmcnt(8)
    buffer_load_dwordx4 a[40:43], v14, s[8:11], s87 offen offset:3072 sc1
    v_mfma_f32_16x16x32_bf16 v[220:223], a[96:99], v[68:71], v[220:223]
    ds_read_b64 v[88:89], v6 offset:18432
    ds_read_b64 v[90:91], v6 offset:18688
    v_mfma_f32_16x16x32_bf16 v[224:227], a[100:103], v[68:71], v[224:227]
    ds_read_b64 v[92:93], v7 offset:18432
    ds_read_b64 v[94:95], v7 offset:18688
    v_mfma_f32_16x16x32_bf16 v[228:231], a[104:107], v[68:71], v[228:231]
    s_waitcnt lgkmcnt(10)
    v_mfma_f32_16x16x32_bf16 v[232:235], a[96:99], v[72:75], v[232:235]
    buffer_load_dwordx4 a[44:47], v14, s[8:11], s88 offen offset:3072 sc1
    v_mfma_f32_16x16x32_bf16 v[236:239], a[100:103], v[72:75], v[236:239]
    v_mfma_f32_16x16x32_bf16 v[240:243], a[104:107], v[72:75], v[240:243]
    s_waitcnt lgkmcnt(8)
    v_mfma_f32_16x16x32_bf16 v[244:247], a[96:99], v[76:79], v[244:247]
    v_mfma_f32_16x16x32_bf16 v[248:251], a[100:103], v[76:79], v[248:251]
    buffer_load_dwordx4 a[48:51], v15, s[8:11], s84 offen offset:0 sc1
    v_mfma_f32_16x16x32_bf16 v[252:255], a[104:107], v[76:79], v[252:255]
    s_waitcnt lgkmcnt(6)
    v_mfma_f32_16x16x32_bf16 v[208:211], a[108:111], v[80:83], v[208:211]
    ds_read_b64 v[64:65], v4 offset:20480
    ds_read_b64 v[66:67], v4 offset:20736
    v_mfma_f32_16x16x32_bf16 v[212:215], a[112:115], v[80:83], v[212:215]
    ds_read_b64 v[68:69], v5 offset:20480
    ds_read_b64 v[70:71], v5 offset:20736
    v_mfma_f32_16x16x32_bf16 v[216:219], a[116:119], v[80:83], v[216:219]
    s_waitcnt lgkmcnt(8)
    buffer_load_dwordx4 a[52:55], v15, s[8:11], s85 offen offset:0 sc1
    v_mfma_f32_16x16x32_bf16 v[220:223], a[108:111], v[84:87], v[220:223]
    ds_read_b64 v[72:73], v6 offset:20480
    ds_read_b64 v[74:75], v6 offset:20736
    v_mfma_f32_16x16x32_bf16 v[224:227], a[112:115], v[84:87], v[224:227]
    ds_read_b64 v[76:77], v7 offset:20480
    ds_read_b64 v[78:79], v7 offset:20736
    v_mfma_f32_16x16x32_bf16 v[228:231], a[116:119], v[84:87], v[228:231]
    s_waitcnt lgkmcnt(10)
    v_mfma_f32_16x16x32_bf16 v[232:235], a[108:111], v[88:91], v[232:235]
    buffer_load_dwordx4 a[56:59], v15, s[8:11], s86 offen offset:0 sc1
    v_mfma_f32_16x16x32_bf16 v[236:239], a[112:115], v[88:91], v[236:239]
    v_mfma_f32_16x16x32_bf16 v[240:243], a[116:119], v[88:91], v[240:243]
    s_waitcnt lgkmcnt(8)
    v_mfma_f32_16x16x32_bf16 v[244:247], a[108:111], v[92:95], v[244:247]
    v_mfma_f32_16x16x32_bf16 v[248:251], a[112:115], v[92:95], v[248:251]
    buffer_load_dwordx4 a[60:63], v15, s[8:11], s87 offen offset:0 sc1
    v_mfma_f32_16x16x32_bf16 v[252:255], a[116:119], v[92:95], v[252:255]
    s_waitcnt lgkmcnt(6)
    v_mfma_f32_16x16x32_bf16 v[208:211], a[120:123], v[64:67], v[208:211]
    ds_read_b64 v[80:81], v4 offset:22528
    ds_read_b64 v[82:83], v4 offset:22784
    v_mfma_f32_16x16x32_bf16 v[212:215], a[124:127], v[64:67], v[212:215]
    ds_read_b64 v[84:85], v5 offset:22528
    ds_read_b64 v[86:87], v5 offset:22784
    v_mfma_f32_16x16x32_bf16 v[216:219], a[128:131], v[64:67], v[216:219]
    s_waitcnt lgkmcnt(8)
    buffer_load_dwordx4 a[64:67], v15, s[8:11], s88 offen offset:0 sc1
    v_mfma_f32_16x16x32_bf16 v[220:223], a[120:123], v[68:71], v[220:223]
    ds_read_b64 v[88:89], v6 offset:22528
    ds_read_b64 v[90:91], v6 offset:22784
    v_mfma_f32_16x16x32_bf16 v[224:227], a[124:127], v[68:71], v[224:227]
    ds_read_b64 v[92:93], v7 offset:22528
    ds_read_b64 v[94:95], v7 offset:22784
    v_mfma_f32_16x16x32_bf16 v[228:231], a[128:131], v[68:71], v[228:231]
    s_waitcnt lgkmcnt(10)
    v_mfma_f32_16x16x32_bf16 v[232:235], a[120:123], v[72:75], v[232:235]
    buffer_load_dwordx4 a[68:71], v15, s[8:11], s84 offen offset:1024 sc1
    v_mfma_f32_16x16x32_bf16 v[236:239], a[124:127], v[72:75], v[236:239]
    s_waitcnt vmcnt(12)
    v_mfma_f32_16x16x32_bf16 v[240:243], a[128:131], v[72:75], v[240:243]
    s_waitcnt lgkmcnt(8)
    v_mfma_f32_16x16x32_bf16 v[244:247], a[120:123], v[76:79], v[244:247]
    buffer_store_dword v14, v3, s[8:11], s54 offen sc1
    s_add_u32 s54, s54, 262144
    v_mfma_f32_16x16x32_bf16 v[248:251], a[124:127], v[76:79], v[248:251]
    s_add_u32 s53, s53, 393216
    s_add_u32 s69, s69, 393216
    s_add_u32 s70, s70, 393216
    v_mfma_f32_16x16x32_bf16 v[252:255], a[128:131], v[76:79], v[252:255]
    s_waitcnt lgkmcnt(6)
    v_mfma_f32_16x16x32_bf16 v[208:211], a[132:135], v[80:83], v[208:211]
    ds_read_b64 v[64:65], v4 offset:24576
    ds_read_b64 v[66:67], v4 offset:24832
    v_mfma_f32_16x16x32_bf16 v[212:215], a[136:139], v[80:83], v[212:215]
    buffer_load_dwordx4 a[72:75], v15, s[8:11], s85 offen offset:1024 sc1
    v_mfma_f32_16x16x32_bf16 v[216:219], a[140:143], v[80:83], v[216:219]
    s_waitcnt lgkmcnt(6)
    ds_read_b64 v[68:69], v5 offset:24576
    ds_read_b64 v[70:71], v5 offset:24832
    v_mfma_f32_16x16x32_bf16 v[220:223], a[132:135], v[84:87], v[220:223]
    ds_read_b64 v[72:73], v6 offset:24576
    ds_read_b64 v[74:75], v6 offset:24832
    v_mfma_f32_16x16x32_bf16 v[224:227], a[136:139], v[84:87], v[224:227]
    ds_read_b64 v[76:77], v7 offset:24576
    ds_read_b64 v[78:79], v7 offset:24832
    v_mfma_f32_16x16x32_bf16 v[228:231], a[140:143], v[84:87], v[228:231]
    s_waitcnt lgkmcnt(10)
    buffer_load_dwordx4 a[128:131], v13, s[8:11], s56 offen offset:0 sc1
    v_mfma_f32_16x16x32_bf16 v[232:235], a[132:135], v[88:91], v[232:235]
    v_mfma_f32_16x16x32_bf16 v[236:239], a[136:139], v[88:91], v[236:239]
    v_mfma_f32_16x16x32_bf16 v[240:243], a[140:143], v[88:91], v[240:243]
    s_waitcnt lgkmcnt(8)
    v_mfma_f32_16x16x32_bf16 v[244:247], a[132:135], v[92:95], v[244:247]
    v_mfma_f32_16x16x32_bf16 v[248:251], a[136:139], v[92:95], v[248:251]
    buffer_load_dwordx4 a[132:135], v13, s[8:11], s57 offen offset:0 sc1
    v_mfma_f32_16x16x32_bf16 v[252:255], a[140:143], v[92:95], v[252:255]
    s_waitcnt lgkmcnt(6)
    v_mfma_f32_16x16x32_bf16 v[208:211], a[144:147], v[64:67], v[208:211]
    ds_read_b64 v[80:81], v4 offset:26624
    ds_read_b64 v[82:83], v4 offset:26880
    v_mfma_f32_16x16x32_bf16 v[212:215], a[148:151], v[64:67], v[212:215]
    ds_read_b64 v[84:85], v5 offset:26624
    ds_read_b64 v[86:87], v5 offset:26880
    v_mfma_f32_16x16x32_bf16 v[216:219], a[152:155], v[64:67], v[216:219]
    s_waitcnt lgkmcnt(8)
    buffer_load_dwordx4 a[136:139], v13, s[8:11], s56 offen offset:1024 sc1
    v_mfma_f32_16x16x32_bf16 v[220:223], a[144:147], v[68:71], v[220:223]
    ds_read_b64 v[88:89], v6 offset:26624
    ds_read_b64 v[90:91], v6 offset:26880
    v_mfma_f32_16x16x32_bf16 v[224:227], a[148:151], v[68:71], v[224:227]
    ds_read_b64 v[92:93], v7 offset:26624
    ds_read_b64 v[94:95], v7 offset:26880
    v_mfma_f32_16x16x32_bf16 v[228:231], a[152:155], v[68:71], v[228:231]
    s_waitcnt lgkmcnt(10)
    v_mfma_f32_16x16x32_bf16 v[232:235], a[144:147], v[72:75], v[232:235]
    buffer_load_dwordx4 a[140:143], v13, s[8:11], s57 offen offset:1024 sc1
    v_mfma_f32_16x16x32_bf16 v[236:239], a[148:151], v[72:75], v[236:239]
    v_mfma_f32_16x16x32_bf16 v[240:243], a[152:155], v[72:75], v[240:243]
    s_waitcnt lgkmcnt(8)
    v_mfma_f32_16x16x32_bf16 v[244:247], a[144:147], v[76:79], v[244:247]
    v_mfma_f32_16x16x32_bf16 v[248:251], a[148:151], v[76:79], v[248:251]
    buffer_load_dwordx4 a[144:147], v13, s[8:11], s56 offen offset:2048 sc1
    v_mfma_f32_16x16x32_bf16 v[252:255], a[152:155], v[76:79], v[252:255]
    s_waitcnt lgkmcnt(6)
    v_mfma_f32_16x16x32_bf16 v[208:211], a[156:159], v[80:83], v[208:211]
    ds_read_b64 v[64:65], v4 offset:28672
    ds_read_b64 v[66:67], v4 offset:28928
    v_mfma_f32_16x16x32_bf16 v[212:215], a[160:163], v[80:83], v[212:215]
    ds_read_b64 v[68:69], v5 offset:28672
    ds_read_b64 v[70:71], v5 offset:28928
    v_mfma_f32_16x16x32_bf16 v[216:219], a[164:167], v[80:83], v[216:219]
    s_waitcnt lgkmcnt(8)
    buffer_load_dwordx4 a[148:151], v13, s[8:11], s57 offen offset:2048 sc1
    v_mfma_f32_16x16x32_bf16 v[220:223], a[156:159], v[84:87], v[220:223]
    ds_read_b64 v[72:73], v6 offset:28672
    ds_read_b64 v[74:75], v6 offset:28928
    v_mfma_f32_16x16x32_bf16 v[224:227], a[160:163], v[84:87], v[224:227]
    ds_read_b64 v[76:77], v7 offset:28672
    ds_read_b64 v[78:79], v7 offset:28928
    v_mfma_f32_16x16x32_bf16 v[228:231], a[164:167], v[84:87], v[228:231]
    s_waitcnt lgkmcnt(10)
    v_mfma_f32_16x16x32_bf16 v[232:235], a[156:159], v[88:91], v[232:235]
    buffer_load_dwordx4 a[152:155], v13, s[8:11], s56 offen offset:3072 sc1
    v_mfma_f32_16x16x32_bf16 v[236:239], a[160:163], v[88:91], v[236:239]
    v_mfma_f32_16x16x32_bf16 v[240:243], a[164:167], v[88:91], v[240:243]
    s_waitcnt lgkmcnt(8)
    v_mfma_f32_16x16x32_bf16 v[244:247], a[156:159], v[92:95], v[244:247]
    v_mfma_f32_16x16x32_bf16 v[248:251], a[160:163], v[92:95], v[248:251]
    buffer_load_dwordx4 a[156:159], v13, s[8:11], s57 offen offset:3072 sc1
    v_mfma_f32_16x16x32_bf16 v[252:255], a[164:167], v[92:95], v[252:255]
    s_waitcnt lgkmcnt(6)
    v_mfma_f32_16x16x32_bf16 v[208:211], a[168:171], v[64:67], v[208:211]
    ds_read_b64 v[80:81], v4 offset:30720
    ds_read_b64 v[82:83], v4 offset:30976
    v_mfma_f32_16x16x32_bf16 v[212:215], a[172:175], v[64:67], v[212:215]
    ds_read_b64 v[84:85], v5 offset:30720
    ds_read_b64 v[86:87], v5 offset:30976
    v_mfma_f32_16x16x32_bf16 v[216:219], a[176:179], v[64:67], v[216:219]
    s_waitcnt lgkmcnt(8)
    buffer_load_dwordx4 a[160:163], v14, s[8:11], s56 offen offset:0 sc1
    v_mfma_f32_16x16x32_bf16 v[220:223], a[168:171], v[68:71], v[220:223]
    ds_read_b64 v[88:89], v6 offset:30720
    ds_read_b64 v[90:91], v6 offset:30976
    v_mfma_f32_16x16x32_bf16 v[224:227], a[172:175], v[68:71], v[224:227]
    ds_read_b64 v[92:93], v7 offset:30720
    ds_read_b64 v[94:95], v7 offset:30976
    v_mfma_f32_16x16x32_bf16 v[228:231], a[176:179], v[68:71], v[228:231]
    s_waitcnt lgkmcnt(10)
    v_mfma_f32_16x16x32_bf16 v[232:235], a[168:171], v[72:75], v[232:235]
    buffer_load_dwordx4 a[164:167], v14, s[8:11], s57 offen offset:0 sc1
    v_mfma_f32_16x16x32_bf16 v[236:239], a[172:175], v[72:75], v[236:239]
    v_mfma_f32_16x16x32_bf16 v[240:243], a[176:179], v[72:75], v[240:243]
    s_waitcnt lgkmcnt(8)
    v_mfma_f32_16x16x32_bf16 v[244:247], a[168:171], v[76:79], v[244:247]
    v_mfma_f32_16x16x32_bf16 v[248:251], a[172:175], v[76:79], v[248:251]
    buffer_load_dwordx4 a[168:171], v14, s[8:11], s56 offen offset:1024 sc1
    v_mfma_f32_16x16x32_bf16 v[252:255], a[176:179], v[76:79], v[252:255]
    s_waitcnt lgkmcnt(6)
    v_mfma_f32_16x16x32_bf16 v[208:211], a[180:183], v[80:83], v[208:211]
    ds_read_b64 v[64:65], v4 offset:32768
    ds_read_b64 v[66:67], v4 offset:33024
    v_mfma_f32_16x16x32_bf16 v[212:215], a[184:187], v[80:83], v[212:215]
    ds_read_b64 v[68:69], v5 offset:32768
    ds_read_b64 v[70:71], v5 offset:33024
    v_mfma_f32_16x16x32_bf16 v[216:219], a[188:191], v[80:83], v[216:219]
    s_waitcnt lgkmcnt(8)
    buffer_load_dwordx4 a[172:175], v14, s[8:11], s57 offen offset:1024 sc1
    v_mfma_f32_16x16x32_bf16 v[220:223], a[180:183], v[84:87], v[220:223]
    ds_read_b64 v[72:73], v6 offset:32768
    ds_read_b64 v[74:75], v6 offset:33024
    v_mfma_f32_16x16x32_bf16 v[224:227], a[184:187], v[84:87], v[224:227]
    ds_read_b64 v[76:77], v7 offset:32768
    ds_read_b64 v[78:79], v7 offset:33024
    v_mfma_f32_16x16x32_bf16 v[228:231], a[188:191], v[84:87], v[228:231]
    s_waitcnt lgkmcnt(10)
    v_mfma_f32_16x16x32_bf16 v[232:235], a[180:183], v[88:91], v[232:235]
    buffer_load_dwordx4 a[176:179], v14, s[8:11], s56 offen offset:2048 sc1
    v_mfma_f32_16x16x32_bf16 v[236:239], a[184:187], v[88:91], v[236:239]
    v_mfma_f32_16x16x32_bf16 v[240:243], a[188:191], v[88:91], v[240:243]
    s_waitcnt lgkmcnt(8)
    v_mfma_f32_16x16x32_bf16 v[244:247], a[180:183], v[92:95], v[244:247]
    v_mfma_f32_16x16x32_bf16 v[248:251], a[184:187], v[92:95], v[248:251]
    buffer_load_dwordx4 a[180:183], v14, s[8:11], s57 offen offset:2048 sc1
    v_mfma_f32_16x16x32_bf16 v[252:255], a[188:191], v[92:95], v[252:255]
    s_waitcnt lgkmcnt(6)
    v_mfma_f32_16x16x32_bf16 v[208:211], a[192:195], v[64:67], v[208:211]
    ds_read_b64 v[80:81], v4 offset:34816
    ds_read_b64 v[82:83], v4 offset:35072
    v_mfma_f32_16x16x32_bf16 v[212:215], a[196:199], v[64:67], v[212:215]
    ds_read_b64 v[84:85], v5 offset:34816
    ds_read_b64 v[86:87], v5 offset:35072
    v_mfma_f32_16x16x32_bf16 v[216:219], a[200:203], v[64:67], v[216:219]
    s_waitcnt lgkmcnt(8)
    buffer_load_dwordx4 a[184:187], v14, s[8:11], s56 offen offset:3072 sc1
    v_mfma_f32_16x16x32_bf16 v[220:223], a[192:195], v[68:71], v[220:223]
    ds_read_b64 v[88:89], v6 offset:34816
    ds_read_b64 v[90:91], v6 offset:35072
    v_mfma_f32_16x16x32_bf16 v[224:227], a[196:199], v[68:71], v[224:227]
    ds_read_b64 v[92:93], v7 offset:34816
    ds_read_b64 v[94:95], v7 offset:35072
    v_mfma_f32_16x16x32_bf16 v[228:231], a[200:203], v[68:71], v[228:231]
    s_waitcnt lgkmcnt(10)
    v_mfma_f32_16x16x32_bf16 v[232:235], a[192:195], v[72:75], v[232:235]
    buffer_load_dwordx4 a[188:191], v14, s[8:11], s57 offen offset:3072 sc1
    v_mfma_f32_16x16x32_bf16 v[236:239], a[196:199], v[72:75], v[236:239]
    v_mfma_f32_16x16x32_bf16 v[240:243], a[200:203], v[72:75], v[240:243]
    s_waitcnt lgkmcnt(8)
    v_mfma_f32_16x16x32_bf16 v[244:247], a[192:195], v[76:79], v[244:247]
    v_mfma_f32_16x16x32_bf16 v[248:251], a[196:199], v[76:79], v[248:251]
    buffer_load_dwordx4 a[192:195], v15, s[8:11], s56 offen offset:0 sc1
    v_mfma_f32_16x16x32_bf16 v[252:255], a[200:203], v[76:79], v[252:255]
    s_waitcnt lgkmcnt(6)
    v_mfma_f32_16x16x32_bf16 v[208:211], a[204:207], v[80:83], v[208:211]
    ds_read_b64 v[64:65], v4 offset:36864
    ds_read_b64 v[66:67], v4 offset:37120
    v_mfma_f32_16x16x32_bf16 v[212:215], a[208:211], v[80:83], v[212:215]
    ds_read_b64 v[68:69], v5 offset:36864
    ds_read_b64 v[70:71], v5 offset:37120
    v_mfma_f32_16x16x32_bf16 v[216:219], a[212:215], v[80:83], v[216:219]
    s_waitcnt lgkmcnt(8)
    buffer_load_dwordx4 a[196:199], v15, s[8:11], s57 offen offset:0 sc1
    v_mfma_f32_16x16x32_bf16 v[220:223], a[204:207], v[84:87], v[220:223]
    ds_read_b64 v[72:73], v6 offset:36864
    ds_read_b64 v[74:75], v6 offset:37120
    v_mfma_f32_16x16x32_bf16 v[224:227], a[208:211], v[84:87], v[224:227]
    ds_read_b64 v[76:77], v7 offset:36864
    ds_read_b64 v[78:79], v7 offset:37120
    v_mfma_f32_16x16x32_bf16 v[228:231], a[212:215], v[84:87], v[228:231]
    s_waitcnt lgkmcnt(10)
    v_mfma_f32_16x16x32_bf16 v[232:235], a[204:207], v[88:91], v[232:235]
    buffer_load_dwordx4 a[200:203], v15, s[8:11], s56 offen offset:1024 sc1
    v_mfma_f32_16x16x32_bf16 v[236:239], a[208:211], v[88:91], v[236:239]
    v_mfma_f32_16x16x32_bf16 v[240:243], a[212:215], v[88:91], v[240:243]
    s_waitcnt lgkmcnt(8)
    v_mfma_f32_16x16x32_bf16 v[244:247], a[204:207], v[92:95], v[244:247]
    v_mfma_f32_16x16x32_bf16 v[248:251], a[208:211], v[92:95], v[248:251]
    buffer_load_dwordx4 a[204:207], v15, s[8:11], s57 offen offset:1024 sc1
    v_mfma_f32_16x16x32_bf16 v[252:255], a[212:215], v[92:95], v[252:255]
    s_waitcnt lgkmcnt(6)
    v_mfma_f32_16x16x32_bf16 v[208:211], a[216:219], v[64:67], v[208:211]
    ds_read_b64 v[80:81], v4 offset:38912
    ds_read_b64 v[82:83], v4 offset:39168
    v_mfma_f32_16x16x32_bf16 v[212:215], a[220:223], v[64:67], v[212:215]
    ds_read_b64 v[84:85], v5 offset:38912
    ds_read_b64 v[86:87], v5 offset:39168
    v_mfma_f32_16x16x32_bf16 v[216:219], a[224:227], v[64:67], v[216:219]
    s_waitcnt lgkmcnt(8)
    buffer_load_dwordx4 a[208:211], v15, s[8:11], s56 offen offset:2048 sc1
    v_mfma_f32_16x16x32_bf16 v[220:223], a[216:219], v[68:71], v[220:223]
    ds_read_b64 v[88:89], v6 offset:38912
    ds_read_b64 v[90:91], v6 offset:39168
    v_mfma_f32_16x16x32_bf16 v[224:227], a[220:223], v[68:71], v[224:227]
    ds_read_b64 v[92:93], v7 offset:38912
    ds_read_b64 v[94:95], v7 offset:39168
    v_mfma_f32_16x16x32_bf16 v[228:231], a[224:227], v[68:71], v[228:231]
    s_waitcnt lgkmcnt(10)
    v_mfma_f32_16x16x32_bf16 v[232:235], a[216:219], v[72:75], v[232:235]
    buffer_load_dword v12, v11, s[8:11], s55 offen sc1
    v_mfma_f32_16x16x32_bf16 v[236:239], a[220:223], v[72:75], v[236:239]
    v_mfma_f32_16x16x32_bf16 v[240:243], a[224:227], v[72:75], v[240:243]
    s_waitcnt lgkmcnt(8)
    v_mfma_f32_16x16x32_bf16 v[244:247], a[216:219], v[76:79], v[244:247]
    buffer_load_dwordx4 a[212:215], v15, s[8:11], s57 offen offset:2048 sc1
    v_mfma_f32_16x16x32_bf16 v[248:251], a[220:223], v[76:79], v[248:251]
    v_mfma_f32_16x16x32_bf16 v[252:255], a[224:227], v[76:79], v[252:255]
    s_waitcnt lgkmcnt(6)
    v_mfma_f32_16x16x32_bf16 v[208:211], a[228:231], v[80:83], v[208:211]
    v_mfma_f32_16x16x32_bf16 v[212:215], a[232:235], v[80:83], v[212:215]
    buffer_load_dwordx4 a[216:219], v15, s[8:11], s56 offen offset:3072 sc1
    v_mfma_f32_16x16x32_bf16 v[216:219], a[236:239], v[80:83], v[216:219]
    s_waitcnt lgkmcnt(4)
    v_mfma_f32_16x16x32_bf16 v[220:223], a[228:231], v[84:87], v[220:223]
    v_mfma_f32_16x16x32_bf16 v[224:227], a[232:235], v[84:87], v[224:227]
    v_mfma_f32_16x16x32_bf16 v[228:231], a[236:239], v[84:87], v[228:231]
    s_waitcnt lgkmcnt(2)
    buffer_load_dwordx4 a[220:223], v15, s[8:11], s57 offen offset:3072 sc1
    v_mfma_f32_16x16x32_bf16 v[232:235], a[228:231], v[88:91], v[232:235]
    v_mfma_f32_16x16x32_bf16 v[236:239], a[232:235], v[88:91], v[236:239]
    v_mfma_f32_16x16x32_bf16 v[240:243], a[236:239], v[88:91], v[240:243]
    s_waitcnt lgkmcnt(0)
    v_mfma_f32_16x16x32_bf16 v[244:247], a[228:231], v[92:95], v[244:247]
    buffer_load_dwordx4 a[76:79], v15, s[8:11], s86 offen offset:1024 sc1
    v_mfma_f32_16x16x32_bf16 v[248:251], a[232:235], v[92:95], v[248:251]
    v_mfma_f32_16x16x32_bf16 v[252:255], a[236:239], v[92:95], v[252:255]
    v_max_f32 v208, 0, v208
    v_max_f32 v209, 0, v209
    v_pk_mul_f32 v[208:209], v[208:209], v[210:211]
    v_cvt_pk_bf16_f32 v208, v208, v209
    v_max_f32 v220, 0, v220
    v_max_f32 v221, 0, v221
    v_pk_mul_f32 v[220:221], v[220:221], v[222:223]
    v_cvt_pk_bf16_f32 v209, v220, v221
    v_max_f32 v232, 0, v232
    v_max_f32 v233, 0, v233
    v_pk_mul_f32 v[232:233], v[232:233], v[234:235]
    v_cvt_pk_bf16_f32 v210, v232, v233
    v_max_f32 v244, 0, v244
    v_max_f32 v245, 0, v245
    v_pk_mul_f32 v[244:245], v[244:245], v[246:247]
    v_cvt_pk_bf16_f32 v211, v244, v245
    v_max_f32 v212, 0, v212
    v_max_f32 v213, 0, v213
    v_permlane32_swap_b32_e64 v208, v210
    v_pk_mul_f32 v[212:213], v[212:213], v[214:215]
    v_cvt_pk_bf16_f32 v212, v212, v213
    v_permlane32_swap_b32 v209, v211
    v_max_f32 v224, 0, v224
    v_max_f32 v225, 0, v225
    v_permlane16_swap_b32 v208, v209
    v_pk_mul_f32 v[224:225], v[224:225], v[226:227]
    v_cvt_pk_bf16_f32 v213, v224, v225
    v_permlane16_swap_b32 v210, v211
    v_max_f32 v236, 0, v236
    v_max_f32_e64 v237, 0, v237
    buffer_store_dwordx4 v[208:211], v8, s[8:11], s53 offen sc1
    v_pk_mul_f32 v[236:237], v[236:237], v[238:239]
    v_cvt_pk_bf16_f32 v214, v236, v237
    v_max_f32 v248, 0, v248
    v_max_f32 v249, 0, v249
    v_pk_mul_f32 v[248:249], v[248:249], v[250:251]
    v_cvt_pk_bf16_f32 v215, v248, v249
    v_max_f32 v216, 0, v216
    v_max_f32 v217, 0, v217
    v_permlane32_swap_b32_e64 v212, v214
    v_pk_mul_f32 v[216:217], v[216:217], v[218:219]
    v_cvt_pk_bf16_f32 v216, v216, v217
    v_permlane32_swap_b32 v213, v215
    v_max_f32 v228, 0, v228
    v_max_f32 v229, 0, v229
    v_permlane16_swap_b32 v212, v213
    v_pk_mul_f32 v[228:229], v[228:229], v[230:231]
    v_cvt_pk_bf16_f32 v217, v228, v229
    v_permlane16_swap_b32 v214, v215
    v_max_f32 v240, 0, v240
    v_max_f32_e64 v241, 0, v241
    buffer_store_dwordx4 v[212:215], v8, s[8:11], s69 offen sc1
    v_pk_mul_f32 v[240:241], v[240:241], v[242:243]
    v_cvt_pk_bf16_f32 v218, v240, v241
    v_max_f32 v252, 0, v252
    v_max_f32 v253, 0, v253
    v_pk_mul_f32 v[252:253], v[252:253], v[254:255]
    v_cvt_pk_bf16_f32 v219, v252, v253
    v_permlane32_swap_b32 v216, v218
    s_nop 0
    v_permlane32_swap_b32 v217, v219
    s_nop 1
    v_permlane16_swap_b32 v216, v217
    v_permlane16_swap_b32 v218, v219
    buffer_store_dwordx4 v[216:219], v8, s[8:11], s70 offen sc1
    s_lshr_b32 s48, s3, 1
    s_mul_i32 s48, s48, 81920
    s_add_u32 s48, s48, s59
    s_sub_u32 s48, s48, 81920
    s_and_b32 s49, s3, 1
    s_lshl_b32 s49, s49, 7
    v_xor_b32 v8, s49, v4
    v_add_u32 v8, s48, v8
    v_and_b32 v4, 1, v2
    v_lshlrev_b32 v4, 3, v4
    v_xor_b32 v4, v4, v1
    v_lshlrev_b32 v4, 4, v4
    v_lshl_add_u32 v4, v2, 9, v4
    s_mul_i32 s48, s3, 10240
    s_add_u32 s48, s48, s59
    v_add_u32 v4, s48, v4
    v_add_u32 v5, 81920, v4
    ds_read_b64 v[208:209], v4 offset:0
    ds_read_b64 v[210:211], v4 offset:256
    ds_read_b64 v[212:213], v4 offset:8
    ds_read_b64 v[214:215], v4 offset:264
    ds_read_b64 v[216:217], v5 offset:0
    ds_read_b64 v[218:219], v5 offset:256
    v_cmp_eq_u32 vcc, 0, v2
    v_mov_b32 v10, -1
    v_mov_b32 v9, 0xffff0000
    v_cndmask_b32 v10, v10, v9, vcc
    s_waitcnt vmcnt(28) lgkmcnt(4)
    v_mfma_f32_16x16x32_bf16 v[16:19], a[128:131], v[208:211], 0
    s_waitcnt vmcnt(27)
    ds_read_b64 v[232:233], v8 offset:0
    ds_read_b64 v[220:221], v5 offset:8
    v_mfma_f32_16x16x32_bf16 v[24:27], a[132:135], v[208:211], 0
    s_waitcnt vmcnt(26)
    ds_read_b64 v[234:235], v8 offset:256
    ds_read_b64 v[236:237], v8 offset:2048
    v_mfma_f32_16x16x32_bf16 v[32:35], a[136:139], v[208:211], 0
    s_waitcnt vmcnt(25)
    ds_read_b64 v[222:223], v5 offset:264
    ds_read_b64 v[224:225], v4 offset:2048
    v_mfma_f32_16x16x32_bf16 v[40:43], a[140:143], v[208:211], 0
    s_waitcnt vmcnt(24)
    ds_read_b64 v[238:239], v8 offset:2304
    ds_read_b64 v[226:227], v4 offset:2304
    v_mfma_f32_16x16x32_bf16 v[48:51], a[144:147], v[208:211], 0
    s_waitcnt lgkmcnt(10)
L_pg6703:
    s_cbranch_execz L_hopr6
    s_add_u32 s56, s56, 196608
    buffer_load_dwordx4 a[224:227], v13, s[8:11], s56 offen offset:0 sc1
    s_mov_b32 s56, s100
    s_add_u32 s57, s100, 98304
    v_mfma_f32_16x16x32_bf16 v[20:23], a[128:131], v[212:215], 0
    v_mfma_f32_16x16x32_bf16 v[28:31], a[132:135], v[212:215], 0
    v_mfma_f32_16x16x32_bf16 v[36:39], a[136:139], v[212:215], 0
    buffer_load_dwordx4 a[80:83], v15, s[8:11], s87 offen offset:1024 sc1
    v_mfma_f32_16x16x32_bf16 v[44:47], a[140:143], v[212:215], 0
    s_waitcnt lgkmcnt(7)
    v_and_b32_e64 v232, v10, v232
    ds_read_b64 v[240:241], v8 offset:4096
    v_mfma_f32_16x16x32_bf16 v[52:55], a[144:147], v[212:215], 0
    ds_read_b64 v[242:243], v8 offset:4352
    ds_read_b64 v[244:245], v8 offset:6144
    v_mfma_f32_16x16x32_bf16 v[56:59], a[128:131], v[216:219], 0
    ds_read_b64 v[246:247], v8 offset:6400
    ds_read_b64 v[248:249], v8 offset:8192
    v_mfma_f32_16x16x32_bf16 v[64:67], a[132:135], v[216:219], 0
    buffer_load_dwordx4 a[84:87], v15, s[8:11], s88 offen offset:1024 sc1
    v_mfma_f32_16x16x32_bf16 v[72:75], a[136:139], v[216:219], 0
    ds_read_b64 v[228:229], v4 offset:2056
    ds_read_b64 v[250:251], v8 offset:8448
    v_mfma_f32_16x16x32_bf16 v[80:83], a[140:143], v[216:219], 0
    s_waitcnt lgkmcnt(12)
    ds_read_b64 v[230:231], v4 offset:2312
    v_mfma_f32_16x16x32_bf16 v[252:255], v[232:235], v[232:235], 0
    v_mfma_f32_16x16x32_bf16 v[88:91], a[144:147], v[216:219], 0
    s_waitcnt lgkmcnt(11)
    buffer_load_dwordx4 a[88:91], v15, s[8:11], s84 offen offset:2048 sc1
    v_mfma_f32_16x16x32_bf16 v[60:63], a[128:131], v[220:223], 0
    s_waitcnt lgkmcnt(9)
    ds_read_b64 v[232:233], v8 offset:10240
    ds_read_b64 v[234:235], v8 offset:10496
    v_mfma_f32_16x16x32_bf16 v[252:255], v[236:239], v[236:239], v[252:255]
    ds_read_b64 v[208:209], v5 offset:2048
    ds_read_b64 v[210:211], v5 offset:2304
    v_mfma_f32_16x16x32_bf16 v[68:71], a[132:135], v[220:223], 0
    ds_read_b64 v[236:237], v8 offset:12288
    ds_read_b64 v[238:239], v8 offset:12544
    v_mfma_f32_16x16x32_bf16 v[76:79], a[136:139], v[220:223], 0
    s_waitcnt lgkmcnt(12)
    buffer_load_dwordx4 a[92:95], v15, s[8:11], s85 offen offset:2048 sc1
    v_mfma_f32_16x16x32_bf16 v[252:255], v[240:243], v[240:243], v[252:255]
    v_mfma_f32_16x16x32_bf16 v[84:87], a[140:143], v[220:223], 0
    ds_read_b64 v[240:241], v8 offset:14336
    ds_read_b64 v[242:243], v8 offset:14592
    v_mfma_f32_16x16x32_bf16 v[92:95], a[144:147], v[220:223], 0
    s_waitcnt lgkmcnt(12)
    v_mfma_f32_16x16x32_bf16 v[252:255], v[244:247], v[244:247], v[252:255]
    s_waitcnt vmcnt(28)
    buffer_load_dwordx4 a[96:99], v15, s[8:11], s86 offen offset:2048 sc1
    v_mfma_f32_16x16x32_bf16 v[16:19], a[148:151], v[224:227], v[16:19]
    s_waitcnt vmcnt(28)
    ds_read_b64 v[244:245], v8 offset:16384
    ds_read_b64 v[246:247], v8 offset:16640
    v_mfma_f32_16x16x32_bf16 v[24:27], a[152:155], v[224:227], v[24:27]
    s_waitcnt lgkmcnt(11)
    ds_read_b64 v[212:213], v5 offset:2056
    ds_read_b64 v[214:215], v5 offset:2312
    v_mfma_f32_16x16x32_bf16 v[252:255], v[248:251], v[248:251], v[252:255]
    s_waitcnt vmcnt(27)
    v_mfma_f32_16x16x32_bf16 v[32:35], a[156:159], v[224:227], v[32:35]
    s_waitcnt vmcnt(26)
    buffer_load_dwordx4 a[100:103], v15, s[8:11], s87 offen offset:2048 sc1
    v_mfma_f32_16x16x32_bf16 v[40:43], a[160:163], v[224:227], v[40:43]
    s_waitcnt lgkmcnt(10)
    ds_read_b64 v[248:249], v8 offset:18432
    ds_read_b64 v[250:251], v8 offset:18688
    v_mfma_f32_16x16x32_bf16 v[252:255], v[232:235], v[232:235], v[252:255]
    s_waitcnt vmcnt(26)
    v_mfma_f32_16x16x32_bf16 v[48:51], a[164:167], v[224:227], v[48:51]
    ds_read_b64 v[232:233], v8 offset:20480
    ds_read_b64 v[234:235], v8 offset:20736
    v_mfma_f32_16x16x32_bf16 v[20:23], a[148:151], v[228:231], v[20:23]
    s_waitcnt lgkmcnt(10)
    buffer_load_dwordx4 a[104:107], v15, s[8:11], s88 offen offset:2048 sc1
    v_mfma_f32_16x16x32_bf16 v[252:255], v[236:239], v[236:239], v[252:255]
    ds_read_b64 v[216:217], v4 offset:4096
    ds_read_b64 v[218:219], v4 offset:4352
    v_mfma_f32_16x16x32_bf16 v[28:31], a[152:155], v[228:231], v[28:31]
    ds_read_b64 v[236:237], v8 offset:22528
    ds_read_b64 v[238:239], v8 offset:22784
    v_mfma_f32_16x16x32_bf16 v[36:39], a[156:159], v[228:231], v[36:39]
    s_waitcnt lgkmcnt(12)
    v_mfma_f32_16x16x32_bf16 v[252:255], v[240:243], v[240:243], v[252:255]
    buffer_load_dwordx4 a[108:111], v15, s[8:11], s84 offen offset:3072 sc1
    v_mfma_f32_16x16x32_bf16 v[44:47], a[160:163], v[228:231], v[44:47]
    ds_read_b64 v[240:241], v8 offset:24576
    ds_read_b64 v[242:243], v8 offset:24832
    v_mfma_f32_16x16x32_bf16 v[52:55], a[164:167], v[228:231], v[52:55]
    s_waitcnt lgkmcnt(12)
    v_mfma_f32_16x16x32_bf16 v[252:255], v[244:247], v[244:247], v[252:255]
    v_mfma_f32_16x16x32_bf16 v[56:59], a[148:151], v[208:211], v[56:59]
    buffer_load_dwordx4 a[112:115], v15, s[8:11], s85 offen offset:3072 sc1
    v_mfma_f32_16x16x32_bf16 v[64:67], a[152:155], v[208:211], v[64:67]
    s_waitcnt lgkmcnt(8)
    ds_read_b64 v[244:245], v8 offset:26624
    ds_read_b64 v[246:247], v8 offset:26880
    v_mfma_f32_16x16x32_bf16 v[252:255], v[248:251], v[248:251], v[252:255]
    ds_read_b64 v[220:221], v4 offset:4104
    ds_read_b64 v[222:223], v4 offset:4360
    v_mfma_f32_16x16x32_bf16 v[72:75], a[156:159], v[208:211], v[72:75]
    ds_read_b64 v[248:249], v8 offset:28672
    ds_read_b64 v[250:251], v8 offset:28928
    v_mfma_f32_16x16x32_bf16 v[80:83], a[160:163], v[208:211], v[80:83]
    s_waitcnt lgkmcnt(12)
    buffer_load_dwordx4 a[116:119], v15, s[8:11], s86 offen offset:3072 sc1
    v_mfma_f32_16x16x32_bf16 v[252:255], v[232:235], v[232:235], v[252:255]
    v_mfma_f32_16x16x32_bf16 v[88:91], a[164:167], v[208:211], v[88:91]
    ds_read_b64 v[232:233], v8 offset:30720
    ds_read_b64 v[234:235], v8 offset:30976
    v_mfma_f32_16x16x32_bf16 v[60:63], a[148:151], v[212:215], v[60:63]
    s_waitcnt lgkmcnt(10)
    v_mfma_f32_16x16x32_bf16 v[252:255], v[236:239], v[236:239], v[252:255]
    buffer_load_dwordx4 a[120:123], v15, s[8:11], s87 offen offset:3072 sc1
    v_mfma_f32_16x16x32_bf16 v[68:71], a[152:155], v[212:215], v[68:71]
    ds_read_b64 v[236:237], v8 offset:32768
    ds_read_b64 v[224:225], v5 offset:4096
    v_mfma_f32_16x16x32_bf16 v[76:79], a[156:159], v[212:215], v[76:79]
    s_waitcnt lgkmcnt(10)
    ds_read_b64 v[238:239], v8 offset:33024
    ds_read_b64 v[226:227], v5 offset:4352
    v_mfma_f32_16x16x32_bf16 v[252:255], v[240:243], v[240:243], v[252:255]
    v_mfma_f32_16x16x32_bf16 v[84:87], a[160:163], v[212:215], v[84:87]
    buffer_load_dwordx4 a[124:127], v15, s[8:11], s88 offen offset:3072 sc1
    v_mfma_f32_16x16x32_bf16 v[92:95], a[164:167], v[212:215], v[92:95]
    s_waitcnt lgkmcnt(10)
    ds_read_b64 v[240:241], v8 offset:34816
    ds_read_b64 v[242:243], v8 offset:35072
    v_mfma_f32_16x16x32_bf16 v[252:255], v[244:247], v[244:247], v[252:255]
    s_waitcnt vmcnt(31)
    ds_read_b64 v[228:229], v5 offset:4104
    ds_read_b64 v[230:231], v5 offset:4360
    v_mfma_f32_16x16x32_bf16 v[16:19], a[168:171], v[216:219], v[16:19]
    s_waitcnt vmcnt(30)
    ds_read_b64 v[244:245], v8 offset:36864
    ds_read_b64 v[246:247], v8 offset:37120
    v_mfma_f32_16x16x32_bf16 v[24:27], a[172:175], v[216:219], v[24:27]
    s_waitcnt lgkmcnt(12)
    v_mfma_f32_16x16x32_bf16 v[252:255], v[248:251], v[248:251], v[252:255]
    s_waitcnt vmcnt(29)
    s_waitcnt vmcnt(20)
    v_cmp_eq_u32 vcc, 0, v12
    v_mfma_f32_16x16x32_bf16 v[32:35], a[176:179], v[216:219], v[32:35]
    s_cbranch_vccnz L_slow10
L_back10:
    s_waitcnt vmcnt(13)
    ds_read_b64 v[248:249], v8 offset:38912
    v_mfma_f32_16x16x32_bf16 v[40:43], a[180:183], v[216:219], v[40:43]
    s_waitcnt lgkmcnt(11)
    buffer_store_dword v14, v3, s[8:11], s54 offen sc1
    v_mfma_f32_16x16x32_bf16 v[252:255], v[232:235], v[232:235], v[252:255]
    s_add_u32 s55, s55, 262144
    buffer_load_dwordx4 a[228:231], v13, s[8:11], s56 offen offset:0 sc1
    v_mfma_f32_16x16x32_bf16 v[48:51], a[184:187], v[216:219], v[48:51]
    ds_read_b64 v[250:251], v8 offset:39168
    ds_read_b64 v[208:209], v4 offset:6144
    v_mfma_f32_16x16x32_bf16 v[20:23], a[168:171], v[220:223], v[20:23]
    s_waitcnt lgkmcnt(10)
    ds_read_b64 v[210:211], v4 offset:6400
    v_mfma_f32_16x16x32_bf16 v[252:255], v[236:239], v[236:239], v[252:255]
    v_mfma_f32_16x16x32_bf16 v[28:31], a[172:175], v[220:223], v[28:31]
    buffer_load_dwordx4 a[232:235], v13, s[8:11], s57 offen offset:0 sc1
    v_mfma_f32_16x16x32_bf16 v[36:39], a[176:179], v[220:223], v[36:39]
    s_waitcnt lgkmcnt(8)
    ds_read_b64 v[212:213], v4 offset:8192
    ds_read_b64 v[214:215], v4 offset:8448
    v_mfma_f32_16x16x32_bf16 v[252:255], v[240:243], v[240:243], v[252:255]
    v_mfma_f32_16x16x32_bf16 v[44:47], a[180:183], v[220:223], v[44:47]
    v_mfma_f32_16x16x32_bf16 v[52:55], a[184:187], v[220:223], v[52:55]
    s_waitcnt lgkmcnt(6)
    buffer_load_dwordx4 a[236:239], v13, s[8:11], s56 offen offset:1024 sc1
    v_mfma_f32_16x16x32_bf16 v[252:255], v[244:247], v[244:247], v[252:255]
    ds_read_b64 v[216:217], v4 offset:6152
    ds_read_b64 v[218:219], v4 offset:6408
    v_mfma_f32_16x16x32_bf16 v[56:59], a[168:171], v[224:227], v[56:59]
    v_mfma_f32_16x16x32_bf16 v[64:67], a[172:175], v[224:227], v[64:67]
    s_waitcnt lgkmcnt(6)
    v_mfma_f32_16x16x32_bf16 v[252:255], v[248:251], v[248:251], v[252:255]
    buffer_load_dwordx4 a[240:243], v13, s[8:11], s57 offen offset:1024 sc1
    v_mfma_f32_16x16x32_bf16 v[72:75], a[176:179], v[224:227], v[72:75]
    v_mfma_f32_16x16x32_bf16 v[80:83], a[180:183], v[224:227], v[80:83]
    ds_read_b64 v[220:221], v4 offset:8200
    ds_read_b64 v[222:223], v4 offset:8456
    v_mfma_f32_16x16x32_bf16 v[88:91], a[184:187], v[224:227], v[88:91]
    v_mfma_f32_16x16x32_bf16 v[60:63], a[168:171], v[228:231], v[60:63]
    v_and_b32 v10, 3, v1
    buffer_load_dwordx4 a[244:247], v13, s[8:11], s56 offen offset:2048 sc1
    v_mfma_f32_16x16x32_bf16 v[68:71], a[172:175], v[228:231], v[68:71]
    v_cmp_eq_u32_e64 vcc, 1, v10
    v_mfma_f32_16x16x32_bf16 v[76:79], a[176:179], v[228:231], v[76:79]
    s_nop 0
    v_cndmask_b32 v252, v252, v253, vcc
    v_cmp_eq_u32_e64 vcc, 2, v10
    v_mfma_f32_16x16x32_bf16 v[84:87], a[180:183], v[228:231], v[84:87]
    s_nop 0
    v_cndmask_b32 v252, v252, v254, vcc
    v_cmp_eq_u32_e64 vcc, 3, v10
    v_mfma_f32_16x16x32_bf16 v[92:95], a[184:187], v[228:231], v[92:95]
    s_waitcnt lgkmcnt(6)
    v_cndmask_b32 v252, v252, v255, vcc
    buffer_load_dwordx4 a[248:251], v13, s[8:11], s57 offen offset:2048 sc1
    v_mfma_f32_16x16x32_bf16 v[16:19], a[188:191], v[208:211], v[16:19]
    v_mov_b32 v9, 0x3727c5ac
    v_fmac_f32 v9, 0x3acccccd, v252
    v_mfma_f32_16x16x32_bf16 v[24:27], a[192:195], v[208:211], v[24:27]
    v_rcp_f32_e64 v10, v9
    v_mfma_f32_16x16x32_bf16 v[32:35], a[196:199], v[208:211], v[32:35]
    s_lshl_b32 s48, s3, 6
    s_add_u32 s48, s48, s63
    v_bfe_u32 v8, v8, 3, 4
    v_mfma_f32_16x16x32_bf16 v[40:43], a[200:203], v[208:211], v[40:43]
    buffer_load_dwordx4 a[252:255], v13, s[8:11], s56 offen offset:3072 sc1
    v_mfma_f32_16x16x32_bf16 v[48:51], a[204:207], v[208:211], v[48:51]
    s_waitcnt lgkmcnt(4)
    v_lshl_add_u32 v8, v8, 2, s48
    v_lshrrev_b32 v252, 2, v1
    v_mfma_f32_16x16x32_bf16 v[16:19], a[208:211], v[212:215], v[16:19]
    ds_read_b64 v[224:225], v5 offset:6144
    v_cmp_eq_u32_e64 vcc, v252, v2
    v_mfma_f32_16x16x32_bf16 v[24:27], a[212:215], v[212:215], v[24:27]
    v_add_u32 v252, 2048, v8
    v_cndmask_b32_e64 v8, v252, v8, vcc
    v_mfma_f32_16x16x32_bf16 v[32:35], a[216:219], v[212:215], v[32:35]
    buffer_load_dwordx4 a[128:131], v13, s[8:11], s57 offen offset:3072 sc1
    v_mfma_f32_16x16x32_bf16 v[40:43], a[220:223], v[212:215], v[40:43]
    s_waitcnt vmcnt(21)
    ds_write_b32 v8, v10 offset:32768
    ds_write_b32 v8, v9 offset:33024
    v_mfma_f32_16x16x32_bf16 v[48:51], a[224:227], v[212:215], v[48:51]
    s_waitcnt lgkmcnt(5)
    v_lshl_add_u32 v9, v1, 3, s63
    s_waitcnt lgkmcnt(0)
    v_mfma_f32_16x16x32_bf16 v[20:23], a[188:191], v[216:219], v[20:23]
    s_barrier
    ds_read_b64 v[226:227], v5 offset:6400
    ds_read_b64 v[228:229], v5 offset:8192
    v_mfma_f32_16x16x32_bf16 v[28:31], a[192:195], v[216:219], v[28:31]
    buffer_load_dwordx4 a[132:135], v14, s[8:11], s56 offen offset:0 sc1
    v_mfma_f32_16x16x32_bf16 v[36:39], a[196:199], v[216:219], v[36:39]
    ds_read_b64 v[6:7], v9 offset:33024
    ds_read_b64 v[252:253], v9 offset:33152
    v_mfma_f32_16x16x32_bf16 v[44:47], a[200:203], v[216:219], v[44:47]
    s_waitcnt lgkmcnt(1)
    v_mul_f32 v16, v6, v16
    v_mul_f32_e64 v17, v6, v17
    v_mfma_f32_16x16x32_bf16 v[52:55], a[204:207], v[216:219], v[52:55]
    ds_read_b64 v[230:231], v5 offset:8448
    ds_read_b64 v[208:209], v5 offset:6152
    v_mfma_f32_16x16x32_bf16 v[20:23], a[208:211], v[220:223], v[20:23]
    buffer_load_dwordx4 a[136:139], v14, s[8:11], s57 offen offset:0 sc1
    v_mfma_f32_16x16x32_bf16 v[28:31], a[212:215], v[220:223], v[28:31]
    ds_read_b64 v[210:211], v5 offset:6408
    ds_read_b64 v[212:213], v5 offset:8200
    v_mfma_f32_16x16x32_bf16 v[36:39], a[216:219], v[220:223], v[36:39]
    v_mul_f32 v18, v6, v18
    v_mul_f32 v19, v6, v19
    v_mul_f32_e64 v24, v6, v24
    v_mfma_f32_16x16x32_bf16 v[44:47], a[220:223], v[220:223], v[44:47]
    v_mul_f32 v25, v6, v25
    v_mul_f32 v26, v6, v26
    v_mfma_f32_16x16x32_bf16 v[52:55], a[224:227], v[220:223], v[52:55]
    buffer_load_dwordx4 a[140:143], v14, s[8:11], s56 offen offset:1024 sc1
    v_mfma_f32_16x16x32_bf16 v[56:59], a[188:191], v[224:227], v[56:59]
    ds_read_b64 v[214:215], v5 offset:8456
    v_mul_f32 v27, v6, v27
    v_mul_f32 v32, v6, v32
    v_mfma_f32_16x16x32_bf16 v[64:67], a[192:195], v[224:227], v[64:67]
    v_mul_f32 v33, v6, v33
    v_mul_f32 v34, v6, v34
    v_mfma_f32_16x16x32_bf16 v[72:75], a[196:199], v[224:227], v[72:75]
    v_mul_f32 v35, v6, v35
    v_mul_f32 v40, v6, v40
    v_mfma_f32_16x16x32_bf16 v[80:83], a[200:203], v[224:227], v[80:83]
    v_mul_f32_e64 v41, v6, v41
    buffer_load_dwordx4 a[144:147], v14, s[8:11], s57 offen offset:1024 sc1
    v_mfma_f32_16x16x32_bf16 v[88:91], a[204:207], v[224:227], v[88:91]
    s_waitcnt lgkmcnt(4)
    v_mul_f32 v42, v6, v42
    v_mul_f32 v43, v6, v43
    v_mul_f32 v48, v6, v48
    v_mul_f32_e64 v49, v6, v49
    v_mfma_f32_16x16x32_bf16 v[56:59], a[208:211], v[228:231], v[56:59]
    v_mul_f32 v50, v6, v50
    v_mul_f32 v51, v6, v51
    v_mul_f32_e64 v20, v7, v20
    v_mfma_f32_16x16x32_bf16 v[64:67], a[212:215], v[228:231], v[64:67]
    v_mul_f32 v21, v7, v21
    v_mul_f32 v22, v7, v22
    v_mfma_f32_16x16x32_bf16 v[72:75], a[216:219], v[228:231], v[72:75]
    buffer_load_dwordx4 a[148:151], v14, s[8:11], s56 offen offset:2048 sc1
    v_mfma_f32_16x16x32_bf16 v[80:83], a[220:223], v[228:231], v[80:83]
    v_mul_f32 v23, v7, v23
    v_mul_f32 v28, v7, v28
    v_mul_f32_e64 v29, v7, v29
    v_mfma_f32_16x16x32_bf16 v[88:91], a[224:227], v[228:231], v[88:91]
    s_waitcnt lgkmcnt(2)
    v_mul_f32 v30, v7, v30
    v_mul_f32 v31, v7, v31
    v_mul_f32 v36, v7, v36
    v_mul_f32_e64 v37, v7, v37
    v_mfma_f32_16x16x32_bf16 v[60:63], a[188:191], v[208:211], v[60:63]
    v_mul_f32 v38, v7, v38
    v_mul_f32 v39, v7, v39
    v_mul_f32_e64 v44, v7, v44
    v_mfma_f32_16x16x32_bf16 v[68:71], a[192:195], v[208:211], v[68:71]
    v_mul_f32_e64 v45, v7, v45
    buffer_load_dwordx4 a[152:155], v14, s[8:11], s57 offen offset:2048 sc1
    v_mfma_f32_16x16x32_bf16 v[76:79], a[196:199], v[208:211], v[76:79]
    v_mul_f32 v46, v7, v46
    v_mul_f32 v47, v7, v47
    v_mul_f32 v52, v7, v52
    v_mul_f32 v53, v7, v53
    v_mfma_f32_16x16x32_bf16 v[84:87], a[200:203], v[208:211], v[84:87]
    v_mul_f32 v54, v7, v54
    v_mul_f32 v55, v7, v55
    v_mfma_f32_16x16x32_bf16 v[92:95], a[204:207], v[208:211], v[92:95]
    s_waitcnt lgkmcnt(0)
    v_mfma_f32_16x16x32_bf16 v[60:63], a[208:211], v[212:215], v[60:63]
    buffer_load_dwordx4 a[156:159], v14, s[8:11], s56 offen offset:3072 sc1
    v_mfma_f32_16x16x32_bf16 v[68:71], a[212:215], v[212:215], v[68:71]
    v_mfma_f32_16x16x32_bf16 v[76:79], a[216:219], v[212:215], v[76:79]
    v_mfma_f32_16x16x32_bf16 v[84:87], a[220:223], v[212:215], v[84:87]
    v_mfma_f32_16x16x32_bf16 v[92:95], a[224:227], v[212:215], v[92:95]
    s_waitcnt vmcnt(14)
    buffer_load_dwordx4 a[160:163], v14, s[8:11], s57 offen offset:3072 sc1
    v_mfma_f32_16x16x32_bf16 v[16:19], v[96:99], a[228:231], v[16:19]
    s_waitcnt vmcnt(14)
    v_mfma_f32_16x16x32_bf16 v[20:23], v[96:99], a[232:235], v[20:23]
    v_mfma_f32_16x16x32_bf16 v[24:27], v[100:103], a[228:231], v[24:27]
    v_mfma_f32_16x16x32_bf16 v[28:31], v[100:103], a[232:235], v[28:31]
    buffer_load_dwordx4 a[164:167], v15, s[8:11], s56 offen offset:0 sc1
    v_mfma_f32_16x16x32_bf16 v[32:35], v[104:107], a[228:231], v[32:35]
    v_mfma_f32_16x16x32_bf16 v[36:39], v[104:107], a[232:235], v[36:39]
    v_mfma_f32_16x16x32_bf16 v[40:43], v[108:111], a[228:231], v[40:43]
    v_mul_f32 v56, v252, v56
    v_mul_f32_e64 v57, v252, v57
    v_mfma_f32_16x16x32_bf16 v[44:47], v[108:111], a[232:235], v[44:47]
    buffer_load_dwordx4 a[168:171], v15, s[8:11], s57 offen offset:0 sc1
    v_mfma_f32_16x16x32_bf16 v[48:51], v[112:115], a[228:231], v[48:51]
    v_mul_f32 v58, v252, v58
    v_mul_f32 v59, v252, v59
    v_mfma_f32_16x16x32_bf16 v[52:55], v[112:115], a[232:235], v[52:55]
    s_waitcnt vmcnt(15)
    v_mul_f32 v60, v253, v60
    v_mul_f32_e64 v61, v253, v61
    v_mfma_f32_16x16x32_bf16 v[16:19], v[116:119], a[236:239], v[16:19]
    s_waitcnt vmcnt(14)
    v_mul_f32 v62, v253, v62
    v_mul_f32_e64 v63, v253, v63
    v_mfma_f32_16x16x32_bf16 v[20:23], v[116:119], a[240:243], v[20:23]
    buffer_load_dwordx4 a[172:175], v15, s[8:11], s56 offen offset:1024 sc1
    v_mfma_f32_16x16x32_bf16 v[24:27], v[120:123], a[236:239], v[24:27]
    v_mul_f32 v64, v252, v64
    v_mul_f32 v65, v252, v65
    v_mfma_f32_16x16x32_bf16 v[28:31], v[120:123], a[240:243], v[28:31]
    v_mul_f32 v66, v252, v66
    v_mul_f32 v67, v252, v67
    v_mfma_f32_16x16x32_bf16 v[32:35], v[124:127], a[236:239], v[32:35]
    v_mul_f32 v68, v253, v68
    v_mul_f32 v69, v253, v69
    v_mfma_f32_16x16x32_bf16 v[36:39], v[124:127], a[240:243], v[36:39]
    buffer_load_dwordx4 a[176:179], v15, s[8:11], s57 offen offset:1024 sc1
    v_mfma_f32_16x16x32_bf16 v[40:43], v[128:131], a[236:239], v[40:43]
    v_mul_f32 v70, v253, v70
    v_mul_f32 v71, v253, v71
    v_mfma_f32_16x16x32_bf16 v[44:47], v[128:131], a[240:243], v[44:47]
    v_mul_f32 v72, v252, v72
    v_mul_f32 v73, v252, v73
    v_mfma_f32_16x16x32_bf16 v[48:51], v[132:135], a[236:239], v[48:51]
    buffer_load_dword v12, v11, s[8:11], s55 offen sc1
    v_mfma_f32_16x16x32_bf16 v[52:55], v[132:135], a[240:243], v[52:55]
    s_waitcnt vmcnt(16)
    buffer_load_dwordx4 a[180:183], v15, s[8:11], s56 offen offset:2048 sc1
    v_mfma_f32_16x16x32_bf16 v[16:19], v[136:139], a[244:247], v[16:19]
    s_waitcnt vmcnt(16)
    v_mul_f32 v74, v252, v74
    v_mul_f32 v75, v252, v75
    v_mfma_f32_16x16x32_bf16 v[20:23], v[136:139], a[248:251], v[20:23]
    v_mul_f32 v76, v253, v76
    v_mul_f32 v77, v253, v77
    v_mfma_f32_16x16x32_bf16 v[24:27], v[140:143], a[244:247], v[24:27]
    v_mul_f32 v78, v253, v78
    v_mul_f32 v79, v253, v79
    v_mfma_f32_16x16x32_bf16 v[28:31], v[140:143], a[248:251], v[28:31]
    buffer_load_dwordx4 a[184:187], v15, s[8:11], s57 offen offset:2048 sc1
    v_mfma_f32_16x16x32_bf16 v[32:35], v[144:147], a[244:247], v[32:35]
    v_mul_f32 v80, v252, v80
    v_mul_f32 v81, v252, v81
    v_mfma_f32_16x16x32_bf16 v[36:39], v[144:147], a[248:251], v[36:39]
    v_mul_f32 v82, v252, v82
    v_mul_f32 v83, v252, v83
    v_mfma_f32_16x16x32_bf16 v[40:43], v[148:151], a[244:247], v[40:43]
    v_mul_f32 v84, v253, v84
    v_mul_f32 v85, v253, v85
    v_mfma_f32_16x16x32_bf16 v[44:47], v[148:151], a[248:251], v[44:47]
    buffer_load_dwordx4 a[188:191], v15, s[8:11], s56 offen offset:3072 sc1
    v_mfma_f32_16x16x32_bf16 v[48:51], v[152:155], a[244:247], v[48:51]
    v_mul_f32 v86, v253, v86
    v_mul_f32 v87, v253, v87
    v_mfma_f32_16x16x32_bf16 v[52:55], v[152:155], a[248:251], v[52:55]
    s_waitcnt vmcnt(17)
    v_mul_f32 v88, v252, v88
    v_mul_f32_e64 v89, v252, v89
    v_mfma_f32_16x16x32_bf16 v[16:19], v[156:159], a[252:255], v[16:19]
    s_waitcnt vmcnt(16)
    v_mul_f32 v90, v252, v90
    v_mul_f32_e64 v91, v252, v91
    v_mfma_f32_16x16x32_bf16 v[20:23], v[156:159], a[128:131], v[20:23]
    buffer_load_dwordx4 a[192:195], v15, s[8:11], s57 offen offset:3072 sc1
    s_add_u32 s56, s56, 393216
    v_mfma_f32_16x16x32_bf16 v[24:27], v[160:163], a[252:255], v[24:27]
    s_add_u32 s57, s57, 393216
    v_mul_f32 v92, v253, v92
    v_mul_f32 v93, v253, v93
    v_mfma_f32_16x16x32_bf16 v[28:31], v[160:163], a[128:131], v[28:31]
    v_mul_f32 v94, v253, v94
    v_mul_f32 v95, v253, v95
    v_mfma_f32_16x16x32_bf16 v[32:35], v[164:167], a[252:255], v[32:35]
    v_mfma_f32_16x16x32_bf16 v[36:39], v[164:167], a[128:131], v[36:39]
    v_mfma_f32_16x16x32_bf16 v[40:43], v[168:171], a[252:255], v[40:43]
    v_mfma_f32_16x16x32_bf16 v[44:47], v[168:171], a[128:131], v[44:47]
    v_mfma_f32_16x16x32_bf16 v[48:51], v[172:175], a[252:255], v[48:51]
    v_mfma_f32_16x16x32_bf16 v[52:55], v[172:175], a[128:131], v[52:55]
    s_waitcnt vmcnt(16)
    v_mfma_f32_16x16x32_bf16 v[16:19], v[176:179], a[132:135], v[16:19]
    s_waitcnt vmcnt(15)
    v_mfma_f32_16x16x32_bf16 v[20:23], v[176:179], a[136:139], v[20:23]
    v_mfma_f32_16x16x32_bf16 v[24:27], v[180:183], a[132:135], v[24:27]
    v_mfma_f32_16x16x32_bf16 v[28:31], v[180:183], a[136:139], v[28:31]
    v_mfma_f32_16x16x32_bf16 v[32:35], v[184:187], a[132:135], v[32:35]
    v_mfma_f32_16x16x32_bf16 v[36:39], v[184:187], a[136:139], v[36:39]
    v_mfma_f32_16x16x32_bf16 v[40:43], v[188:191], a[132:135], v[40:43]
    v_mfma_f32_16x16x32_bf16 v[44:47], v[188:191], a[136:139], v[44:47]
    v_mfma_f32_16x16x32_bf16 v[48:51], v[192:195], a[132:135], v[48:51]
    v_mfma_f32_16x16x32_bf16 v[52:55], v[192:195], a[136:139], v[52:55]
    s_waitcnt vmcnt(14)
    v_mfma_f32_16x16x32_bf16 v[16:19], v[196:199], a[140:143], v[16:19]
    s_waitcnt vmcnt(13)
    v_mfma_f32_16x16x32_bf16 v[20:23], v[196:199], a[144:147], v[20:23]
    v_mfma_f32_16x16x32_bf16 v[24:27], v[200:203], a[140:143], v[24:27]
    v_mfma_f32_16x16x32_bf16 v[28:31], v[200:203], a[144:147], v[28:31]
    v_mfma_f32_16x16x32_bf16 v[32:35], v[204:207], a[140:143], v[32:35]
    v_mfma_f32_16x16x32_bf16 v[36:39], v[204:207], a[144:147], v[36:39]
    v_mfma_f32_16x16x32_bf16 v[40:43], a[0:3], a[140:143], v[40:43]
    v_mfma_f32_16x16x32_bf16 v[44:47], a[0:3], a[144:147], v[44:47]
    v_mfma_f32_16x16x32_bf16 v[48:51], a[4:7], a[140:143], v[48:51]
    s_waitcnt vmcnt(4)
    v_cmp_eq_u32 vcc, 0, v12
    v_mfma_f32_16x16x32_bf16 v[52:55], a[4:7], a[144:147], v[52:55]
    s_cbranch_vccnz L_slow11
L_back11:
    buffer_load_dwordx4 a[196:199], v13, s[8:11], s56 offen offset:0 sc1
    v_mfma_f32_16x16x32_bf16 v[16:19], a[8:11], a[148:151], v[16:19]
    v_mfma_f32_16x16x32_bf16 v[20:23], a[8:11], a[152:155], v[20:23]
    v_mfma_f32_16x16x32_bf16 v[24:27], a[12:15], a[148:151], v[24:27]
    v_mfma_f32_16x16x32_bf16 v[28:31], a[12:15], a[152:155], v[28:31]
    buffer_load_dwordx4 a[200:203], v13, s[8:11], s57 offen offset:0 sc1
    v_mfma_f32_16x16x32_bf16 v[32:35], a[16:19], a[148:151], v[32:35]
    v_mfma_f32_16x16x32_bf16 v[36:39], a[16:19], a[152:155], v[36:39]
    v_mfma_f32_16x16x32_bf16 v[40:43], a[20:23], a[148:151], v[40:43]
    s_mul_i32 s50, s3, 6144
    s_add_u32 s50, s50, s58
    v_add_u32_e64 v4, s50, v13
    v_mfma_f32_16x16x32_bf16 v[44:47], a[20:23], a[152:155], v[44:47]
    buffer_load_dwordx4 a[204:207], v13, s[8:11], s56 offen offset:1024 sc1
    v_mfma_f32_16x16x32_bf16 v[48:51], a[24:27], a[148:151], v[48:51]
    v_lshrrev_b32_e64 v11, 5, v0
    v_bfe_u32 v12, v0, 3, 2
    v_mfma_f32_16x16x32_bf16 v[52:55], a[24:27], a[152:155], v[52:55]
    s_lshl_b32 s50, s3, 2
    v_add_u32 v12, s50, v12
    v_lshl_add_u32 v3, v12, 1, v11
    v_mfma_f32_16x16x32_bf16 v[16:19], a[28:31], a[156:159], v[16:19]
    v_lshl_add_u32 v3, v3, 2, s63
    v_lshl_add_u32 v10, v11, 5, v12
    v_mfma_f32_16x16x32_bf16 v[20:23], a[28:31], a[160:163], v[20:23]
    buffer_load_dwordx4 a[208:211], v13, s[8:11], s57 offen offset:1024 sc1
    v_mfma_f32_16x16x32_bf16 v[24:27], a[32:35], a[156:159], v[24:27]
    v_mul_u32_u24 v10, 1280, v10
    v_and_b32_e64 v5, 7, v0
    v_mfma_f32_16x16x32_bf16 v[28:31], a[32:35], a[160:163], v[28:31]
    v_lshl_add_u32 v10, v5, 2, v10
    v_bfe_u32 v5, v0, 1, 2
    v_mfma_f32_16x16x32_bf16 v[32:35], a[36:39], a[156:159], v[32:35]
    v_lshl_add_u32 v5, v11, 2, v5
    v_lshl_add_u32 v5, v5, 4, v12
    v_mfma_f32_16x16x32_bf16 v[36:39], a[36:39], a[160:163], v[36:39]
    buffer_load_dwordx4 a[212:215], v13, s[8:11], s56 offen offset:2048 sc1
    v_mfma_f32_16x16x32_bf16 v[40:43], a[40:43], a[156:159], v[40:43]
    v_and_b32_e64 v11, 1, v0
    v_lshl_add_u32 v5, v5, 1, v11
    v_mfma_f32_16x16x32_bf16 v[44:47], a[40:43], a[160:163], v[44:47]
    v_lshl_add_u32 v5, v5, 3, s58
    v_and_b32_e64 v11, 1, v2
    v_mfma_f32_16x16x32_bf16 v[48:51], a[44:47], a[156:159], v[48:51]
    v_lshl_add_u32 v8, v11, 5, v1
    v_mul_u32_u24 v8, 1280, v8
    v_mfma_f32_16x16x32_bf16 v[52:55], a[44:47], a[160:163], v[52:55]
    buffer_load_dwordx4 a[216:219], v13, s[8:11], s57 offen offset:2048 sc1
    v_mfma_f32_16x16x32_bf16 v[16:19], a[48:51], a[164:167], v[16:19]
    v_lshrrev_b32_e64 v11, 1, v2
    v_lshl_add_u32 v8, v11, 4, v8
    v_mfma_f32_16x16x32_bf16 v[20:23], a[48:51], a[168:171], v[20:23]
    s_lshr_b32 s50, s64, 3
    s_bfe_u32 s49, s64, 0x10002
    s_lshl_b32 s49, s49, 6
    v_mfma_f32_16x16x32_bf16 v[16:19], a[68:71], a[172:175], v[16:19]
    s_add_u32 s50, s50, s49
    s_lshl_b32 s49, s66, 4
    s_add_u32 s50, s50, s49
    v_mfma_f32_16x16x32_bf16 v[20:23], a[68:71], a[176:179], v[20:23]
    s_waitcnt vmcnt(9)
    s_lshl_b32 s48, s3, 11
    s_add_u32 s48, s48, 24576
    v_mfma_f32_16x16x32_bf16 v[16:19], a[88:91], a[180:183], v[16:19]
    s_waitcnt vmcnt(8)
    buffer_load_dwordx4 a[220:223], v13, s[8:11], s56 offen offset:3072 sc1
    v_mfma_f32_16x16x32_bf16 v[20:23], a[88:91], a[184:187], v[20:23]
    s_waitcnt vmcnt(8)
    s_add_u32 s48, s48, s58
    v_add_u32_e64 v9, s48, v13
    v_mfma_f32_16x16x32_bf16 v[16:19], a[108:111], a[188:191], v[16:19]
    s_waitcnt vmcnt(7)
    s_and_b32 s49, s64, 3
    s_lshl_b32 s49, s49, 2
    v_mfma_f32_16x16x32_bf16 v[20:23], a[108:111], a[192:195], v[20:23]
    s_add_u32 s50, s50, s49
    s_mul_i32 s50, s50, 20480
    s_mul_i32 s49, s67, 160
    v_mfma_f32_16x16x32_bf16 v[24:27], a[52:55], a[164:167], v[24:27]
    buffer_load_dwordx4 a[224:227], v13, s[8:11], s57 offen offset:3072 sc1
    v_mfma_f32_16x16x32_bf16 v[28:31], a[52:55], a[168:171], v[28:31]
    s_add_u32 s50, s50, s49
    s_add_u32 s99, s50, 128
    s_lshl_b32 s49, s3, 5
    v_mfma_f32_16x16x32_bf16 v[24:27], a[72:75], a[172:175], v[24:27]
    s_add_u32 s98, s50, s49
    s_mov_b32 s12, s30
    s_mov_b32 s13, s31
    v_mfma_f32_16x16x32_bf16 v[28:31], a[72:75], a[176:179], v[28:31]
    s_mov_b32 s14, 2621440
    s_mov_b32 s15, 0x00020000
    v_mfma_f32_16x16x32_bf16 v[24:27], a[92:95], a[180:183], v[24:27]
    ds_write_b128 v9, v[16:19] offset:0
    v_mfma_f32_16x16x32_bf16 v[28:31], a[92:95], a[184:187], v[28:31]
    buffer_load_dwordx4 a[228:231], v14, s[8:11], s56 offen offset:0 sc1
    ds_write_b128 v9, v[20:23] offset:1024
    s_add_u32 s48, s3, 1
    s_and_b32 s48, s48, 3
    v_mfma_f32_16x16x32_bf16 v[24:27], a[112:115], a[188:191], v[24:27]
    s_mul_i32 s48, s48, 6144
    s_add_u32 s48, s48, s58
    v_add_u32_e64 v9, s48, v13
    v_mfma_f32_16x16x32_bf16 v[28:31], a[112:115], a[192:195], v[28:31]
    v_mfma_f32_16x16x32_bf16 v[32:35], a[56:59], a[164:167], v[32:35]
    v_mfma_f32_16x16x32_bf16 v[36:39], a[56:59], a[168:171], v[36:39]
    buffer_load_dwordx4 a[232:235], v14, s[8:11], s57 offen offset:0 sc1
    v_mfma_f32_16x16x32_bf16 v[32:35], a[76:79], a[172:175], v[32:35]
    ds_write_b128 v9, v[24:27] offset:0
    v_mfma_f32_16x16x32_bf16 v[36:39], a[76:79], a[176:179], v[36:39]
    ds_write_b128 v9, v[28:31] offset:1024
    v_mfma_f32_16x16x32_bf16 v[32:35], a[96:99], a[180:183], v[32:35]
    s_add_u32 s48, s3, 2
    s_and_b32 s48, s48, 3
    s_mul_i32 s48, s48, 6144
    v_mfma_f32_16x16x32_bf16 v[36:39], a[96:99], a[184:187], v[36:39]
    buffer_load_dwordx4 a[236:239], v14, s[8:11], s56 offen offset:1024 sc1
    v_mfma_f32_16x16x32_bf16 v[32:35], a[116:119], a[188:191], v[32:35]
    s_add_u32 s48, s48, s58
    v_add_u32 v9, s48, v13
    v_mfma_f32_16x16x32_bf16 v[36:39], a[116:119], a[192:195], v[36:39]
    v_mfma_f32_16x16x32_bf16 v[40:43], a[60:63], a[164:167], v[40:43]
    v_mfma_f32_16x16x32_bf16 v[44:47], a[60:63], a[168:171], v[44:47]
    buffer_load_dwordx4 a[240:243], v14, s[8:11], s57 offen offset:1024 sc1
    v_mfma_f32_16x16x32_bf16 v[40:43], a[80:83], a[172:175], v[40:43]
    ds_write_b128 v9, v[32:35] offset:2048
    v_mfma_f32_16x16x32_bf16 v[44:47], a[80:83], a[176:179], v[44:47]
    ds_write_b128 v9, v[36:39] offset:3072
    v_mfma_f32_16x16x32_bf16 v[40:43], a[100:103], a[180:183], v[40:43]
    s_add_u32 s48, s3, 3
    s_and_b32 s48, s48, 3
    s_mul_i32 s48, s48, 6144
    v_mfma_f32_16x16x32_bf16 v[44:47], a[100:103], a[184:187], v[44:47]
    buffer_load_dwordx4 a[244:247], v14, s[8:11], s56 offen offset:2048 sc1
    v_mfma_f32_16x16x32_bf16 v[40:43], a[120:123], a[188:191], v[40:43]
    s_add_u32 s48, s48, s58
    v_add_u32 v9, s48, v13
    v_mfma_f32_16x16x32_bf16 v[44:47], a[120:123], a[192:195], v[44:47]
    v_mfma_f32_16x16x32_bf16 v[48:51], a[64:67], a[164:167], v[48:51]
    v_mfma_f32_16x16x32_bf16 v[52:55], a[64:67], a[168:171], v[52:55]
L_pg7295:
    s_cbranch_execz L_hopr6
    buffer_load_dwordx4 a[248:251], v14, s[8:11], s57 offen offset:2048 sc1
    v_mfma_f32_16x16x32_bf16 v[48:51], a[84:87], a[172:175], v[48:51]
    ds_write_b128 v9, v[40:43] offset:4096
    v_mfma_f32_16x16x32_bf16 v[52:55], a[84:87], a[176:179], v[52:55]
    ds_write_b128 v9, v[44:47] offset:5120
    v_mfma_f32_16x16x32_bf16 v[48:51], a[104:107], a[180:183], v[48:51]
    v_mfma_f32_16x16x32_bf16 v[52:55], a[104:107], a[184:187], v[52:55]
    buffer_load_dwordx4 a[252:255], v14, s[8:11], s56 offen offset:3072 sc1
    v_mfma_f32_16x16x32_bf16 v[48:51], a[124:127], a[188:191], v[48:51]
    v_mfma_f32_16x16x32_bf16 v[52:55], a[124:127], a[192:195], v[52:55]
    s_waitcnt vmcnt(14)
    v_mfma_f32_16x16x32_bf16 v[56:59], v[96:99], a[196:199], v[56:59]
    s_waitcnt vmcnt(13)
    v_mfma_f32_16x16x32_bf16 v[60:63], v[96:99], a[200:203], v[60:63]
    buffer_load_dwordx4 a[128:131], v14, s[8:11], s57 offen offset:3072 sc1
    v_mfma_f32_16x16x32_bf16 v[64:67], v[100:103], a[196:199], v[64:67]
    v_lshl_add_u32 v11, v1, 3, s63
    v_mfma_f32_16x16x32_bf16 v[68:71], v[100:103], a[200:203], v[68:71]
    ds_read_b64 v[6:7], v11 offset:32768
    ds_read_b32 v12, v3 offset:32768
    v_mfma_f32_16x16x32_bf16 v[72:75], v[104:107], a[196:199], v[72:75]
    s_waitcnt lgkmcnt(0)
    s_barrier
    v_mfma_f32_16x16x32_bf16 v[76:79], v[104:107], a[200:203], v[76:79]
    buffer_load_dwordx4 a[132:135], v15, s[8:11], s56 offen offset:0 sc1
    v_mfma_f32_16x16x32_bf16 v[80:83], v[108:111], a[196:199], v[80:83]
    ds_read_b128 v[208:211], v4 offset:0
    ds_read_b128 v[212:215], v4 offset:1024
    v_mfma_f32_16x16x32_bf16 v[84:87], v[108:111], a[200:203], v[84:87]
    s_waitcnt vmcnt(14)
    ds_read_b128 v[216:219], v4 offset:2048
    ds_read_b128 v[220:223], v4 offset:3072
    v_mfma_f32_16x16x32_bf16 v[56:59], v[116:119], a[204:207], v[56:59]
    s_waitcnt vmcnt(13)
    ds_read_b128 v[224:227], v4 offset:4096
    ds_read_b128 v[228:231], v4 offset:5120
    v_mfma_f32_16x16x32_bf16 v[60:63], v[116:119], a[208:211], v[60:63]
    buffer_load_dwordx4 a[136:139], v15, s[8:11], s57 offen offset:0 sc1
    v_mfma_f32_16x16x32_bf16 v[64:67], v[120:123], a[204:207], v[64:67]
    ds_read_b64 v[244:245], v5 offset:24576
    ds_read_b64 v[246:247], v5 offset:26624
    v_mfma_f32_16x16x32_bf16 v[68:71], v[120:123], a[208:211], v[68:71]
    ds_read_b64 v[248:249], v5 offset:28672
    ds_read_b64 v[250:251], v5 offset:30720
    v_mfma_f32_16x16x32_bf16 v[72:75], v[124:127], a[204:207], v[72:75]
    v_mfma_f32_16x16x32_bf16 v[76:79], v[124:127], a[208:211], v[76:79]
    buffer_load_dwordx4 a[140:143], v15, s[8:11], s56 offen offset:1024 sc1
    v_mfma_f32_16x16x32_bf16 v[80:83], v[128:131], a[204:207], v[80:83]
    s_waitcnt lgkmcnt(7)
    v_add_f32 v208, v208, v216
    v_add_f32 v209, v209, v217
    v_mfma_f32_16x16x32_bf16 v[84:87], v[128:131], a[208:211], v[84:87]
    s_waitcnt vmcnt(14)
    v_add_f32 v210, v210, v218
    v_add_f32_e64 v211, v211, v219
    v_mfma_f32_16x16x32_bf16 v[56:59], v[136:139], a[212:215], v[56:59]
    s_waitcnt vmcnt(13)
    s_waitcnt lgkmcnt(6)
    v_add_f32_e64 v212, v212, v220
    v_mfma_f32_16x16x32_bf16 v[60:63], v[136:139], a[216:219], v[60:63]
    buffer_load_dwordx4 a[144:147], v15, s[8:11], s57 offen offset:1024 sc1
    v_mfma_f32_16x16x32_bf16 v[64:67], v[140:143], a[212:215], v[64:67]
    v_add_f32 v213, v213, v221
    v_add_f32 v214, v214, v222
    v_mfma_f32_16x16x32_bf16 v[68:71], v[140:143], a[216:219], v[68:71]
    v_add_f32_e64 v215, v215, v223
    v_mfma_f32_16x16x32_bf16 v[72:75], v[144:147], a[212:215], v[72:75]
    s_waitcnt lgkmcnt(5)
    v_add_f32 v208, v208, v224
    v_add_f32_e64 v209, v209, v225
    v_mfma_f32_16x16x32_bf16 v[76:79], v[144:147], a[216:219], v[76:79]
    buffer_load_dwordx4 a[148:151], v15, s[8:11], s56 offen offset:2048 sc1
    v_mfma_f32_16x16x32_bf16 v[80:83], v[148:151], a[212:215], v[80:83]
    v_add_f32 v210, v210, v226
    v_add_f32 v211, v211, v227
    v_mfma_f32_16x16x32_bf16 v[84:87], v[148:151], a[216:219], v[84:87]
    s_waitcnt vmcnt(14)
    s_waitcnt lgkmcnt(4)
    v_add_f32_e64 v212, v212, v228
    v_mfma_f32_16x16x32_bf16 v[56:59], v[156:159], a[220:223], v[56:59]
    s_waitcnt vmcnt(13)
    v_add_f32 v213, v213, v229
    v_add_f32_e64 v214, v214, v230
    v_mfma_f32_16x16x32_bf16 v[60:63], v[156:159], a[224:227], v[60:63]
    buffer_load_dwordx4 a[152:155], v15, s[8:11], s57 offen offset:2048 sc1
    v_mfma_f32_16x16x32_bf16 v[64:67], v[160:163], a[220:223], v[64:67]
    v_add_f32 v215, v215, v231
    v_add_f32 v208, v208, v48
    v_mfma_f32_16x16x32_bf16 v[68:71], v[160:163], a[224:227], v[68:71]
    v_add_f32 v209, v209, v49
    v_add_f32 v210, v210, v50
    v_mfma_f32_16x16x32_bf16 v[72:75], v[164:167], a[220:223], v[72:75]
    v_add_f32 v211, v211, v51
    v_add_f32 v212, v212, v52
    v_mfma_f32_16x16x32_bf16 v[76:79], v[164:167], a[224:227], v[76:79]
    buffer_load_dwordx4 a[156:159], v15, s[8:11], s56 offen offset:3072 sc1
    v_mfma_f32_16x16x32_bf16 v[80:83], v[168:171], a[220:223], v[80:83]
    v_add_f32 v213, v213, v53
    v_add_f32 v214, v214, v54
    v_mfma_f32_16x16x32_bf16 v[84:87], v[168:171], a[224:227], v[84:87]
    s_waitcnt vmcnt(14)
    v_add_f32 v215, v215, v55
    v_mul_f32_e64 v208, v208, v6
    v_mfma_f32_16x16x32_bf16 v[56:59], v[176:179], a[228:231], v[56:59]
    s_waitcnt vmcnt(13)
    v_mul_f32 v209, v209, v6
    v_mul_f32_e64 v210, v210, v6
    v_mfma_f32_16x16x32_bf16 v[60:63], v[176:179], a[232:235], v[60:63]
    buffer_load_dwordx4 a[160:163], v15, s[8:11], s57 offen offset:3072 sc1
    v_mfma_f32_16x16x32_bf16 v[64:67], v[180:183], a[228:231], v[64:67]
    v_mul_f32 v211, v211, v6
    v_mul_f32 v212, v212, v7
    v_mfma_f32_16x16x32_bf16 v[68:71], v[180:183], a[232:235], v[68:71]
    v_mul_f32 v213, v213, v7
    v_mul_f32 v214, v214, v7
    v_mfma_f32_16x16x32_bf16 v[72:75], v[184:187], a[228:231], v[72:75]
    v_mul_f32_e64 v215, v215, v7
    v_cvt_pk_bf16_f32 v240, v208, v209
    v_mfma_f32_16x16x32_bf16 v[76:79], v[184:187], a[232:235], v[76:79]
    v_cvt_pk_bf16_f32 v242, v212, v213
    v_cvt_pk_bf16_f32 v241, v210, v211
    v_mfma_f32_16x16x32_bf16 v[80:83], v[188:191], a[228:231], v[80:83]
    v_cvt_pk_bf16_f32 v243, v214, v215
    v_mfma_f32_16x16x32_bf16 v[84:87], v[188:191], a[232:235], v[84:87]
    s_waitcnt vmcnt(13)
    v_permlane16_swap_b32 v240, v242
    v_mfma_f32_16x16x32_bf16 v[56:59], v[196:199], a[236:239], v[56:59]
    s_waitcnt vmcnt(12)
    v_permlane16_swap_b32 v241, v243
    v_mfma_f32_16x16x32_bf16 v[60:63], v[196:199], a[240:243], v[60:63]
    buffer_store_dwordx4 v[240:243], v8, s[12:15], s98 offen sc1
    v_mfma_f32_16x16x32_bf16 v[64:67], v[200:203], a[236:239], v[64:67]
    s_waitcnt lgkmcnt(2)
    v_add_f32 v244, v244, v246
    v_add_f32_e64 v245, v245, v247
    v_mfma_f32_16x16x32_bf16 v[68:71], v[200:203], a[240:243], v[68:71]
    s_waitcnt lgkmcnt(1)
    v_add_f32 v244, v244, v248
    v_add_f32_e64 v245, v245, v249
    v_mfma_f32_16x16x32_bf16 v[72:75], v[204:207], a[236:239], v[72:75]
    s_waitcnt lgkmcnt(0)
    v_add_f32 v244, v244, v250
    v_add_f32_e64 v245, v245, v251
    v_mfma_f32_16x16x32_bf16 v[76:79], v[204:207], a[240:243], v[76:79]
    v_mul_f32 v244, v244, v12
    v_mul_f32 v245, v245, v12
    v_mfma_f32_16x16x32_bf16 v[80:83], a[0:3], a[236:239], v[80:83]
    v_cvt_pk_bf16_f32 v246, v244, v245
    v_mfma_f32_16x16x32_bf16 v[84:87], a[0:3], a[240:243], v[84:87]
    s_waitcnt vmcnt(12)
    buffer_store_dword v246, v10, s[12:15], s99 offen sc1
    v_mfma_f32_16x16x32_bf16 v[56:59], a[8:11], a[244:247], v[56:59]
    s_waitcnt vmcnt(12)
    v_lshl_add_u32 v11, v1, 3, s63
    v_mfma_f32_16x16x32_bf16 v[60:63], a[8:11], a[248:251], v[60:63]
    ds_read_b64 v[16:17], v11 offset:32896
    ds_read_b32 v18, v3 offset:32896
    v_mfma_f32_16x16x32_bf16 v[64:67], a[12:15], a[244:247], v[64:67]
    s_add_u32 s58, s58, 81920
    v_add_u32 v4, 81920, v4
    v_add_u32 v5, 81920, v5
    v_mfma_f32_16x16x32_bf16 v[68:71], a[12:15], a[248:251], v[68:71]
    s_add_u32 s98, s98, 655360
    s_add_u32 s99, s99, 655360
    v_mfma_f32_16x16x32_bf16 v[72:75], a[16:19], a[244:247], v[72:75]
    v_mfma_f32_16x16x32_bf16 v[76:79], a[16:19], a[248:251], v[76:79]
    v_mfma_f32_16x16x32_bf16 v[80:83], a[20:23], a[244:247], v[80:83]
    v_mfma_f32_16x16x32_bf16 v[84:87], a[20:23], a[248:251], v[84:87]
    s_waitcnt vmcnt(11)
    v_mfma_f32_16x16x32_bf16 v[56:59], a[28:31], a[252:255], v[56:59]
    s_waitcnt vmcnt(10)
    v_mfma_f32_16x16x32_bf16 v[60:63], a[28:31], a[128:131], v[60:63]
    v_mfma_f32_16x16x32_bf16 v[64:67], a[32:35], a[252:255], v[64:67]
    v_mfma_f32_16x16x32_bf16 v[68:71], a[32:35], a[128:131], v[68:71]
    v_mfma_f32_16x16x32_bf16 v[72:75], a[36:39], a[252:255], v[72:75]
    v_mfma_f32_16x16x32_bf16 v[76:79], a[36:39], a[128:131], v[76:79]
    v_mfma_f32_16x16x32_bf16 v[80:83], a[40:43], a[252:255], v[80:83]
    v_mfma_f32_16x16x32_bf16 v[84:87], a[40:43], a[128:131], v[84:87]
    s_waitcnt vmcnt(9)
    v_mfma_f32_16x16x32_bf16 v[56:59], a[48:51], a[132:135], v[56:59]
    s_waitcnt vmcnt(8)
    v_mfma_f32_16x16x32_bf16 v[60:63], a[48:51], a[136:139], v[60:63]
    s_waitcnt vmcnt(7)
    v_mfma_f32_16x16x32_bf16 v[56:59], a[68:71], a[140:143], v[56:59]
    s_waitcnt vmcnt(6)
    v_mfma_f32_16x16x32_bf16 v[60:63], a[68:71], a[144:147], v[60:63]
    s_waitcnt vmcnt(5)
    s_lshl_b32 s48, s3, 11
    s_add_u32 s48, s48, 24576
    v_mfma_f32_16x16x32_bf16 v[56:59], a[88:91], a[148:151], v[56:59]
    s_waitcnt vmcnt(4)
    s_add_u32 s48, s48, s58
    v_add_u32_e64 v9, s48, v13
    v_mfma_f32_16x16x32_bf16 v[60:63], a[88:91], a[152:155], v[60:63]
    s_waitcnt vmcnt(3)
    v_mfma_f32_16x16x32_bf16 v[56:59], a[108:111], a[156:159], v[56:59]
    s_waitcnt vmcnt(2)
    v_mfma_f32_16x16x32_bf16 v[60:63], a[108:111], a[160:163], v[60:63]
    v_mfma_f32_16x16x32_bf16 v[64:67], a[52:55], a[132:135], v[64:67]
    v_mfma_f32_16x16x32_bf16 v[68:71], a[52:55], a[136:139], v[68:71]
    ds_write_b128 v9, v[56:59] offset:0
    v_mfma_f32_16x16x32_bf16 v[64:67], a[72:75], a[140:143], v[64:67]
    ds_write_b128 v9, v[60:63] offset:1024
    v_mfma_f32_16x16x32_bf16 v[68:71], a[72:75], a[144:147], v[68:71]
    s_add_u32 s48, s3, 1
    s_and_b32 s48, s48, 3
    s_mul_i32 s48, s48, 6144
    v_mfma_f32_16x16x32_bf16 v[64:67], a[92:95], a[148:151], v[64:67]
    s_add_u32 s48, s48, s58
    v_add_u32 v9, s48, v13
    v_mfma_f32_16x16x32_bf16 v[68:71], a[92:95], a[152:155], v[68:71]
    v_mfma_f32_16x16x32_bf16 v[64:67], a[112:115], a[156:159], v[64:67]
    v_mfma_f32_16x16x32_bf16 v[68:71], a[112:115], a[160:163], v[68:71]
    v_mfma_f32_16x16x32_bf16 v[72:75], a[56:59], a[132:135], v[72:75]
    v_mfma_f32_16x16x32_bf16 v[76:79], a[56:59], a[136:139], v[76:79]
    ds_write_b128 v9, v[64:67] offset:0
    v_mfma_f32_16x16x32_bf16 v[72:75], a[76:79], a[140:143], v[72:75]
    ds_write_b128 v9, v[68:71] offset:1024
    v_mfma_f32_16x16x32_bf16 v[76:79], a[76:79], a[144:147], v[76:79]
    s_add_u32 s48, s3, 2
    s_and_b32 s48, s48, 3
    s_mul_i32 s48, s48, 6144
    v_mfma_f32_16x16x32_bf16 v[72:75], a[96:99], a[148:151], v[72:75]
    s_add_u32 s48, s48, s58
    v_add_u32 v9, s48, v13
    v_mfma_f32_16x16x32_bf16 v[76:79], a[96:99], a[152:155], v[76:79]
    v_mfma_f32_16x16x32_bf16 v[72:75], a[116:119], a[156:159], v[72:75]
    v_mfma_f32_16x16x32_bf16 v[76:79], a[116:119], a[160:163], v[76:79]
    v_mfma_f32_16x16x32_bf16 v[80:83], a[60:63], a[132:135], v[80:83]
    v_mfma_f32_16x16x32_bf16 v[84:87], a[60:63], a[136:139], v[84:87]
    ds_write_b128 v9, v[72:75] offset:2048
    v_mfma_f32_16x16x32_bf16 v[80:83], a[80:83], a[140:143], v[80:83]
    ds_write_b128 v9, v[76:79] offset:3072
    v_mfma_f32_16x16x32_bf16 v[84:87], a[80:83], a[144:147], v[84:87]
    s_add_u32 s48, s3, 3
    s_and_b32 s48, s48, 3
    s_mul_i32 s48, s48, 6144
    v_mfma_f32_16x16x32_bf16 v[80:83], a[100:103], a[148:151], v[80:83]
    s_add_u32 s48, s48, s58
    v_add_u32 v9, s48, v13
    v_mfma_f32_16x16x32_bf16 v[84:87], a[100:103], a[152:155], v[84:87]
    v_mfma_f32_16x16x32_bf16 v[80:83], a[120:123], a[156:159], v[80:83]
    v_mfma_f32_16x16x32_bf16 v[84:87], a[120:123], a[160:163], v[84:87]
    v_mfma_f32_16x16x32_bf16 v[88:91], v[112:115], a[196:199], v[88:91]
    v_mfma_f32_16x16x32_bf16 v[92:95], v[112:115], a[200:203], v[92:95]
    ds_write_b128 v9, v[80:83] offset:4096
    v_mfma_f32_16x16x32_bf16 v[88:91], v[132:135], a[204:207], v[88:91]
    ds_write_b128 v9, v[84:87] offset:5120
    v_mfma_f32_16x16x32_bf16 v[92:95], v[132:135], a[208:211], v[92:95]
    v_mfma_f32_16x16x32_bf16 v[88:91], v[152:155], a[212:215], v[88:91]
    v_mfma_f32_16x16x32_bf16 v[92:95], v[152:155], a[216:219], v[92:95]
    v_mfma_f32_16x16x32_bf16 v[88:91], v[172:175], a[220:223], v[88:91]
    s_waitcnt lgkmcnt(0)
    s_barrier
    v_mfma_f32_16x16x32_bf16 v[92:95], v[172:175], a[224:227], v[92:95]
    ds_read_b128 v[208:211], v4 offset:0
    ds_read_b128 v[212:215], v4 offset:1024
    v_mfma_f32_16x16x32_bf16 v[88:91], v[192:195], a[228:231], v[88:91]
    ds_read_b128 v[216:219], v4 offset:2048
    ds_read_b128 v[220:223], v4 offset:3072
    v_mfma_f32_16x16x32_bf16 v[92:95], v[192:195], a[232:235], v[92:95]
    ds_read_b128 v[224:227], v4 offset:4096
    ds_read_b128 v[228:231], v4 offset:5120
    v_mfma_f32_16x16x32_bf16 v[88:91], a[4:7], a[236:239], v[88:91]
    ds_read_b64 v[244:245], v5 offset:24576
    ds_read_b64 v[246:247], v5 offset:26624
    v_mfma_f32_16x16x32_bf16 v[92:95], a[4:7], a[240:243], v[92:95]
    ds_read_b64 v[248:249], v5 offset:28672
    ds_read_b64 v[250:251], v5 offset:30720
    v_mfma_f32_16x16x32_bf16 v[88:91], a[24:27], a[244:247], v[88:91]
    s_waitcnt lgkmcnt(7)
    v_add_f32 v208, v208, v216
    v_add_f32_e64 v209, v209, v217
    v_mfma_f32_16x16x32_bf16 v[92:95], a[24:27], a[248:251], v[92:95]
    v_add_f32 v210, v210, v218
    v_add_f32 v211, v211, v219
    v_mfma_f32_16x16x32_bf16 v[88:91], a[44:47], a[252:255], v[88:91]
    s_waitcnt lgkmcnt(6)
    v_add_f32 v212, v212, v220
    v_add_f32_e64 v213, v213, v221
    v_mfma_f32_16x16x32_bf16 v[92:95], a[44:47], a[128:131], v[92:95]
    v_add_f32 v214, v214, v222
    v_add_f32 v215, v215, v223
    v_mfma_f32_16x16x32_bf16 v[88:91], a[64:67], a[132:135], v[88:91]
    s_waitcnt lgkmcnt(5)
    v_add_f32 v208, v208, v224
    v_add_f32_e64 v209, v209, v225
    v_mfma_f32_16x16x32_bf16 v[92:95], a[64:67], a[136:139], v[92:95]
    v_add_f32 v210, v210, v226
    v_add_f32 v211, v211, v227
    v_mfma_f32_16x16x32_bf16 v[88:91], a[84:87], a[140:143], v[88:91]
    s_waitcnt lgkmcnt(4)
    v_add_f32 v212, v212, v228
    v_add_f32_e64 v213, v213, v229
    v_mfma_f32_16x16x32_bf16 v[92:95], a[84:87], a[144:147], v[92:95]
    v_add_f32 v214, v214, v230
    v_add_f32 v215, v215, v231
    v_mfma_f32_16x16x32_bf16 v[88:91], a[104:107], a[148:151], v[88:91]
    v_mul_f32 v208, v208, v16
    v_mul_f32 v209, v209, v16
    v_mfma_f32_16x16x32_bf16 v[92:95], a[104:107], a[152:155], v[92:95]
    v_mul_f32 v210, v210, v16
    v_mul_f32 v211, v211, v16
    v_mfma_f32_16x16x32_bf16 v[88:91], a[124:127], a[156:159], v[88:91]
    v_mul_f32 v212, v212, v17
    v_mul_f32 v213, v213, v17
    v_mfma_f32_16x16x32_bf16 v[92:95], a[124:127], a[160:163], v[92:95]
    v_mul_f32 v214, v214, v17
    v_mul_f32 v215, v215, v17
    s_waitcnt lgkmcnt(2)
    v_add_f32 v244, v244, v246
    v_add_f32 v245, v245, v247
    s_waitcnt lgkmcnt(1)
    v_add_f32 v244, v244, v248
    v_add_f32 v245, v245, v249
    s_waitcnt lgkmcnt(0)
    v_add_f32 v244, v244, v250
    v_add_f32 v245, v245, v251
    v_mul_f32 v244, v244, v18
    v_mul_f32_e64 v245, v245, v18
    v_cvt_pk_bf16_f32 v246, v244, v245
    buffer_store_dword v246, v10, s[12:15], s99 offen sc1
    v_pk_fma_f32 v[208:209], v[88:89], v[16:17], v[208:209] op_sel_hi:[1,0,1]
    v_pk_fma_f32 v[210:211], v[90:91], v[16:17], v[210:211] op_sel_hi:[1,0,1]
    v_pk_fma_f32 v[212:213], v[92:93], v[16:17], v[212:213] op_sel:[0,1,0]
    v_pk_fma_f32 v[214:215], v[94:95], v[16:17], v[214:215] op_sel:[0,1,0]
    v_cvt_pk_bf16_f32 v240, v208, v209
    v_cvt_pk_bf16_f32 v242, v212, v213
    v_cvt_pk_bf16_f32 v241, v210, v211
    v_cvt_pk_bf16_f32 v243, v214, v215
    v_permlane16_swap_b32 v240, v242
    s_nop 0
    v_permlane16_swap_b32_e64 v241, v243
    buffer_store_dwordx4 v[240:243], v8, s[12:15], s98 offen sc1
L_end:
    s_endpgm
L_pw:
    v_lshrrev_b32 v1, 6, v0
    v_and_b32 v0, 63, v0
    v_readfirstlane_b32 s3, v1
    v_and_b32 v1, 15, v0
    v_lshrrev_b32 v2, 4, v0
    s_mul_i32 s92, s49, 128
    s_and_b32 s66, s2, 1
    s_and_b32 s67, s49, 3
    s_and_b32 s50, s2, 2
    s_lshl_b32 s50, s50, 1
    s_add_u32 s67, s67, s50
    s_lshl_b32 s65, s66, 3
    s_add_u32 s65, s65, s67
    s_mov_b32 s68, 0
    s_mul_i32 s48, s3, 3
    s_and_b32 s71, s48, 14
    s_add_u32 s71, s71, s48
    s_lshl_b32 s71, s71, 12
    s_mov_b32 s10, 268435456
    s_mov_b32 s11, 0x00020000
    s_movk_i32 s38, 256
    s_mov_b32 s39, 0x00020000
    s_sub_u32 s56, s2, 160
    s_lshr_b32 s53, s56, 3
    s_and_b32 s57, s53, 1
    s_lshr_b32 s53, s53, 1
    s_and_b32 s50, s2, 7
    s_mul_i32 s58, s50, 6
    s_add_u32 s58, s58, s53
    s_mov_b32 s86, 1966080
    s_mov_b32 s87, 0x00020000
    v_lshrrev_b32 v4, 2, v0
    v_mul_u32_u24 v5, 3, v4
    v_add_u32 v8, s3, v5
    s_lshl_b32 s48, s3, 5
    v_add_u32 v4, s48, v4
    v_mul_u32_u24 v4, 3072, v4
    v_lshrrev_b32 v5, 5, v0
    v_lshlrev_b32 v5, 1, v5
    v_xor_b32 v5, v5, v0
    v_and_b32 v5, 3, v5
    v_lshl_add_u32 v4, v5, 4, v4
    s_lshl_b32 s48, s58, 6
    s_add_u32 s49, s48, 49152
    s_lshl_b32 s50, s3, 11
    s_mov_b32 s51, 393216
    s_bitcmp1_b32 s58, 0
    s_cselect_b32 s52, s49, s48
    s_cselect_b32 s53, s48, s49
    s_cselect_b32 s54, 3, 0
    s_cselect_b32 s55, 1024, 0
    v_add_u32 v8, s54, v8
    s_add_u32 s54, s50, s55
    s_xor_b32 s55, s54, 1024
    v_add_u32_e64 v5, 0, v8
    v_mul_u32_u24 v7, 205, v5
    v_lshrrev_b32 v7, 10, v7
    v_mul_u32_u24 v7, 5, v7
    v_sub_u32_e64 v5, v5, v7
    v_mad_u32_u24 v16, v5, s51, v4
    v_add_u32_e64 v5, 1, v8
    v_mul_u32_u24 v7, 205, v5
    v_lshrrev_b32 v7, 10, v7
    v_mul_u32_u24 v7, 5, v7
    v_sub_u32_e64 v5, v5, v7
    v_mad_u32_u24 v17, v5, s51, v4
    v_add_u32_e64 v5, 2, v8
    v_mul_u32_u24 v7, 205, v5
    v_lshrrev_b32 v7, 10, v7
    v_mul_u32_u24 v7, 5, v7
    v_sub_u32_e64 v5, v5, v7
    v_mad_u32_u24 v18, v5, s51, v4
    v_add_u32_e64 v5, 3, v8
    v_mul_u32_u24 v7, 205, v5
    v_lshrrev_b32 v7, 10, v7
    v_mul_u32_u24 v7, 5, v7
    v_sub_u32_e64 v5, v5, v7
    v_mad_u32_u24 v19, v5, s51, v4
    v_add_u32_e64 v5, 4, v8
    v_mul_u32_u24 v7, 205, v5
    v_lshrrev_b32 v7, 10, v7
    v_mul_u32_u24 v7, 5, v7
    v_sub_u32_e64 v5, v5, v7
    v_mad_u32_u24 v20, v5, s51, v4
    s_cmp_eq_u32 s57, 0
    s_waitcnt lgkmcnt(0)
    s_cselect_b32 s84, s24, s26
    s_cselect_b32 s85, s25, s27
    s_add_u32 m0, s54, 0
    s_nop 0
    buffer_load_dwordx4 v16, s[84:87], s52 offen lds
    s_add_u32 m0, s54, 8192
    s_nop 0
    buffer_load_dwordx4 v17, s[84:87], s52 offen lds
    s_add_u32 m0, s54, 16384
    s_nop 0
    buffer_load_dwordx4 v18, s[84:87], s52 offen lds
    s_add_u32 m0, s54, 24576
    s_nop 0
    buffer_load_dwordx4 v19, s[84:87], s52 offen lds
    s_add_u32 m0, s54, 32768
    s_nop 0
    buffer_load_dwordx4 v20, s[84:87], s52 offen lds
    s_bitcmp1_b32 s58, 0
    s_cselect_b32 s52, 3, 2
    s_lshl_b32 s52, s52, 13
    s_add_u32 m0, s55, s52
    s_nop 0
    buffer_load_dwordx4 v16, s[84:87], s53 offen lds
    s_bitcmp1_b32 s58, 0
    s_cselect_b32 s52, 4, 3
    s_lshl_b32 s52, s52, 13
    s_add_u32 m0, s55, s52
    s_nop 0
    buffer_load_dwordx4 v17, s[84:87], s53 offen lds
    s_bitcmp1_b32 s58, 0
    s_cselect_b32 s52, 0, 4
    s_lshl_b32 s52, s52, 13
    s_add_u32 m0, s55, s52
    s_nop 0
    buffer_load_dwordx4 v18, s[84:87], s53 offen lds
    s_bitcmp1_b32 s58, 0
    s_cselect_b32 s52, 1, 0
    s_lshl_b32 s52, s52, 13
    s_add_u32 m0, s55, s52
    s_nop 0
    buffer_load_dwordx4 v19, s[84:87], s53 offen lds
    s_bitcmp1_b32 s58, 0
    s_cselect_b32 s52, 2, 1
    s_lshl_b32 s52, s52, 13
    s_add_u32 m0, s55, s52
    s_nop 0
    buffer_load_dwordx4 v20, s[84:87], s53 offen lds
    s_mov_b64 s[8:9], s[34:35]
    s_mov_b64 s[36:37], s[32:33]
    s_xor_b32 s4, s3, 0
    s_lshl_b32 s4, s4, 8
    v_and_or_b32 v77, v0, 12, s4
    s_cselect_b32 s4, 0, 1
    buffer_load_dword v76, v77, s[36:39], 0 offen offset:128 sc1
    s_lshl_b32 s48, s3, 4
    v_add_u32 v5, s48, v1
    v_cmp_eq_u32 s[62:63], 0, v5
    v_mul_u32_u24 v5, 77, v5
    v_and_b32 v5, 127, v5
    v_cvt_f32_u32_e64 v5, v5
    v_mul_f32 v5, 0x3c000000, v5
    v_mul_f32 v6, 0x41c80000, v5
    v_lshlrev_b32 v4, 3, v2
    v_cvt_f32_u32 v4, v4
    v_mul_f32_e64 v4, v4, v5
    v_mov_b32 v11, 0xbf803f80
    v_bfe_i32 v3, v1, 0, 1
    v_and_b32 v3, 0x80008000, v3
    v_cos_f32_e64 v7, v4
    v_sin_f32 v9, -v4
    v_add_f32 v4, v4, v5
    v_cos_f32 v8, v4
    v_sin_f32 v10, -v4
    v_add_f32_e64 v4, v4, v5
    v_cvt_pk_bf16_f32 v16, v7, v8
    v_cvt_pk_bf16_f32 v20, v9, v10
    v_xor_b32_e64 v32, v3, v16
    v_cndmask_b32 v20, v20, v11, s[62:63]
    v_xor_b32 v36, v3, v20
    v_cos_f32 v7, v4
    v_sin_f32 v9, -v4
    v_add_f32 v4, v4, v5
    v_cos_f32 v8, v4
    v_sin_f32 v10, -v4
    v_add_f32_e64 v4, v4, v5
    v_cvt_pk_bf16_f32 v17, v7, v8
    v_cvt_pk_bf16_f32 v21, v9, v10
    v_xor_b32_e64 v33, v3, v17
    v_cndmask_b32 v21, v21, v11, s[62:63]
    v_xor_b32 v37, v3, v21
    v_cos_f32 v7, v4
    v_sin_f32 v9, -v4
    v_add_f32 v4, v4, v5
    v_cos_f32 v8, v4
    v_sin_f32 v10, -v4
    v_add_f32_e64 v4, v4, v5
    v_cvt_pk_bf16_f32 v18, v7, v8
    v_cvt_pk_bf16_f32 v22, v9, v10
    v_xor_b32_e64 v34, v3, v18
    v_cndmask_b32 v22, v22, v11, s[62:63]
    v_xor_b32 v38, v3, v22
    v_cos_f32 v7, v4
    v_sin_f32 v9, -v4
    v_add_f32 v4, v4, v5
    v_cos_f32 v8, v4
    v_sin_f32 v10, -v4
    v_add_f32_e64 v4, v4, v6
    v_cvt_pk_bf16_f32 v19, v7, v8
    v_cvt_pk_bf16_f32 v23, v9, v10
    v_xor_b32_e64 v35, v3, v19
    v_cndmask_b32 v23, v23, v11, s[62:63]
    v_xor_b32 v39, v3, v23
    v_cos_f32 v7, v4
    v_sin_f32 v9, -v4
    v_add_f32 v4, v4, v5
    v_cos_f32 v8, v4
    v_sin_f32 v10, -v4
    v_add_f32_e64 v4, v4, v5
    v_cvt_pk_bf16_f32 v24, v7, v8
    v_cvt_pk_bf16_f32 v28, v9, v10
    v_xor_b32_e64 v40, v3, v24
    v_cndmask_b32 v28, v28, v11, s[62:63]
    v_xor_b32 v44, v3, v28
    v_cos_f32 v7, v4
    v_sin_f32 v9, -v4
    v_add_f32 v4, v4, v5
    v_cos_f32 v8, v4
    v_sin_f32 v10, -v4
    v_add_f32_e64 v4, v4, v5
    v_cvt_pk_bf16_f32 v25, v7, v8
    v_cvt_pk_bf16_f32 v29, v9, v10
    v_xor_b32_e64 v41, v3, v25
    v_cndmask_b32 v29, v29, v11, s[62:63]
    v_xor_b32 v45, v3, v29
    v_cos_f32 v7, v4
    v_sin_f32 v9, -v4
    v_add_f32 v4, v4, v5
    v_cos_f32 v8, v4
    v_sin_f32 v10, -v4
    v_add_f32_e64 v4, v4, v5
    v_cvt_pk_bf16_f32 v26, v7, v8
    v_cvt_pk_bf16_f32 v30, v9, v10
    v_xor_b32_e64 v42, v3, v26
    v_cndmask_b32 v30, v30, v11, s[62:63]
    v_xor_b32 v46, v3, v30
    v_cos_f32 v7, v4
    v_sin_f32 v9, -v4
    v_add_f32 v4, v4, v5
    v_cos_f32 v8, v4
    v_sin_f32 v10, -v4
    v_add_f32_e64 v4, v4, v6
    v_cvt_pk_bf16_f32 v27, v7, v8
    v_cvt_pk_bf16_f32 v31, v9, v10
    v_xor_b32_e64 v43, v3, v27
    v_cndmask_b32 v31, v31, v11, s[62:63]
    v_xor_b32_e64 v47, v3, v31
    s_mov_b32 s84, 0x3d64f92e
    s_mov_b32 s85, 0x3c8d8369
    s_mov_b32 s86, 0xbd393e4c
    s_mov_b32 s87, 0xbd59c440
    s_mov_b32 s88, 0xbd069650
    s_mov_b32 s89, 0x3d59c440
    v_add_u32 v4, s3, v2
    v_cmp_eq_u32 vcc, 0, v4
    v_mov_b32 v13, 1.0
    v_mov_b32 v4, 0
    v_mov_b32 v221, 0x3d64f92e
    v_mov_b32 v5, 0x3d21e89b
    v_cndmask_b32 v12, v13, v4, vcc
    v_mov_b32 v223, v221
    v_cndmask_b32 v220, v221, v4, vcc
    v_cndmask_b32 v222, v221, v5, vcc
    v_lshrrev_b32 v14, 3, v0
    v_and_b32 v15, 7, v0
    s_and_b32 s50, s3, 1
    s_lshr_b32 s51, s3, 1
    s_lshl_b32 s50, s50, 3
    v_add_u32 v6, s50, v14
    v_xor_b32 v6, v6, v15
    v_lshlrev_b32 v6, 4, v6
    s_lshl_b32 s51, s51, 3
    v_add_u32 v4, s51, v15
    v_and_b32_e64 v5, 3, v4
    v_lshl_add_u32 v6, v5, 8, v6
    v_lshrrev_b32_e64 v5, 2, v4
    v_mul_u32_u24 v5, 5120, v5
    v_add_u32 v6, v6, v5
    v_add_u32 v5, 0, v4
    v_mul_u32_u24 v7, 205, v5
    v_lshrrev_b32 v7, 10, v7
    v_mul_u32_u24 v7, 5, v7
    v_sub_u32_e64 v5, v5, v7
    v_lshl_add_u32 v68, v5, 10, v6
    v_add_u32_e64 v5, 1, v4
    v_mul_u32_u24 v7, 205, v5
    v_lshrrev_b32 v7, 10, v7
    v_mul_u32_u24 v7, 5, v7
    v_sub_u32_e64 v5, v5, v7
    v_lshl_add_u32 v69, v5, 10, v6
    v_add_u32_e64 v5, 2, v4
    v_mul_u32_u24 v7, 205, v5
    v_lshrrev_b32 v7, 10, v7
    v_mul_u32_u24 v7, 5, v7
    v_sub_u32_e64 v5, v5, v7
    v_lshl_add_u32 v70, v5, 10, v6
    v_add_u32_e64 v5, 3, v4
    v_mul_u32_u24 v7, 205, v5
    v_lshrrev_b32 v7, 10, v7
    v_mul_u32_u24 v7, 5, v7
    v_sub_u32_e64 v5, v5, v7
    v_lshl_add_u32 v71, v5, 10, v6
    v_add_u32_e64 v5, 4, v4
    v_mul_u32_u24 v7, 205, v5
    v_lshrrev_b32 v7, 10, v7
    v_mul_u32_u24 v7, 5, v7
    v_sub_u32_e64 v5, v5, v7
    v_lshl_add_u32 v72, v5, 10, v6
    v_lshrrev_b32_e64 v4, 2, v1
    v_lshl_add_u32 v4, v2, 3, v4
    v_lshlrev_b32 v4, 6, v4
    v_and_b32 v5, 1, v2
    v_lshl_add_u32 v4, v5, 5, v4
    v_and_b32_e64 v5, 3, v0
    v_lshl_add_u32 v4, v5, 3, v4
    v_xor_b32_e64 v5, 32, v4
    v_bfe_u32 v6, v0, 2, 1
    v_and_b32_e64 v7, 0x33, v0
    v_lshl_add_u32 v6, v6, 3, v7
    v_lshlrev_b32 v6, 4, v6
    s_lshl_b32 s48, s58, 2
    v_bfe_u32 v7, v0, 3, 1
    v_add_u32_e64 v7, s48, v7
    v_mul_u32_u24 v8, 171, v7
    v_lshrrev_b32_e64 v8, 9, v8
    v_mad_u32_u24 v8, v8, 57, v7
    v_lshl_add_u32 v14, v8, 10, v6
    v_add_u32_e64 v7, 2, v7
    v_mul_u32_u24 v8, 171, v7
    v_lshrrev_b32_e64 v8, 9, v8
    v_mad_u32_u24 v8, v8, 57, v7
    v_lshl_add_u32 v15, v8, 10, v6
    s_waitcnt vmcnt(1)
    s_barrier
    ds_read_b64_tr_b16 v[176:177], v4 offset:0
    ds_read_b64_tr_b16 v[178:179], v4 offset:256
    ds_read_b64_tr_b16 v[180:181], v4 offset:8192
    ds_read_b64_tr_b16 v[182:183], v4 offset:8448
    ds_read_b64_tr_b16 v[184:185], v4 offset:16384
    ds_read_b64_tr_b16 v[186:187], v4 offset:16640
    ds_read_b64_tr_b16 v[188:189], v4 offset:24576
    ds_read_b64_tr_b16 v[190:191], v4 offset:24832
    ds_read_b64_tr_b16 v[192:193], v4 offset:32768
    ds_read_b64_tr_b16 v[194:195], v4 offset:33024
    ds_read_b64_tr_b16 v[196:197], v4 offset:2048
    ds_read_b64_tr_b16 v[198:199], v4 offset:2304
    s_waitcnt lgkmcnt(10)
    v_mfma_f32_16x16x32_bf16 v[88:91], v[16:19], v[176:179], 0
    v_mfma_f32_16x16x32_bf16 v[92:95], v[20:23], v[176:179], 0
    ds_read_b64_tr_b16 v[176:177], v4 offset:10240
    ds_read_b64_tr_b16 v[178:179], v4 offset:10496
    s_waitcnt lgkmcnt(10)
    v_mfma_f32_16x16x32_bf16 v[96:99], v[16:19], v[180:183], 0
    v_mfma_f32_16x16x32_bf16 v[100:103], v[20:23], v[180:183], 0
    ds_read_b64_tr_b16 v[180:181], v4 offset:18432
    ds_read_b64_tr_b16 v[182:183], v4 offset:18688
    s_waitcnt lgkmcnt(10)
    v_mfma_f32_16x16x32_bf16 v[104:107], v[16:19], v[184:187], 0
    v_mfma_f32_16x16x32_bf16 v[108:111], v[20:23], v[184:187], 0
    ds_read_b64_tr_b16 v[184:185], v4 offset:26624
    ds_read_b64_tr_b16 v[186:187], v4 offset:26880
    s_waitcnt lgkmcnt(10)
    v_mfma_f32_16x16x32_bf16 v[112:115], v[16:19], v[188:191], 0
    v_mfma_f32_16x16x32_bf16 v[116:119], v[20:23], v[188:191], 0
    ds_read_b64_tr_b16 v[188:189], v4 offset:34816
    ds_read_b64_tr_b16 v[190:191], v4 offset:35072
    s_waitcnt lgkmcnt(10)
    v_mfma_f32_16x16x32_bf16 v[120:123], v[16:19], v[192:195], 0
    v_mfma_f32_16x16x32_bf16 v[124:127], v[20:23], v[192:195], 0
    ds_read_b64_tr_b16 v[192:193], v4 offset:4096
    ds_read_b64_tr_b16 v[194:195], v4 offset:4352
    s_waitcnt lgkmcnt(10)
    v_mfma_f32_16x16x32_bf16 v[88:91], v[24:27], v[196:199], v[88:91]
    v_mfma_f32_16x16x32_bf16 v[92:95], v[28:31], v[196:199], v[92:95]
    ds_read_b64_tr_b16 v[196:197], v4 offset:12288
    ds_read_b64_tr_b16 v[198:199], v4 offset:12544
    s_waitcnt lgkmcnt(10)
    v_mfma_f32_16x16x32_bf16 v[96:99], v[24:27], v[176:179], v[96:99]
    v_mfma_f32_16x16x32_bf16 v[100:103], v[28:31], v[176:179], v[100:103]
    ds_read_b64_tr_b16 v[176:177], v4 offset:20480
    ds_read_b64_tr_b16 v[178:179], v4 offset:20736
    s_waitcnt lgkmcnt(10)
    v_mfma_f32_16x16x32_bf16 v[104:107], v[24:27], v[180:183], v[104:107]
    v_mfma_f32_16x16x32_bf16 v[108:111], v[28:31], v[180:183], v[108:111]
    ds_read_b64_tr_b16 v[180:181], v4 offset:28672
    ds_read_b64_tr_b16 v[182:183], v4 offset:28928
    s_waitcnt lgkmcnt(10)
    v_mfma_f32_16x16x32_bf16 v[112:115], v[24:27], v[184:187], v[112:115]
    v_mfma_f32_16x16x32_bf16 v[116:119], v[28:31], v[184:187], v[116:119]
    ds_read_b64_tr_b16 v[184:185], v4 offset:36864
    ds_read_b64_tr_b16 v[186:187], v4 offset:37120
    s_waitcnt lgkmcnt(10)
    v_mfma_f32_16x16x32_bf16 v[120:123], v[24:27], v[188:191], v[120:123]
    v_mfma_f32_16x16x32_bf16 v[124:127], v[28:31], v[188:191], v[124:127]
    ds_read_b64_tr_b16 v[188:189], v4 offset:6144
    ds_read_b64_tr_b16 v[190:191], v4 offset:6400
    s_waitcnt lgkmcnt(10)
    v_mfma_f32_16x16x32_bf16 v[88:91], v[32:35], v[192:195], v[88:91]
    v_mfma_f32_16x16x32_bf16 v[92:95], v[36:39], v[192:195], v[92:95]
    ds_read_b64_tr_b16 v[192:193], v4 offset:14336
    ds_read_b64_tr_b16 v[194:195], v4 offset:14592
    s_waitcnt lgkmcnt(10)
    v_mfma_f32_16x16x32_bf16 v[96:99], v[32:35], v[196:199], v[96:99]
    v_mfma_f32_16x16x32_bf16 v[100:103], v[36:39], v[196:199], v[100:103]
    ds_read_b64_tr_b16 v[196:197], v4 offset:22528
    ds_read_b64_tr_b16 v[198:199], v4 offset:22784
    s_waitcnt lgkmcnt(10)
    v_mfma_f32_16x16x32_bf16 v[104:107], v[32:35], v[176:179], v[104:107]
    v_mfma_f32_16x16x32_bf16 v[108:111], v[36:39], v[176:179], v[108:111]
    ds_read_b64_tr_b16 v[176:177], v4 offset:30720
    ds_read_b64_tr_b16 v[178:179], v4 offset:30976
    s_waitcnt lgkmcnt(10)
    v_mfma_f32_16x16x32_bf16 v[112:115], v[32:35], v[180:183], v[112:115]
    v_mfma_f32_16x16x32_bf16 v[116:119], v[36:39], v[180:183], v[116:119]
    ds_read_b64_tr_b16 v[180:181], v4 offset:38912
    ds_read_b64_tr_b16 v[182:183], v4 offset:39168
    s_waitcnt lgkmcnt(10)
    v_mfma_f32_16x16x32_bf16 v[120:123], v[32:35], v[184:187], v[120:123]
    v_mfma_f32_16x16x32_bf16 v[124:127], v[36:39], v[184:187], v[124:127]
    ds_read_b64_tr_b16 v[184:185], v5 offset:0
    ds_read_b64_tr_b16 v[186:187], v5 offset:256
    s_waitcnt lgkmcnt(10)
    v_mfma_f32_16x16x32_bf16 v[88:91], v[40:43], v[188:191], v[88:91]
    v_mfma_f32_16x16x32_bf16 v[92:95], v[44:47], v[188:191], v[92:95]
    ds_read_b64_tr_b16 v[188:189], v5 offset:8192
    ds_read_b64_tr_b16 v[190:191], v5 offset:8448
    s_waitcnt lgkmcnt(10)
    v_mfma_f32_16x16x32_bf16 v[96:99], v[40:43], v[192:195], v[96:99]
    v_mfma_f32_16x16x32_bf16 v[100:103], v[44:47], v[192:195], v[100:103]
    ds_read_b64_tr_b16 v[192:193], v5 offset:16384
    ds_read_b64_tr_b16 v[194:195], v5 offset:16640
    s_waitcnt lgkmcnt(10)
    v_mfma_f32_16x16x32_bf16 v[104:107], v[40:43], v[196:199], v[104:107]
    v_mfma_f32_16x16x32_bf16 v[108:111], v[44:47], v[196:199], v[108:111]
    ds_read_b64_tr_b16 v[196:197], v5 offset:24576
    ds_read_b64_tr_b16 v[198:199], v5 offset:24832
    s_waitcnt lgkmcnt(10)
    v_mfma_f32_16x16x32_bf16 v[112:115], v[40:43], v[176:179], v[112:115]
    v_mfma_f32_16x16x32_bf16 v[116:119], v[44:47], v[176:179], v[116:119]
    ds_read_b64_tr_b16 v[176:177], v5 offset:32768
    ds_read_b64_tr_b16 v[178:179], v5 offset:33024
    s_waitcnt lgkmcnt(10)
    v_mfma_f32_16x16x32_bf16 v[120:123], v[40:43], v[180:183], v[120:123]
    v_mfma_f32_16x16x32_bf16 v[124:127], v[44:47], v[180:183], v[124:127]
    s_mul_i32 s52, s3, 15360
    s_lshl_b32 s49, s57, 6
    s_add_u32 s52, s52, s49
    s_add_u32 s52, s52, 23068672
    s_add_u32 s53, s52, 6144
    s_add_u32 s54, s52, 12288
    ds_read_b64_tr_b16 v[180:181], v5 offset:2048
    ds_read_b64_tr_b16 v[182:183], v5 offset:2304
    s_waitcnt lgkmcnt(10)
    v_mfma_f32_16x16x32_bf16 v[128:131], v[16:19], v[184:187], 0
    v_mfma_f32_16x16x32_bf16 v[132:135], v[20:23], v[184:187], 0
    ds_read_b64_tr_b16 v[184:185], v5 offset:10240
    ds_read_b64_tr_b16 v[186:187], v5 offset:10496
    s_waitcnt lgkmcnt(10)
    v_mfma_f32_16x16x32_bf16 v[136:139], v[16:19], v[188:191], 0
    v_mfma_f32_16x16x32_bf16 v[140:143], v[20:23], v[188:191], 0
    ds_read_b64_tr_b16 v[188:189], v5 offset:18432
    ds_read_b64_tr_b16 v[190:191], v5 offset:18688
    s_waitcnt lgkmcnt(10)
    v_mfma_f32_16x16x32_bf16 v[144:147], v[16:19], v[192:195], 0
    v_mfma_f32_16x16x32_bf16 v[148:151], v[20:23], v[192:195], 0
    ds_read_b64_tr_b16 v[192:193], v5 offset:26624
    ds_read_b64_tr_b16 v[194:195], v5 offset:26880
    s_waitcnt lgkmcnt(10)
    v_mfma_f32_16x16x32_bf16 v[152:155], v[16:19], v[196:199], 0
    v_mfma_f32_16x16x32_bf16 v[156:159], v[20:23], v[196:199], 0
    ds_read_b64_tr_b16 v[196:197], v5 offset:34816
    ds_read_b64_tr_b16 v[198:199], v5 offset:35072
    s_waitcnt lgkmcnt(10)
    v_mfma_f32_16x16x32_bf16 v[160:163], v[16:19], v[176:179], 0
    v_mfma_f32_16x16x32_bf16 v[164:167], v[20:23], v[176:179], 0
    ds_read_b64_tr_b16 v[176:177], v5 offset:4096
    ds_read_b64_tr_b16 v[178:179], v5 offset:4352
    s_waitcnt lgkmcnt(10)
    v_mfma_f32_16x16x32_bf16 v[128:131], v[24:27], v[180:183], v[128:131]
    v_mfma_f32_16x16x32_bf16 v[132:135], v[28:31], v[180:183], v[132:135]
    ds_read_b64_tr_b16 v[180:181], v5 offset:12288
    ds_read_b64_tr_b16 v[182:183], v5 offset:12544
    s_waitcnt lgkmcnt(10)
    v_mfma_f32_16x16x32_bf16 v[136:139], v[24:27], v[184:187], v[136:139]
    v_mfma_f32_16x16x32_bf16 v[140:143], v[28:31], v[184:187], v[140:143]
    ds_read_b64_tr_b16 v[184:185], v5 offset:20480
    ds_read_b64_tr_b16 v[186:187], v5 offset:20736
    s_waitcnt lgkmcnt(10)
    v_mfma_f32_16x16x32_bf16 v[144:147], v[24:27], v[188:191], v[144:147]
    v_mfma_f32_16x16x32_bf16 v[148:151], v[28:31], v[188:191], v[148:151]
    ds_read_b64_tr_b16 v[188:189], v5 offset:28672
    ds_read_b64_tr_b16 v[190:191], v5 offset:28928
    s_waitcnt lgkmcnt(10)
    v_mfma_f32_16x16x32_bf16 v[152:155], v[24:27], v[192:195], v[152:155]
    v_mfma_f32_16x16x32_bf16 v[156:159], v[28:31], v[192:195], v[156:159]
    ds_read_b64_tr_b16 v[192:193], v5 offset:36864
    ds_read_b64_tr_b16 v[194:195], v5 offset:37120
    s_waitcnt lgkmcnt(10)
    v_mfma_f32_16x16x32_bf16 v[160:163], v[24:27], v[196:199], v[160:163]
    v_mfma_f32_16x16x32_bf16 v[164:167], v[28:31], v[196:199], v[164:167]
    ds_read_b64_tr_b16 v[196:197], v5 offset:6144
    ds_read_b64_tr_b16 v[198:199], v5 offset:6400
    s_waitcnt lgkmcnt(10)
    v_mfma_f32_16x16x32_bf16 v[128:131], v[32:35], v[176:179], v[128:131]
    v_mfma_f32_16x16x32_bf16 v[132:135], v[36:39], v[176:179], v[132:135]
    ds_read_b64_tr_b16 v[176:177], v5 offset:14336
    ds_read_b64_tr_b16 v[178:179], v5 offset:14592
    s_waitcnt lgkmcnt(10)
    v_mfma_f32_16x16x32_bf16 v[136:139], v[32:35], v[180:183], v[136:139]
    v_mfma_f32_16x16x32_bf16 v[140:143], v[36:39], v[180:183], v[140:143]
    ds_read_b64_tr_b16 v[180:181], v5 offset:22528
    ds_read_b64_tr_b16 v[182:183], v5 offset:22784
    s_waitcnt lgkmcnt(10)
    v_mfma_f32_16x16x32_bf16 v[144:147], v[32:35], v[184:187], v[144:147]
    v_mfma_f32_16x16x32_bf16 v[148:151], v[36:39], v[184:187], v[148:151]
    ds_read_b64_tr_b16 v[184:185], v5 offset:30720
    ds_read_b64_tr_b16 v[186:187], v5 offset:30976
    s_waitcnt lgkmcnt(10)
    v_mfma_f32_16x16x32_bf16 v[152:155], v[32:35], v[188:191], v[152:155]
    v_mfma_f32_16x16x32_bf16 v[156:159], v[36:39], v[188:191], v[156:159]
    ds_read_b64_tr_b16 v[188:189], v5 offset:38912
    ds_read_b64_tr_b16 v[190:191], v5 offset:39168
    s_waitcnt lgkmcnt(10)
    v_mfma_f32_16x16x32_bf16 v[160:163], v[32:35], v[192:195], v[160:163]
    v_mfma_f32_16x16x32_bf16 v[164:167], v[36:39], v[192:195], v[164:167]
    s_waitcnt lgkmcnt(8)
    v_mfma_f32_16x16x32_bf16 v[128:131], v[40:43], v[196:199], v[128:131]
    v_mfma_f32_16x16x32_bf16 v[132:135], v[44:47], v[196:199], v[132:135]
    s_waitcnt lgkmcnt(6)
    v_mfma_f32_16x16x32_bf16 v[136:139], v[40:43], v[176:179], v[136:139]
    v_mfma_f32_16x16x32_bf16 v[140:143], v[44:47], v[176:179], v[140:143]
    s_waitcnt lgkmcnt(4)
    v_mfma_f32_16x16x32_bf16 v[144:147], v[40:43], v[180:183], v[144:147]
    v_mfma_f32_16x16x32_bf16 v[148:151], v[44:47], v[180:183], v[148:151]
    s_waitcnt lgkmcnt(2)
    v_mfma_f32_16x16x32_bf16 v[152:155], v[40:43], v[184:187], v[152:155]
    v_mfma_f32_16x16x32_bf16 v[156:159], v[44:47], v[184:187], v[156:159]
    s_waitcnt lgkmcnt(0)
    v_mfma_f32_16x16x32_bf16 v[160:163], v[40:43], v[188:191], v[160:163]
    v_mfma_f32_16x16x32_bf16 v[164:167], v[44:47], v[188:191], v[164:167]
    v_pk_add_f32 v[208:209], v[96:97], v[120:121]
    v_pk_add_f32 v[210:211], v[104:105], v[112:113]
    v_pk_add_f32 v[212:213], v[96:97], v[120:121] neg_lo:[0,1] neg_hi:[0,1]
    v_pk_add_f32 v[214:215], v[104:105], v[112:113] neg_lo:[0,1] neg_hi:[0,1]
    v_pk_mul_f32 v[216:217], v[88:89], s[84:85] op_sel_hi:[1,0]
    v_pk_add_f32 v[88:89], v[88:89], v[208:209]
    v_pk_fma_f32 v[96:97], v[208:209], s[84:85], v[216:217] op_sel:[0,1,0]
    v_pk_fma_f32 v[104:105], v[208:209], s[86:87], v[216:217] op_sel_hi:[1,0,1]
    v_pk_mul_f32 v[120:121], v[212:213], s[86:87] op_sel:[0,1]
    v_pk_mul_f32 v[112:113], v[212:213], s[88:89] op_sel_hi:[1,0]
    v_pk_add_f32 v[88:89], v[88:89], v[210:211]
    v_pk_fma_f32 v[96:97], v[210:211], s[86:87], v[96:97] op_sel_hi:[1,0,1]
    v_pk_fma_f32 v[104:105], v[210:211], s[84:85], v[104:105] op_sel:[0,1,0]
    v_pk_fma_f32 v[120:121], v[214:215], s[88:89], v[120:121] op_sel_hi:[1,0,1]
    v_pk_fma_f32 v[112:113], v[214:215], s[88:89], v[112:113] op_sel:[0,1,0]
    v_pk_mul_f32 v[88:89], v[88:89], v[220:221]
    v_pk_add_f32 v[208:209], v[100:101], v[124:125]
    v_pk_add_f32 v[210:211], v[108:109], v[116:117]
    v_pk_add_f32 v[212:213], v[100:101], v[124:125] neg_lo:[0,1] neg_hi:[0,1]
    v_pk_add_f32 v[214:215], v[108:109], v[116:117] neg_lo:[0,1] neg_hi:[0,1]
    v_pk_mul_f32 v[216:217], v[92:93], s[84:85] op_sel_hi:[1,0]
    v_pk_add_f32 v[92:93], v[92:93], v[208:209]
    v_pk_fma_f32 v[100:101], v[208:209], s[84:85], v[216:217] op_sel:[0,1,0]
    v_pk_fma_f32 v[108:109], v[208:209], s[86:87], v[216:217] op_sel_hi:[1,0,1]
    v_pk_mul_f32 v[124:125], v[212:213], s[86:87] op_sel:[0,1]
    v_pk_mul_f32 v[116:117], v[212:213], s[88:89] op_sel_hi:[1,0]
    v_pk_add_f32 v[92:93], v[92:93], v[210:211]
    v_pk_fma_f32 v[100:101], v[210:211], s[86:87], v[100:101] op_sel_hi:[1,0,1]
    v_pk_fma_f32 v[108:109], v[210:211], s[84:85], v[108:109] op_sel:[0,1,0]
    v_pk_fma_f32 v[124:125], v[214:215], s[88:89], v[124:125] op_sel_hi:[1,0,1]
    v_pk_fma_f32 v[116:117], v[214:215], s[88:89], v[116:117] op_sel:[0,1,0]
    v_pk_mul_f32 v[92:93], v[92:93], v[222:223]
    v_pk_fma_f32 v[218:219], v[124:125], v[12:13], v[96:97] neg_lo:[1,0,0] neg_hi:[1,0,0]
    v_pk_fma_f32 v[124:125], v[96:97], v[12:13], v[124:125]
    v_pk_fma_f32 v[96:97], v[100:101], v[12:13], v[120:121]
    v_pk_fma_f32 v[100:101], v[120:121], v[12:13], v[100:101] neg_lo:[1,0,0] neg_hi:[1,0,0]
    v_pk_fma_f32 v[120:121], v[116:117], v[12:13], v[104:105] neg_lo:[1,0,0] neg_hi:[1,0,0]
    v_pk_fma_f32 v[116:117], v[104:105], v[12:13], v[116:117]
    v_pk_fma_f32 v[104:105], v[108:109], v[12:13], v[112:113]
    v_pk_fma_f32 v[108:109], v[112:113], v[12:13], v[108:109] neg_lo:[1,0,0] neg_hi:[1,0,0]
    v_pk_add_f32 v[208:209], v[98:99], v[122:123]
    v_pk_add_f32 v[210:211], v[106:107], v[114:115]
    v_pk_add_f32 v[212:213], v[98:99], v[122:123] neg_lo:[0,1] neg_hi:[0,1]
    v_pk_add_f32 v[214:215], v[106:107], v[114:115] neg_lo:[0,1] neg_hi:[0,1]
    v_pk_mul_f32 v[216:217], v[90:91], s[84:85] op_sel_hi:[1,0]
    v_pk_add_f32 v[90:91], v[90:91], v[208:209]
    v_pk_fma_f32 v[98:99], v[208:209], s[84:85], v[216:217] op_sel:[0,1,0]
    v_pk_fma_f32 v[106:107], v[208:209], s[86:87], v[216:217] op_sel_hi:[1,0,1]
    v_pk_mul_f32 v[122:123], v[212:213], s[86:87] op_sel:[0,1]
    v_pk_mul_f32 v[114:115], v[212:213], s[88:89] op_sel_hi:[1,0]
    v_pk_add_f32 v[90:91], v[90:91], v[210:211]
    v_pk_fma_f32 v[98:99], v[210:211], s[86:87], v[98:99] op_sel_hi:[1,0,1]
    v_pk_fma_f32 v[106:107], v[210:211], s[84:85], v[106:107] op_sel:[0,1,0]
    v_pk_fma_f32 v[122:123], v[214:215], s[88:89], v[122:123] op_sel_hi:[1,0,1]
    v_pk_fma_f32 v[114:115], v[214:215], s[88:89], v[114:115] op_sel:[0,1,0]
    v_pk_mul_f32 v[90:91], v[90:91], s[84:85] op_sel_hi:[1,0]
    v_pk_add_f32 v[208:209], v[102:103], v[126:127]
    v_pk_add_f32 v[210:211], v[110:111], v[118:119]
    v_pk_add_f32 v[212:213], v[102:103], v[126:127] neg_lo:[0,1] neg_hi:[0,1]
    v_pk_add_f32 v[214:215], v[110:111], v[118:119] neg_lo:[0,1] neg_hi:[0,1]
    v_pk_mul_f32 v[216:217], v[94:95], s[84:85] op_sel_hi:[1,0]
    v_pk_add_f32 v[94:95], v[94:95], v[208:209]
    v_pk_fma_f32 v[102:103], v[208:209], s[84:85], v[216:217] op_sel:[0,1,0]
    v_pk_fma_f32 v[110:111], v[208:209], s[86:87], v[216:217] op_sel_hi:[1,0,1]
    v_pk_mul_f32 v[126:127], v[212:213], s[86:87] op_sel:[0,1]
    v_pk_mul_f32 v[118:119], v[212:213], s[88:89] op_sel_hi:[1,0]
    v_pk_add_f32 v[94:95], v[94:95], v[210:211]
    v_pk_fma_f32 v[102:103], v[210:211], s[86:87], v[102:103] op_sel_hi:[1,0,1]
    v_pk_fma_f32 v[110:111], v[210:211], s[84:85], v[110:111] op_sel:[0,1,0]
    v_pk_fma_f32 v[126:127], v[214:215], s[88:89], v[126:127] op_sel_hi:[1,0,1]
    v_pk_fma_f32 v[118:119], v[214:215], s[88:89], v[118:119] op_sel:[0,1,0]
    v_pk_mul_f32 v[94:95], v[94:95], s[84:85] op_sel_hi:[1,0]
    v_pk_add_f32 v[112:113], v[98:99], v[126:127] neg_lo:[0,1] neg_hi:[0,1]
    v_pk_add_f32 v[126:127], v[126:127], v[98:99]
    v_pk_add_f32 v[98:99], v[122:123], v[102:103]
    v_pk_add_f32 v[102:103], v[102:103], v[122:123] neg_lo:[0,1] neg_hi:[0,1]
    v_pk_add_f32 v[122:123], v[106:107], v[118:119] neg_lo:[0,1] neg_hi:[0,1]
    v_pk_add_f32 v[118:119], v[118:119], v[106:107]
    v_pk_add_f32 v[106:107], v[114:115], v[110:111]
    v_pk_add_f32 v[110:111], v[110:111], v[114:115] neg_lo:[0,1] neg_hi:[0,1]
    v_cvt_pk_bf16_f32 v224, v88, v92
    v_cvt_pk_bf16_f32 v225, v89, v93
    v_cvt_pk_bf16_f32 v226, v90, v94
    v_cvt_pk_bf16_f32 v227, v91, v95
    buffer_store_dwordx4 v[224:227], v14, s[8:11], s52 offen offset:0 sc1
    v_cvt_pk_bf16_f32 v228, v218, v96
    v_cvt_pk_bf16_f32 v229, v219, v97
    v_cvt_pk_bf16_f32 v230, v112, v98
    v_cvt_pk_bf16_f32 v231, v113, v99
    buffer_store_dwordx4 v[228:231], v14, s[8:11], s52 offen offset:3072 sc1
    v_cvt_pk_bf16_f32 v232, v120, v104
    v_cvt_pk_bf16_f32 v233, v121, v105
    v_cvt_pk_bf16_f32 v234, v122, v106
    v_cvt_pk_bf16_f32 v235, v123, v107
    buffer_store_dwordx4 v[232:235], v14, s[8:11], s53 offen offset:0 sc1
    v_cvt_pk_bf16_f32 v236, v116, v108
    v_cvt_pk_bf16_f32 v237, v117, v109
    v_cvt_pk_bf16_f32 v238, v118, v110
    v_cvt_pk_bf16_f32 v239, v119, v111
    buffer_store_dwordx4 v[236:239], v14, s[8:11], s53 offen offset:3072 sc1
    v_cvt_pk_bf16_f32 v240, v124, v100
    v_cvt_pk_bf16_f32 v241, v125, v101
    v_cvt_pk_bf16_f32 v242, v126, v102
    v_cvt_pk_bf16_f32 v243, v127, v103
    buffer_store_dwordx4 v[240:243], v14, s[8:11], s54 offen offset:0 sc1
    v_pk_add_f32 v[208:209], v[136:137], v[160:161]
    v_pk_add_f32 v[210:211], v[144:145], v[152:153]
    v_pk_add_f32 v[212:213], v[136:137], v[160:161] neg_lo:[0,1] neg_hi:[0,1]
    v_pk_add_f32 v[214:215], v[144:145], v[152:153] neg_lo:[0,1] neg_hi:[0,1]
    v_pk_mul_f32 v[216:217], v[128:129], s[84:85] op_sel_hi:[1,0]
    v_pk_add_f32 v[128:129], v[128:129], v[208:209]
    v_pk_fma_f32 v[136:137], v[208:209], s[84:85], v[216:217] op_sel:[0,1,0]
    v_pk_fma_f32 v[144:145], v[208:209], s[86:87], v[216:217] op_sel_hi:[1,0,1]
    v_pk_mul_f32 v[160:161], v[212:213], s[86:87] op_sel:[0,1]
    v_pk_mul_f32 v[152:153], v[212:213], s[88:89] op_sel_hi:[1,0]
    v_pk_add_f32 v[128:129], v[128:129], v[210:211]
    v_pk_fma_f32 v[136:137], v[210:211], s[86:87], v[136:137] op_sel_hi:[1,0,1]
    v_pk_fma_f32 v[144:145], v[210:211], s[84:85], v[144:145] op_sel:[0,1,0]
    v_pk_fma_f32 v[160:161], v[214:215], s[88:89], v[160:161] op_sel_hi:[1,0,1]
    v_pk_fma_f32 v[152:153], v[214:215], s[88:89], v[152:153] op_sel:[0,1,0]
    v_pk_mul_f32 v[128:129], v[128:129], v[220:221]
    v_pk_add_f32 v[208:209], v[140:141], v[164:165]
    v_pk_add_f32 v[210:211], v[148:149], v[156:157]
    v_pk_add_f32 v[212:213], v[140:141], v[164:165] neg_lo:[0,1] neg_hi:[0,1]
    v_pk_add_f32 v[214:215], v[148:149], v[156:157] neg_lo:[0,1] neg_hi:[0,1]
    v_pk_mul_f32 v[216:217], v[132:133], s[84:85] op_sel_hi:[1,0]
    v_pk_add_f32 v[132:133], v[132:133], v[208:209]
    v_pk_fma_f32 v[140:141], v[208:209], s[84:85], v[216:217] op_sel:[0,1,0]
    v_pk_fma_f32 v[148:149], v[208:209], s[86:87], v[216:217] op_sel_hi:[1,0,1]
    v_pk_mul_f32 v[164:165], v[212:213], s[86:87] op_sel:[0,1]
    v_pk_mul_f32 v[156:157], v[212:213], s[88:89] op_sel_hi:[1,0]
    v_pk_add_f32 v[132:133], v[132:133], v[210:211]
    v_pk_fma_f32 v[140:141], v[210:211], s[86:87], v[140:141] op_sel_hi:[1,0,1]
    v_pk_fma_f32 v[148:149], v[210:211], s[84:85], v[148:149] op_sel:[0,1,0]
    v_pk_fma_f32 v[164:165], v[214:215], s[88:89], v[164:165] op_sel_hi:[1,0,1]
    v_pk_fma_f32 v[156:157], v[214:215], s[88:89], v[156:157] op_sel:[0,1,0]
    v_pk_mul_f32 v[132:133], v[132:133], v[222:223]
    v_pk_fma_f32 v[114:115], v[164:165], v[12:13], v[136:137] neg_lo:[1,0,0] neg_hi:[1,0,0]
    v_pk_fma_f32 v[164:165], v[136:137], v[12:13], v[164:165]
    v_pk_fma_f32 v[136:137], v[140:141], v[12:13], v[160:161]
    v_pk_fma_f32 v[140:141], v[160:161], v[12:13], v[140:141] neg_lo:[1,0,0] neg_hi:[1,0,0]
    v_pk_fma_f32 v[160:161], v[156:157], v[12:13], v[144:145] neg_lo:[1,0,0] neg_hi:[1,0,0]
    v_pk_fma_f32 v[156:157], v[144:145], v[12:13], v[156:157]
    v_pk_fma_f32 v[144:145], v[148:149], v[12:13], v[152:153]
    v_pk_fma_f32 v[148:149], v[152:153], v[12:13], v[148:149] neg_lo:[1,0,0] neg_hi:[1,0,0]
    v_pk_add_f32 v[208:209], v[138:139], v[162:163]
    v_pk_add_f32 v[210:211], v[146:147], v[154:155]
    v_pk_add_f32 v[212:213], v[138:139], v[162:163] neg_lo:[0,1] neg_hi:[0,1]
    v_pk_add_f32 v[214:215], v[146:147], v[154:155] neg_lo:[0,1] neg_hi:[0,1]
    v_pk_mul_f32 v[216:217], v[130:131], s[84:85] op_sel_hi:[1,0]
    v_pk_add_f32 v[130:131], v[130:131], v[208:209]
    v_pk_fma_f32 v[138:139], v[208:209], s[84:85], v[216:217] op_sel:[0,1,0]
    v_pk_fma_f32 v[146:147], v[208:209], s[86:87], v[216:217] op_sel_hi:[1,0,1]
    v_pk_mul_f32 v[162:163], v[212:213], s[86:87] op_sel:[0,1]
    v_pk_mul_f32 v[154:155], v[212:213], s[88:89] op_sel_hi:[1,0]
    v_pk_add_f32 v[130:131], v[130:131], v[210:211]
    v_pk_fma_f32 v[138:139], v[210:211], s[86:87], v[138:139] op_sel_hi:[1,0,1]
    v_pk_fma_f32 v[146:147], v[210:211], s[84:85], v[146:147] op_sel:[0,1,0]
    v_pk_fma_f32 v[162:163], v[214:215], s[88:89], v[162:163] op_sel_hi:[1,0,1]
    v_pk_fma_f32 v[154:155], v[214:215], s[88:89], v[154:155] op_sel:[0,1,0]
    v_pk_mul_f32 v[130:131], v[130:131], s[84:85] op_sel_hi:[1,0]
    v_pk_add_f32 v[208:209], v[142:143], v[166:167]
    v_pk_add_f32 v[210:211], v[150:151], v[158:159]
    v_pk_add_f32 v[212:213], v[142:143], v[166:167] neg_lo:[0,1] neg_hi:[0,1]
    v_pk_add_f32 v[214:215], v[150:151], v[158:159] neg_lo:[0,1] neg_hi:[0,1]
    v_pk_mul_f32 v[216:217], v[134:135], s[84:85] op_sel_hi:[1,0]
    v_pk_add_f32 v[134:135], v[134:135], v[208:209]
    v_pk_fma_f32 v[142:143], v[208:209], s[84:85], v[216:217] op_sel:[0,1,0]
    v_pk_fma_f32 v[150:151], v[208:209], s[86:87], v[216:217] op_sel_hi:[1,0,1]
    v_pk_mul_f32 v[166:167], v[212:213], s[86:87] op_sel:[0,1]
    v_pk_mul_f32 v[158:159], v[212:213], s[88:89] op_sel_hi:[1,0]
    v_pk_add_f32 v[134:135], v[134:135], v[210:211]
    v_pk_fma_f32 v[142:143], v[210:211], s[86:87], v[142:143] op_sel_hi:[1,0,1]
    v_pk_fma_f32 v[150:151], v[210:211], s[84:85], v[150:151] op_sel:[0,1,0]
    v_pk_fma_f32 v[166:167], v[214:215], s[88:89], v[166:167] op_sel_hi:[1,0,1]
    v_pk_fma_f32 v[158:159], v[214:215], s[88:89], v[158:159] op_sel:[0,1,0]
    v_pk_mul_f32 v[134:135], v[134:135], s[84:85] op_sel_hi:[1,0]
    v_pk_add_f32 v[152:153], v[138:139], v[166:167] neg_lo:[0,1] neg_hi:[0,1]
    v_pk_add_f32 v[166:167], v[166:167], v[138:139]
    v_pk_add_f32 v[138:139], v[162:163], v[142:143]
    v_pk_add_f32 v[142:143], v[142:143], v[162:163] neg_lo:[0,1] neg_hi:[0,1]
    v_pk_add_f32 v[162:163], v[146:147], v[158:159] neg_lo:[0,1] neg_hi:[0,1]
    v_pk_add_f32 v[158:159], v[158:159], v[146:147]
    v_pk_add_f32 v[146:147], v[154:155], v[150:151]
    v_pk_add_f32 v[150:151], v[150:151], v[154:155] neg_lo:[0,1] neg_hi:[0,1]
    v_cvt_pk_bf16_f32 v244, v128, v132
    v_cvt_pk_bf16_f32 v245, v129, v133
    v_cvt_pk_bf16_f32 v246, v130, v134
    v_cvt_pk_bf16_f32 v247, v131, v135
    buffer_store_dwordx4 v[244:247], v15, s[8:11], s52 offen offset:0 sc1
    v_cvt_pk_bf16_f32 v248, v114, v136
    v_cvt_pk_bf16_f32 v249, v115, v137
    v_cvt_pk_bf16_f32 v250, v152, v138
    v_cvt_pk_bf16_f32 v251, v153, v139
    buffer_store_dwordx4 v[248:251], v15, s[8:11], s52 offen offset:3072 sc1
    v_cvt_pk_bf16_f32 v252, v160, v144
    v_cvt_pk_bf16_f32 v253, v161, v145
    v_cvt_pk_bf16_f32 v254, v162, v146
    v_cvt_pk_bf16_f32 v255, v163, v147
    buffer_store_dwordx4 v[252:255], v15, s[8:11], s53 offen offset:0 sc1
    v_cvt_pk_bf16_f32 v224, v156, v148
    v_cvt_pk_bf16_f32 v225, v157, v149
    v_cvt_pk_bf16_f32 v226, v158, v150
    v_cvt_pk_bf16_f32 v227, v159, v151
    buffer_store_dwordx4 v[224:227], v15, s[8:11], s53 offen offset:3072 sc1
    v_cvt_pk_bf16_f32 v228, v164, v140
    v_cvt_pk_bf16_f32 v229, v165, v141
    v_cvt_pk_bf16_f32 v230, v166, v142
    v_cvt_pk_bf16_f32 v231, v167, v143
    buffer_store_dwordx4 v[228:231], v15, s[8:11], s54 offen offset:0 sc1
    s_waitcnt vmcnt(10)
    buffer_load_dword v76, v77, s[36:39], 0 offen offset:0 sc1
    v_and_b32 v15, 0x39, v0
    v_bfe_u32 v14, v0, 1, 1
    v_lshl_add_u32 v15, v14, 2, v15
    v_bfe_u32 v14, v0, 2, 1
    v_lshl_add_u32 v15, v14, 1, v15
    v_lshlrev_b32_e64 v15, 4, v15
    s_lshl_b32 s83, s65, 2
    s_add_u32 s83, s83, s3
    s_mul_i32 s83, s83, 61440
    s_add_u32 s83, s83, 23068672
    s_add_u32 s48, s92, 32
    v_mov_b32 v10, 1
    v_mul_u32_u24 v11, 4096, v0
    s_and_b32 s5, s2, 7
    s_lshl_b32 s5, s5, 5
    s_add_u32 s5, s5, s3
    s_lshl_b32 s5, s5, 7
    s_add_u32 s5, s5, 2160
    v_and_b32_e64 v79, 4, v0
    v_lshl_add_u32 v11, s3, 28, v11
    s_waitcnt vmcnt(0) lgkmcnt(0)
    v_cmp_gt_u32_e64 vcc, s4, v76
    s_nop 0
    s_cbranch_vccnz L_slow0
L_back0:
    s_barrier
    buffer_load_dword v76, v79, s[8:11], s5 offen sc1
    s_mov_b64 exec, 0xff
    buffer_atomic_add v10, v11, s[8:11], s48 offen sc1
    s_mov_b64 exec, -1
    s_mov_b32 s44, s28
    s_mov_b32 s45, s29
    s_mov_b32 s46, 1966080
    s_mov_b32 s47, 0x00020000
    s_lshl_b32 s48, s56, 1
    s_and_b32 s49, s3, 1
    s_add_u32 s48, s48, s49
    s_mul_i32 s48, s48, 10240
    s_lshr_b32 s49, s3, 1
    s_lshl_b32 s49, s49, 7
    s_add_u32 s48, s48, s49
    v_lshrrev_b32 v6, 3, v0
    v_and_b32_e64 v7, 7, v0
    v_mul_u32_u24 v6, 1280, v6
    v_lshl_add_u32 v6, v7, 4, v6
    buffer_load_dwordx4 v[48:51], v6, s[44:47], s48 offen offset:0 nt
    buffer_load_dwordx4 v[52:55], v6, s[44:47], s48 offen offset:256 nt
    buffer_load_dwordx4 v[56:59], v6, s[44:47], s48 offen offset:512 nt
    buffer_load_dwordx4 v[60:63], v6, s[44:47], s48 offen offset:768 nt
    buffer_load_dwordx4 v[64:67], v6, s[44:47], s48 offen offset:1024 nt
    s_waitcnt vmcnt(6)
    v_and_b32 v78, 0x80008, v76
    v_cmp_eq_u32 vcc, 0, v78
    s_nop 0
    s_cbranch_vccnz L_slow1
L_back1:
    v_readlane_b32 s48, v78, 0
    v_readlane_b32 s49, v76, 4
    s_lshr_b32 s48, s48, 1
    s_add_u32 s48, s48, s49
    s_add_u32 s48, s48, s2
    s_and_b32 s48, s48, 4
    s_andn2_b32 s6, s2, 4
    s_or_b32 s6, s6, s48
    s_lshr_b32 s49, s6, 5
    s_lshl_b32 s64, s48, 1
    s_add_u32 s64, s64, s49
    s_lshl_b32 s48, s48, 11
    s_lshl_b32 s49, s49, 15
    s_add_u32 s49, s49, s48
    s_add_u32 s97, s49, 20971520
    s_and_b32 s49, s6, 2
    s_lshl_b32 s49, s49, 13
    s_add_u32 s48, s48, s49
    s_lshl_b32 s49, s66, 12
    s_add_u32 s93, s48, s49
    v_mov_b32 v12, 1.0
    v_mov_b32_e64 v4, 0
    v_cndmask_b32 v12, v12, v4, s[62:63]
    v_mov_b32 v13, 0x3d64f92e
    v_mov_b32 v4, 0x3d21e89b
    v_cndmask_b32 v13, v13, v4, s[62:63]
    s_mov_b32 s54, 0xffff
    s_waitcnt vmcnt(1)
    v_bfi_b32 v176, s54, v48, v60
    s_waitcnt vmcnt(0)
    v_bfi_b32 v177, s54, v53, v65
    v_bfi_b32 v178, s54, v58, v50
    v_bfi_b32 v179, s54, v63, v55
    ds_write_b128 v68, v[176:179] offset:40960
    v_bfi_b32 v180, s54, v52, v64
    v_bfi_b32 v181, s54, v57, v49
    v_bfi_b32 v182, s54, v62, v54
    v_bfi_b32 v183, s54, v67, v59
    ds_write_b128 v69, v[180:183] offset:40960
    v_bfi_b32 v184, s54, v56, v48
    v_bfi_b32 v185, s54, v61, v53
    v_bfi_b32 v186, s54, v66, v58
    v_bfi_b32 v187, s54, v51, v63
    ds_write_b128 v70, v[184:187] offset:40960
    v_bfi_b32 v188, s54, v60, v52
    v_bfi_b32 v189, s54, v65, v57
    v_bfi_b32 v190, s54, v50, v62
    v_bfi_b32 v191, s54, v55, v67
    ds_write_b128 v71, v[188:191] offset:40960
    v_bfi_b32 v176, s54, v64, v56
    v_bfi_b32 v177, s54, v49, v61
    v_bfi_b32 v178, s54, v54, v66
    v_bfi_b32 v179, s54, v59, v51
    ds_write_b128 v72, v[176:179] offset:40960
    v_xor_b32 v4, v1, v2
    v_lshlrev_b32 v4, 4, v4
    v_lshl_add_u32 v4, v2, 8, v4
    v_xor_b32 v5, 64, v4
    s_waitcnt lgkmcnt(0)
    s_cmp_eq_u32 s3, 1
    s_cbranch_scc1 L_wait_1p
    s_mov_b64 exec, 0
    s_cmp_eq_u32 s3, 0
    s_cbranch_scc1 L_pg1913
    s_cmp_eq_u32 s3, 2
    s_cbranch_scc1 L_pg5202
    s_branch L_pg8530
L_wait_1p:
    s_add_u32 s48, s93, 2592
    v_mul_u32_u24 v11, 128, v0
    s_mov_b32 s7, 0x20000
    s_mov_b32 exec_lo, 0xfff
    s_mov_b32 exec_hi, 0
L_poll_2:
    buffer_load_dword v10, v11, s[8:11], s48 offen sc1
    s_sub_u32 s7, s7, 1
    s_cbranch_scc1 L_polld_3
    s_waitcnt vmcnt(0)
    v_cmp_gt_u32_e64 vcc, 8, v10
    s_nop 0
    s_cbranch_vccnz L_poll_2
L_polld_3:
L_hopr2:
    s_mov_b64 exec, -1
L_wait_1:
    s_barrier
    ds_read_b128 v[176:179], v4 offset:40960
    ds_read_b128 v[180:183], v4 offset:41984
    ds_read_b128 v[184:187], v4 offset:43008
    ds_read_b128 v[188:191], v4 offset:44032
    ds_read_b128 v[192:195], v4 offset:45056
    ds_read_b128 v[196:199], v5 offset:46080
    ds_read_b128 v[200:203], v5 offset:47104
L_pg8530:
    s_cbranch_execz L_hopr2
    ds_read_b128 v[204:207], v5 offset:48128
    buffer_load_dwordx4 a[0:3], v15, s[8:11], s83 offen offset:0 sc1
    s_waitcnt lgkmcnt(7)
    v_mfma_f32_16x16x32_bf16 v[88:91], v[176:179], v[16:19], 0
    v_mfma_f32_16x16x32_bf16 v[92:95], v[176:179], v[20:23], 0
    ds_read_b128 v[176:179], v5 offset:49152
    s_waitcnt lgkmcnt(7)
    v_mfma_f32_16x16x32_bf16 v[96:99], v[180:183], v[16:19], 0
    buffer_load_dwordx4 a[4:7], v15, s[8:11], s83 offen offset:1024 sc1
    v_mfma_f32_16x16x32_bf16 v[100:103], v[180:183], v[20:23], 0
    ds_read_b128 v[180:183], v5 offset:50176
    s_waitcnt lgkmcnt(7)
    v_mfma_f32_16x16x32_bf16 v[104:107], v[184:187], v[16:19], 0
    v_mfma_f32_16x16x32_bf16 v[108:111], v[184:187], v[20:23], 0
    buffer_load_dwordx4 a[8:11], v15, s[8:11], s83 offen offset:2048 sc1
    ds_read_b128 v[184:187], v4 offset:51200
    s_waitcnt lgkmcnt(7)
    v_mfma_f32_16x16x32_bf16 v[112:115], v[188:191], v[16:19], 0
    v_mfma_f32_16x16x32_bf16 v[116:119], v[188:191], v[20:23], 0
    ds_read_b128 v[188:191], v4 offset:52224
    s_waitcnt lgkmcnt(7)
    v_mfma_f32_16x16x32_bf16 v[120:123], v[192:195], v[16:19], 0
    buffer_load_dwordx4 a[12:15], v15, s[8:11], s83 offen offset:3072 sc1
    s_add_u32 s83, s83, 0x1000
    v_mfma_f32_16x16x32_bf16 v[124:127], v[192:195], v[20:23], 0
    ds_read_b128 v[192:195], v4 offset:53248
    s_waitcnt lgkmcnt(7)
    v_mfma_f32_16x16x32_bf16 v[88:91], v[196:199], v[24:27], v[88:91]
    v_mfma_f32_16x16x32_bf16 v[92:95], v[196:199], v[28:31], v[92:95]
    buffer_load_dwordx4 a[16:19], v15, s[8:11], s83 offen offset:0 sc1
    ds_read_b128 v[196:199], v4 offset:54272
    s_waitcnt lgkmcnt(7)
    v_mfma_f32_16x16x32_bf16 v[96:99], v[200:203], v[24:27], v[96:99]
    v_mfma_f32_16x16x32_bf16 v[100:103], v[200:203], v[28:31], v[100:103]
    ds_read_b128 v[200:203], v4 offset:55296
    s_waitcnt lgkmcnt(7)
    v_mfma_f32_16x16x32_bf16 v[104:107], v[204:207], v[24:27], v[104:107]
    buffer_load_dwordx4 a[20:23], v15, s[8:11], s83 offen offset:1024 sc1
    v_mfma_f32_16x16x32_bf16 v[108:111], v[204:207], v[28:31], v[108:111]
    ds_read_b128 v[204:207], v5 offset:56320
    s_waitcnt lgkmcnt(7)
    v_mfma_f32_16x16x32_bf16 v[112:115], v[176:179], v[24:27], v[112:115]
    v_mfma_f32_16x16x32_bf16 v[116:119], v[176:179], v[28:31], v[116:119]
    buffer_load_dwordx4 a[24:27], v15, s[8:11], s83 offen offset:2048 sc1
    ds_read_b128 v[176:179], v5 offset:57344
    s_waitcnt lgkmcnt(7)
    v_mfma_f32_16x16x32_bf16 v[120:123], v[180:183], v[24:27], v[120:123]
    v_mfma_f32_16x16x32_bf16 v[124:127], v[180:183], v[28:31], v[124:127]
    ds_read_b128 v[180:183], v5 offset:58368
    buffer_load_dwordx4 a[28:31], v15, s[8:11], s83 offen offset:3072 sc1
    s_add_u32 s83, s83, 0x1000
    s_waitcnt lgkmcnt(7)
    v_mfma_f32_16x16x32_bf16 v[88:91], v[184:187], v[32:35], v[88:91]
    v_mfma_f32_16x16x32_bf16 v[92:95], v[184:187], v[36:39], v[92:95]
    ds_read_b128 v[184:187], v5 offset:59392
    s_waitcnt lgkmcnt(7)
    v_mfma_f32_16x16x32_bf16 v[96:99], v[188:191], v[32:35], v[96:99]
    v_mfma_f32_16x16x32_bf16 v[100:103], v[188:191], v[36:39], v[100:103]
    buffer_load_dwordx4 a[32:35], v15, s[8:11], s83 offen offset:0 sc1
    ds_read_b128 v[188:191], v5 offset:60416
    s_waitcnt lgkmcnt(7)
    v_mfma_f32_16x16x32_bf16 v[104:107], v[192:195], v[32:35], v[104:107]
    v_mfma_f32_16x16x32_bf16 v[108:111], v[192:195], v[36:39], v[108:111]
    s_waitcnt lgkmcnt(6)
    v_mfma_f32_16x16x32_bf16 v[112:115], v[196:199], v[32:35], v[112:115]
    buffer_load_dwordx4 a[36:39], v15, s[8:11], s83 offen offset:1024 sc1
    v_mfma_f32_16x16x32_bf16 v[116:119], v[196:199], v[36:39], v[116:119]
    s_waitcnt lgkmcnt(5)
    v_mfma_f32_16x16x32_bf16 v[120:123], v[200:203], v[32:35], v[120:123]
    v_mfma_f32_16x16x32_bf16 v[124:127], v[200:203], v[36:39], v[124:127]
    s_waitcnt lgkmcnt(4)
    v_mfma_f32_16x16x32_bf16 v[88:91], v[204:207], v[40:43], v[88:91]
    v_mfma_f32_16x16x32_bf16 v[92:95], v[204:207], v[44:47], v[92:95]
    buffer_load_dwordx4 a[40:43], v15, s[8:11], s83 offen offset:2048 sc1
    s_waitcnt lgkmcnt(3)
    v_mfma_f32_16x16x32_bf16 v[96:99], v[176:179], v[40:43], v[96:99]
    v_mfma_f32_16x16x32_bf16 v[100:103], v[176:179], v[44:47], v[100:103]
    s_waitcnt lgkmcnt(2)
    v_mfma_f32_16x16x32_bf16 v[104:107], v[180:183], v[40:43], v[104:107]
    v_mfma_f32_16x16x32_bf16 v[108:111], v[180:183], v[44:47], v[108:111]
    buffer_load_dwordx4 a[44:47], v15, s[8:11], s83 offen offset:3072 sc1
    s_add_u32 s83, s83, 0x1000
    s_waitcnt lgkmcnt(1)
    v_mfma_f32_16x16x32_bf16 v[112:115], v[184:187], v[40:43], v[112:115]
    v_mfma_f32_16x16x32_bf16 v[116:119], v[184:187], v[44:47], v[116:119]
    s_waitcnt lgkmcnt(0)
    v_mfma_f32_16x16x32_bf16 v[120:123], v[188:191], v[40:43], v[120:123]
    v_mfma_f32_16x16x32_bf16 v[124:127], v[188:191], v[44:47], v[124:127]
    v_and_b32 v4, 7, v0
    v_and_b32_e64 v5, 1, v2
    v_lshl_add_u32 v4, v4, 1, v5
    v_lshrrev_b32_e64 v5, 1, v2
    v_lshl_add_u32 v4, v5, 4, v4
    v_bfe_u32 v5, v0, 3, 1
    v_mul_u32_u24_e64 v5, 32, v5
    v_add_lshl_u32 v4, v4, v5, 4
    s_mul_i32 s48, s3, 5120
    v_add_u32_e64 v4, s48, v4
    v_lshl_add_u32 v5, v0, 4, s48
    v_lshrrev_b32_e64 v9, 5, v0
    v_mul_u32_u24 v9, 97792, v9
    v_lshl_add_u32 v9, v0, 4, v9
    s_and_b32 s52, s3, 1
    s_mul_i32 s52, s52, 1920
    s_add_u32 s52, s52, s56
    s_and_b32 s53, s56, 0x70
    s_add_u32 s52, s52, s53
    s_lshl_b32 s52, s52, 9
    s_lshr_b32 s54, s3, 1
    s_lshl_b32 s54, s54, 21
    s_add_u32 s52, s52, s54
    s_nop 0
    s_add_u32 s52, s52, 33554432
    s_add_u32 s54, s52, 8192
    v_pk_add_f32 v[208:209], v[96:97], v[120:121]
    buffer_load_dwordx4 a[48:51], v15, s[8:11], s83 offen offset:0 sc1
    v_pk_add_f32 v[210:211], v[104:105], v[112:113]
    v_pk_add_f32 v[212:213], v[96:97], v[120:121] neg_lo:[0,1] neg_hi:[0,1]
    v_pk_add_f32 v[214:215], v[104:105], v[112:113] neg_lo:[0,1] neg_hi:[0,1]
    v_pk_mul_f32 v[216:217], v[88:89], s[84:85] op_sel_hi:[1,0]
    v_pk_add_f32 v[88:89], v[88:89], v[208:209]
    v_pk_fma_f32 v[96:97], v[208:209], s[84:85], v[216:217] op_sel:[0,1,0]
    buffer_load_dwordx4 a[52:55], v15, s[8:11], s83 offen offset:1024 sc1
    v_pk_fma_f32 v[104:105], v[208:209], s[86:87], v[216:217] op_sel_hi:[1,0,1]
    v_pk_mul_f32 v[120:121], v[212:213], s[86:87] op_sel:[0,1]
    v_pk_mul_f32 v[112:113], v[212:213], s[88:89] op_sel_hi:[1,0]
    v_pk_add_f32 v[88:89], v[88:89], v[210:211]
    v_pk_fma_f32 v[96:97], v[210:211], s[86:87], v[96:97] op_sel_hi:[1,0,1]
    v_pk_fma_f32 v[104:105], v[210:211], s[84:85], v[104:105] op_sel:[0,1,0]
    v_pk_fma_f32 v[120:121], v[214:215], s[88:89], v[120:121] op_sel_hi:[1,0,1]
    buffer_load_dwordx4 a[56:59], v15, s[8:11], s83 offen offset:2048 sc1
    v_pk_fma_f32 v[112:113], v[214:215], s[88:89], v[112:113] op_sel:[0,1,0]
    v_pk_mul_f32 v[88:89], v[88:89], v[12:13] op_sel:[0,1]
    v_pk_add_f32 v[208:209], v[100:101], v[124:125]
    v_pk_add_f32 v[210:211], v[108:109], v[116:117]
    v_pk_add_f32 v[212:213], v[100:101], v[124:125] neg_lo:[0,1] neg_hi:[0,1]
    v_pk_add_f32 v[214:215], v[108:109], v[116:117] neg_lo:[0,1] neg_hi:[0,1]
    v_pk_mul_f32 v[216:217], v[92:93], s[84:85] op_sel_hi:[1,0]
    buffer_load_dwordx4 a[60:63], v15, s[8:11], s83 offen offset:3072 sc1
    s_add_u32 s83, s83, 0x1000
    v_pk_add_f32 v[92:93], v[92:93], v[208:209]
    v_pk_fma_f32 v[100:101], v[208:209], s[84:85], v[216:217] op_sel:[0,1,0]
    v_pk_fma_f32 v[108:109], v[208:209], s[86:87], v[216:217] op_sel_hi:[1,0,1]
    v_pk_mul_f32 v[124:125], v[212:213], s[86:87] op_sel:[0,1]
    v_pk_mul_f32 v[116:117], v[212:213], s[88:89] op_sel_hi:[1,0]
    v_pk_add_f32 v[92:93], v[92:93], v[210:211]
    buffer_load_dwordx4 a[64:67], v15, s[8:11], s83 offen offset:0 sc1
    v_pk_fma_f32 v[100:101], v[210:211], s[86:87], v[100:101] op_sel_hi:[1,0,1]
    v_pk_fma_f32 v[108:109], v[210:211], s[84:85], v[108:109] op_sel:[0,1,0]
    v_pk_fma_f32 v[124:125], v[214:215], s[88:89], v[124:125] op_sel_hi:[1,0,1]
    v_pk_fma_f32 v[116:117], v[214:215], s[88:89], v[116:117] op_sel:[0,1,0]
    v_pk_mul_f32 v[92:93], v[92:93], v[12:13] op_sel:[0,1]
    v_pk_fma_f32 v[218:219], v[124:125], v[12:13], v[96:97] op_sel_hi:[1,0,1] neg_lo:[1,0,0] neg_hi:[1,0,0]
    v_pk_fma_f32 v[124:125], v[96:97], v[12:13], v[124:125] op_sel_hi:[1,0,1]
    buffer_load_dwordx4 a[68:71], v15, s[8:11], s83 offen offset:1024 sc1
    v_pk_fma_f32 v[96:97], v[100:101], v[12:13], v[120:121] op_sel_hi:[1,0,1]
    v_pk_fma_f32 v[100:101], v[120:121], v[12:13], v[100:101] op_sel_hi:[1,0,1] neg_lo:[1,0,0] neg_hi:[1,0,0]
    v_pk_fma_f32 v[120:121], v[116:117], v[12:13], v[104:105] op_sel_hi:[1,0,1] neg_lo:[1,0,0] neg_hi:[1,0,0]
    v_pk_fma_f32 v[116:117], v[104:105], v[12:13], v[116:117] op_sel_hi:[1,0,1]
    v_pk_fma_f32 v[104:105], v[108:109], v[12:13], v[112:113] op_sel_hi:[1,0,1]
    v_pk_fma_f32 v[108:109], v[112:113], v[12:13], v[108:109] op_sel_hi:[1,0,1] neg_lo:[1,0,0] neg_hi:[1,0,0]
    v_pk_add_f32 v[208:209], v[98:99], v[122:123]
    buffer_load_dwordx4 a[72:75], v15, s[8:11], s83 offen offset:2048 sc1
    v_pk_add_f32 v[210:211], v[106:107], v[114:115]
    v_pk_add_f32 v[212:213], v[98:99], v[122:123] neg_lo:[0,1] neg_hi:[0,1]
    v_pk_add_f32 v[214:215], v[106:107], v[114:115] neg_lo:[0,1] neg_hi:[0,1]
    v_pk_mul_f32 v[216:217], v[90:91], s[84:85] op_sel_hi:[1,0]
    v_pk_add_f32 v[90:91], v[90:91], v[208:209]
    v_pk_fma_f32 v[98:99], v[208:209], s[84:85], v[216:217] op_sel:[0,1,0]
    buffer_load_dwordx4 a[76:79], v15, s[8:11], s83 offen offset:3072 sc1
    s_add_u32 s83, s83, 0x1000
    v_pk_fma_f32 v[106:107], v[208:209], s[86:87], v[216:217] op_sel_hi:[1,0,1]
    v_pk_mul_f32 v[122:123], v[212:213], s[86:87] op_sel:[0,1]
    v_pk_mul_f32 v[114:115], v[212:213], s[88:89] op_sel_hi:[1,0]
    v_pk_add_f32 v[90:91], v[90:91], v[210:211]
    v_pk_fma_f32 v[98:99], v[210:211], s[86:87], v[98:99] op_sel_hi:[1,0,1]
    v_pk_fma_f32 v[106:107], v[210:211], s[84:85], v[106:107] op_sel:[0,1,0]
    v_pk_fma_f32 v[122:123], v[214:215], s[88:89], v[122:123] op_sel_hi:[1,0,1]
    buffer_load_dwordx4 a[80:83], v15, s[8:11], s83 offen offset:0 sc1
    v_pk_fma_f32 v[114:115], v[214:215], s[88:89], v[114:115] op_sel:[0,1,0]
    v_pk_mul_f32 v[90:91], v[90:91], v[12:13] op_sel:[0,1]
    v_pk_add_f32 v[208:209], v[102:103], v[126:127]
    v_pk_add_f32 v[210:211], v[110:111], v[118:119]
    v_pk_add_f32 v[212:213], v[102:103], v[126:127] neg_lo:[0,1] neg_hi:[0,1]
    v_pk_add_f32 v[214:215], v[110:111], v[118:119] neg_lo:[0,1] neg_hi:[0,1]
    v_pk_mul_f32 v[216:217], v[94:95], s[84:85] op_sel_hi:[1,0]
    buffer_load_dwordx4 a[84:87], v15, s[8:11], s83 offen offset:1024 sc1
    v_pk_add_f32 v[94:95], v[94:95], v[208:209]
    v_pk_fma_f32 v[102:103], v[208:209], s[84:85], v[216:217] op_sel:[0,1,0]
    v_pk_fma_f32 v[110:111], v[208:209], s[86:87], v[216:217] op_sel_hi:[1,0,1]
    v_pk_mul_f32 v[126:127], v[212:213], s[86:87] op_sel:[0,1]
    v_pk_mul_f32 v[118:119], v[212:213], s[88:89] op_sel_hi:[1,0]
    v_pk_add_f32 v[94:95], v[94:95], v[210:211]
    buffer_load_dwordx4 a[88:91], v15, s[8:11], s83 offen offset:2048 sc1
    v_pk_fma_f32 v[102:103], v[210:211], s[86:87], v[102:103] op_sel_hi:[1,0,1]
    v_pk_fma_f32 v[110:111], v[210:211], s[84:85], v[110:111] op_sel:[0,1,0]
    v_pk_fma_f32 v[126:127], v[214:215], s[88:89], v[126:127] op_sel_hi:[1,0,1]
    v_pk_fma_f32 v[118:119], v[214:215], s[88:89], v[118:119] op_sel:[0,1,0]
    v_pk_mul_f32 v[94:95], v[94:95], v[12:13] op_sel:[0,1]
    v_pk_fma_f32 v[112:113], v[126:127], v[12:13], v[98:99] op_sel_hi:[1,0,1] neg_lo:[1,0,0] neg_hi:[1,0,0]
    v_pk_fma_f32 v[126:127], v[98:99], v[12:13], v[126:127] op_sel_hi:[1,0,1]
    buffer_load_dwordx4 a[92:95], v15, s[8:11], s83 offen offset:3072 sc1
    s_add_u32 s83, s83, 0x1000
    v_pk_fma_f32 v[98:99], v[102:103], v[12:13], v[122:123] op_sel_hi:[1,0,1]
    v_pk_fma_f32 v[102:103], v[122:123], v[12:13], v[102:103] op_sel_hi:[1,0,1] neg_lo:[1,0,0] neg_hi:[1,0,0]
    v_pk_fma_f32 v[122:123], v[118:119], v[12:13], v[106:107] op_sel_hi:[1,0,1] neg_lo:[1,0,0] neg_hi:[1,0,0]
    v_pk_fma_f32 v[118:119], v[106:107], v[12:13], v[118:119] op_sel_hi:[1,0,1]
    v_pk_fma_f32 v[106:107], v[110:111], v[12:13], v[114:115] op_sel_hi:[1,0,1]
    v_pk_fma_f32 v[110:111], v[114:115], v[12:13], v[110:111] op_sel_hi:[1,0,1] neg_lo:[1,0,0] neg_hi:[1,0,0]
    v_cvt_pk_bf16_f32 v176, v88, v89
    v_cvt_pk_bf16_f32 v177, v90, v91
    v_cvt_pk_bf16_f32 v178, v92, v93
    v_cvt_pk_bf16_f32 v179, v94, v95
    v_cvt_pk_bf16_f32 v180, v218, v219
    v_cvt_pk_bf16_f32 v181, v112, v113
    v_cvt_pk_bf16_f32 v182, v96, v97
    v_cvt_pk_bf16_f32 v183, v98, v99
    v_cvt_pk_bf16_f32 v184, v120, v121
    v_cvt_pk_bf16_f32 v185, v122, v123
    v_cvt_pk_bf16_f32 v186, v104, v105
    v_cvt_pk_bf16_f32 v187, v106, v107
    v_cvt_pk_bf16_f32 v188, v116, v117
    v_cvt_pk_bf16_f32 v189, v118, v119
    v_cvt_pk_bf16_f32 v190, v108, v109
    v_cvt_pk_bf16_f32 v191, v110, v111
    v_cvt_pk_bf16_f32 v192, v124, v125
    v_cvt_pk_bf16_f32 v193, v126, v127
    v_cvt_pk_bf16_f32 v194, v100, v101
    v_cvt_pk_bf16_f32 v195, v102, v103
    v_permlane16_swap_b32 v176, v178
    v_permlane16_swap_b32 v177, v179
    ds_write_b128 v4, v[176:179] offset:0
    ds_read_b128 v[224:227], v5 offset:0
    v_permlane16_swap_b32 v180, v182
    v_permlane16_swap_b32 v181, v183
    ds_write_b128 v4, v[180:183] offset:1024
    ds_read_b128 v[228:231], v5 offset:1024
    v_permlane16_swap_b32 v184, v186
    v_permlane16_swap_b32 v185, v187
    ds_write_b128 v4, v[184:187] offset:2048
    ds_read_b128 v[232:235], v5 offset:2048
    v_permlane16_swap_b32 v188, v190
    v_permlane16_swap_b32 v189, v191
    ds_write_b128 v4, v[188:191] offset:3072
    ds_read_b128 v[236:239], v5 offset:3072
    v_permlane16_swap_b32 v192, v194
    v_permlane16_swap_b32 v193, v195
    ds_write_b128 v4, v[192:195] offset:4096
    ds_read_b128 v[240:243], v5 offset:4096
    s_waitcnt lgkmcnt(8)
    buffer_store_dwordx4 v[224:227], v9, s[8:11], s52 offen sc1
    s_add_u32 s52, s52, 196608
    buffer_store_dwordx4 v[224:227], v9, s[8:11], s54 offen sc1
    s_add_u32 s54, s54, 196608
    s_waitcnt lgkmcnt(6)
    buffer_store_dwordx4 v[228:231], v9, s[8:11], s52 offen sc1
    s_add_u32 s52, s52, 196608
    buffer_store_dwordx4 v[228:231], v9, s[8:11], s54 offen sc1
    s_add_u32 s54, s54, 196608
    s_waitcnt lgkmcnt(4)
    buffer_store_dwordx4 v[232:235], v9, s[8:11], s52 offen sc1
    s_add_u32 s52, s52, 196608
    buffer_store_dwordx4 v[232:235], v9, s[8:11], s54 offen sc1
    s_add_u32 s54, s54, 196608
    s_waitcnt lgkmcnt(2)
    buffer_store_dwordx4 v[236:239], v9, s[8:11], s52 offen sc1
    s_add_u32 s52, s52, 196608
    buffer_store_dwordx4 v[236:239], v9, s[8:11], s54 offen sc1
    s_add_u32 s54, s54, 196608
    s_waitcnt lgkmcnt(0)
    buffer_store_dwordx4 v[240:243], v9, s[8:11], s52 offen sc1
    buffer_store_dwordx4 v[240:243], v9, s[8:11], s54 offen sc1
    s_lshl_b32 s48, s56, 2
    s_add_u32 s48, s48, s3
    s_movk_i32 s49, 5120
    s_cmp_lt_u32 s48, 256
    s_cselect_b32 s49, s49, -220
    s_add_u32 s49, s49, s48
    s_cmp_lt_u32 s48, 260
    s_cselect_b32 s49, s49, 0x10000
    s_lshl_b32 s49, s49, 12
    v_lshl_add_u32 v6, v0, 4, s49
    v_mov_b32 v16, 0
    v_mov_b32 v17, 0
    v_mov_b32 v18, 0
    v_mov_b32 v19, 0
    buffer_store_dwordx4 v[16:19], v6, s[8:11], 0 offen offset:0 sc1
    buffer_store_dwordx4 v[16:19], v6, s[8:11], 0 offen offset:1024 sc1
    buffer_store_dwordx4 v[16:19], v6, s[8:11], 0 offen offset:2048 sc1
    buffer_store_dwordx4 v[16:19], v6, s[8:11], 0 offen offset:3072 sc1
    buffer_load_dwordx4 a[96:99], v15, s[8:11], s83 offen offset:0 sc1
    buffer_load_dwordx4 a[100:103], v15, s[8:11], s83 offen offset:1024 sc1
    buffer_load_dwordx4 a[104:107], v15, s[8:11], s83 offen offset:2048 sc1
    buffer_load_dwordx4 a[108:111], v15, s[8:11], s83 offen offset:3072 sc1
    s_add_u32 s83, s83, 0x1000
    buffer_load_dwordx4 a[112:115], v15, s[8:11], s83 offen offset:0 sc1
    buffer_load_dwordx4 a[116:119], v15, s[8:11], s83 offen offset:1024 sc1
    buffer_load_dwordx4 a[120:123], v15, s[8:11], s83 offen offset:2048 sc1
    buffer_load_dwordx4 a[124:127], v15, s[8:11], s83 offen offset:3072 sc1
    s_add_u32 s83, s83, 0x1000
    buffer_load_dwordx4 a[128:131], v15, s[8:11], s83 offen offset:0 sc1
    buffer_load_dwordx4 a[132:135], v15, s[8:11], s83 offen offset:1024 sc1
    buffer_load_dwordx4 a[136:139], v15, s[8:11], s83 offen offset:2048 sc1
    buffer_load_dwordx4 a[140:143], v15, s[8:11], s83 offen offset:3072 sc1
    s_add_u32 s83, s83, 0x1000
    buffer_load_dwordx4 a[144:147], v15, s[8:11], s83 offen offset:0 sc1
    buffer_load_dwordx4 a[148:151], v15, s[8:11], s83 offen offset:1024 sc1
    buffer_load_dwordx4 a[152:155], v15, s[8:11], s83 offen offset:2048 sc1
    buffer_load_dwordx4 a[156:159], v15, s[8:11], s83 offen offset:3072 sc1
    s_add_u32 s83, s83, 0x1000
    buffer_load_dwordx4 a[160:163], v15, s[8:11], s83 offen offset:0 sc1
    buffer_load_dwordx4 a[164:167], v15, s[8:11], s83 offen offset:1024 sc1
    buffer_load_dwordx4 a[168:171], v15, s[8:11], s83 offen offset:2048 sc1
    buffer_load_dwordx4 a[172:175], v15, s[8:11], s83 offen offset:3072 sc1
    s_add_u32 s83, s83, 0x1000
    buffer_load_dwordx4 a[176:179], v15, s[8:11], s83 offen offset:0 sc1
    buffer_load_dwordx4 a[180:183], v15, s[8:11], s83 offen offset:1024 sc1
    buffer_load_dwordx4 a[184:187], v15, s[8:11], s83 offen offset:2048 sc1
    buffer_load_dwordx4 a[188:191], v15, s[8:11], s83 offen offset:3072 sc1
    s_add_u32 s83, s83, 0x1000
    buffer_load_dwordx4 a[192:195], v15, s[8:11], s83 offen offset:0 sc1
    buffer_load_dwordx4 a[196:199], v15, s[8:11], s83 offen offset:1024 sc1
    buffer_load_dwordx4 a[200:203], v15, s[8:11], s83 offen offset:2048 sc1
    buffer_load_dwordx4 a[204:207], v15, s[8:11], s83 offen offset:3072 sc1
    s_add_u32 s83, s83, 0x1000
    s_add_u32 s48, s92, 48
    v_mov_b32 v10, 1
    v_mul_u32_u24 v11, 4096, v0
    v_lshl_add_u32 v11, s3, 28, v11
    s_mov_b64 exec, 0xff
    s_waitcnt vmcnt(28) lgkmcnt(0)
    s_barrier
    buffer_atomic_add v10, v11, s[8:11], s48 offen sc1
    s_mov_b64 exec, -1
    s_cmp_ge_u32 s2, 176
    s_cbranch_scc0 L_of_4
    s_mov_b32 s12, s30
    s_mov_b32 s13, s31
    s_mov_b32 s14, 2621440
    s_mov_b32 s15, 0x00020000
    s_sub_u32 s48, s2, 176
    s_lshl_b32 s48, s48, 2
    s_add_u32 s48, s48, s3
    s_mul_i32 s48, s48, 1024
    v_lshlrev_b32 v6, 4, v0
    v_mov_b32 v16, 0
    v_mov_b32 v17, 0
    v_mov_b32 v18, 0
    v_mov_b32_e64 v19, 0
    buffer_store_dwordx4 v[16:19], v6, s[12:15], s48 offen offset:0 sc1
    s_add_u32 s48, s48, 327680
    buffer_store_dwordx4 v[16:19], v6, s[12:15], s48 offen offset:0 sc1
    s_add_u32 s48, s48, 327680
    buffer_store_dwordx4 v[16:19], v6, s[12:15], s48 offen offset:0 sc1
    s_add_u32 s48, s48, 327680
    buffer_store_dwordx4 v[16:19], v6, s[12:15], s48 offen offset:0 sc1
    s_add_u32 s48, s48, 327680
    buffer_store_dwordx4 v[16:19], v6, s[12:15], s48 offen offset:0 sc1
    s_add_u32 s48, s48, 327680
    buffer_store_dwordx4 v[16:19], v6, s[12:15], s48 offen offset:0 sc1
    s_add_u32 s48, s48, 327680
    buffer_store_dwordx4 v[16:19], v6, s[12:15], s48 offen offset:0 sc1
    s_add_u32 s48, s48, 327680
    buffer_store_dwordx4 v[16:19], v6, s[12:15], s48 offen offset:0 sc1
L_of_4:
    s_nop 1
    s_branch L_g1
L_ptr:
    v_lshrrev_b32 v1, 6, v0
    v_and_b32 v0, 63, v0
    v_readfirstlane_b32 s3, v1
    v_and_b32 v1, 15, v0
    v_lshrrev_b32_e64 v2, 4, v0
    s_mul_i32 s92, s49, 128
    s_and_b32 s66, s2, 1
    s_and_b32 s67, s49, 3
    s_and_b32 s50, s2, 2
    s_lshl_b32 s50, s50, 1
    s_add_u32 s67, s67, s50
    s_lshl_b32 s65, s66, 3
    s_add_u32 s65, s65, s67
    s_mov_b32 s68, 0
    s_mul_i32 s48, s3, 3
    s_and_b32 s71, s48, 14
    s_add_u32 s71, s71, s48
    s_lshl_b32 s71, s71, 12
    s_mov_b32 s10, 268435456
    s_mov_b32 s11, 0x00020000
    s_movk_i32 s38, 256
    s_mov_b32 s39, 0x00020000
    s_waitcnt lgkmcnt(0)
    s_mov_b64 s[8:9], s[34:35]
    s_mov_b64 s[36:37], s[32:33]
    s_cmp_eq_u32 s2, 128
    s_cbranch_scc0 L_noinit_5
    s_getreg_b32 s49, hwreg(HW_REG_XCC_ID, 0, 3)
    v_or_b32_e64 v9, s49, 8
    v_mov_b32 v8, 0
    v_mov_b32 v10, 0
    v_mov_b32 v11, 0
    v_lshlrev_b32_e64 v5, 4, v0
    s_lshl_b32 s49, s3, 13
    s_add_u32 s50, s49, 4096
    buffer_store_dwordx4 v[8:11], v5, s[8:11], s49 offen offset:0 sc1
    buffer_store_dwordx4 v[8:11], v5, s[8:11], s49 offen offset:1024 sc1
    buffer_store_dwordx4 v[8:11], v5, s[8:11], s49 offen offset:2048 sc1
    buffer_store_dwordx4 v[8:11], v5, s[8:11], s49 offen offset:3072 sc1
    buffer_store_dwordx4 v[8:11], v5, s[8:11], s50 offen offset:0 sc1
    buffer_store_dwordx4 v[8:11], v5, s[8:11], s50 offen offset:1024 sc1
    buffer_store_dwordx4 v[8:11], v5, s[8:11], s50 offen offset:2048 sc1
    buffer_store_dwordx4 v[8:11], v5, s[8:11], s50 offen offset:3072 sc1
    buffer_load_dword v7, off, s[36:39], 0 offset:128 sc1
    s_lshl_b32 s49, s3, 2
    s_waitcnt vmcnt(0)
    s_mov_b64 exec, 1
    buffer_store_dword v9, off, s[36:39], s49 sc1
    s_mov_b64 exec, -1
L_noinit_5:
    v_mov_b32_e64 v7, 1
    s_xor_b32 s4, s3, 2
    s_lshl_b32 s4, s4, 8
    v_and_or_b32 v77, v0, 12, s4
    s_cselect_b32 s4, 0, 1
    v_and_b32 v13, 3, v0
    v_and_b32_e64 v6, 28, v0
    v_lshl_add_u32 v13, v6, 3, v13
    v_lshlrev_b32_e64 v13, 7, v13
    s_sub_u32 s48, s2, 129
    s_cmp_lt_u32 s48, 15
    s_cbranch_scc0 L_noprobe
    s_and_b32 s48, s2, 12
    s_and_b32 s50, s3, 2
    s_add_u32 s49, s48, s50
    s_lshl_b32 s49, s49, 1
    s_and_b32 s51, s2, 3
    s_add_u32 s49, s49, s51
    s_lshl_b32 s49, s49, 1
    s_and_b32 s51, s3, 1
    s_add_u32 s49, s49, s51
    s_lshl_b32 s49, s49, 10
    s_add_u32 s49, s49, 32768
    v_mov_b32 v8, 0
    v_mov_b32 v9, 0
    v_mov_b32 v10, 0
    v_mov_b32 v11, 0
    v_lshlrev_b32_e64 v5, 4, v0
    buffer_store_dwordx4 v[8:11], v5, s[8:11], s49 offen sc1
    buffer_load_dword v76, v77, s[36:39], 0 offen offset:128 sc1
    ds_write_b32 v8, v8
    s_getreg_b32 s48, hwreg(HW_REG_XCC_ID, 0, 3)
    s_lshl_b32 s50, s50, 1
    s_xor_b32 s48, s48, s50
    s_and_b32 s48, s48, 4
    s_cselect_b32 s48, 1, 0x10000
    v_mov_b32_e64 v12, s48
    s_load_dword s52, s[34:35], 98304 glc
    s_add_u32 s50, s34, s49
    s_addc_u32 s51, s35, 0
    s_waitcnt vmcnt(0) lgkmcnt(0)
    s_barrier
    s_bitcmp1_b32 s3, 0
    s_cbranch_scc1 L_raced
    s_cmp_eq_u32 s3, 0
    s_cbranch_scc1 L_prs
    buffer_load_dword v6, off, s[8:11], s49 offset:128 sc1
    s_waitcnt vmcnt(0)
    buffer_load_dword v6, off, s[8:11], s49 offset:384 sc1
    buffer_load_dword v76, v77, s[36:39], 0 offen offset:0 sc1
    s_waitcnt vmcnt(1)
    s_branch L_prd
L_prs:
    s_load_dword s52, s[50:51], 0 glc
    s_waitcnt lgkmcnt(0)
    s_load_dword s52, s[50:51], 256 glc
    s_waitcnt lgkmcnt(0)
L_prd:
    s_mov_b64 exec, 1
    ds_add_rtn_u32 v7, v8, v12
    s_mov_b64 exec, -1
    s_branch L_raced
L_noprobe:
    s_waitcnt vmcnt(0)
    buffer_load_dword v76, v77, s[36:39], 0 offen offset:0 sc1
L_raced:
    s_waitcnt vmcnt(0) lgkmcnt(0)
    v_cmp_gt_u32 vcc, s4, v76
    s_nop 0
    s_cbranch_vccnz L_slow2
L_back2:
    s_barrier
    v_cmp_eq_u32 vcc, 0, v7
    s_nop 0
    s_cbranch_vccz L_novote
    s_mov_b32 exec_hi, 0
    buffer_atomic_add v12, v13, s[8:11], 0 offen offset:2160 sc1
    s_mov_b32 exec_hi, -1
L_novote:
    s_mov_b32 s91, 0x80008000
    s_lshl_b32 s90, s3, 4
    v_cvt_f32_u32 v3, v2
    v_add_u32 v11, s90, v1
    v_cvt_f32_u32_e64 v11, v11
    v_mul_f32 v5, 0x3c800000, v11
    v_mul_f32 v4, 0x41000000, v3
    v_mul_f32 v4, v4, v5
    v_cos_f32 v6, v4
    v_sin_f32 v8, v4
    v_add_f32 v4, v4, v5
    v_cos_f32 v7, v4
    v_sin_f32 v9, v4
    v_add_f32_e64 v4, v4, v5
    v_cvt_pk_bf16_f32 v128, v6, v7
    v_cvt_pk_bf16_f32 v132, v8, v9
    v_xor_b32 v136, s91, v132
    v_cos_f32 v6, v4
    v_sin_f32 v8, v4
    v_add_f32 v4, v4, v5
    v_cos_f32 v7, v4
    v_sin_f32 v9, v4
    v_add_f32_e64 v4, v4, v5
    v_cvt_pk_bf16_f32 v129, v6, v7
    v_cvt_pk_bf16_f32 v133, v8, v9
    v_xor_b32 v137, s91, v133
    v_cos_f32 v6, v4
    v_sin_f32 v8, v4
    v_add_f32 v4, v4, v5
    v_cos_f32 v7, v4
    v_sin_f32 v9, v4
    v_add_f32_e64 v4, v4, v5
    v_cvt_pk_bf16_f32 v130, v6, v7
    v_cvt_pk_bf16_f32 v134, v8, v9
    v_xor_b32 v138, s91, v134
    v_cos_f32 v6, v4
    v_sin_f32 v8, v4
    v_add_f32 v4, v4, v5
    v_cos_f32 v7, v4
    v_sin_f32 v9, v4
    v_add_f32_e64 v4, v4, v5
    v_cvt_pk_bf16_f32 v131, v6, v7
    v_cvt_pk_bf16_f32 v135, v8, v9
    v_xor_b32_e64 v139, s91, v135
    v_mul_f32 v5, 0x3a000000, v11
    v_mul_f32 v10, 0x41500000, v5
    v_mul_f32 v4, 4.0, v3
    v_mul_f32 v4, v4, v5
    v_cos_f32 v224, v4
    v_sin_f32 v232, v4
    v_add_f32 v4, v4, v5
    v_cos_f32 v225, v4
    v_sin_f32 v233, v4
    v_add_f32 v4, v4, v5
    v_cos_f32 v226, v4
    v_sin_f32 v234, v4
    v_add_f32 v4, v4, v5
    v_cos_f32 v227, v4
    v_sin_f32 v235, v4
    v_add_f32 v4, v4, v10
    v_cos_f32 v228, v4
    v_sin_f32 v236, v4
    v_add_f32 v4, v4, v5
    v_cos_f32 v229, v4
    v_sin_f32 v237, v4
    v_add_f32 v4, v4, v5
    v_cos_f32 v230, v4
    v_sin_f32 v238, v4
    v_add_f32 v4, v4, v5
    v_cos_f32 v231, v4
    v_sin_f32_e64 v239, v4
    v_bfe_i32 v11, v1, 0, 1
    v_and_b32 v11, s91, v11
    v_xor_b32 v140, v11, v128
    v_xor_b32 v141, v11, v129
    v_xor_b32 v142, v11, v130
    v_xor_b32 v143, v11, v131
    v_xor_b32 v144, v11, v132
    v_xor_b32 v145, v11, v133
    v_xor_b32 v146, v11, v134
    v_xor_b32 v147, v11, v135
    v_xor_b32 v148, v11, v136
    v_xor_b32 v149, v11, v137
    v_xor_b32 v150, v11, v138
    v_xor_b32 v151, v11, v139
    v_cvt_f32_u32 v11, v1
    v_mul_f32 v5, 0x3d000000, v11
    v_mul_f32 v4, 4.0, v3
    v_mul_f32 v4, v4, v5
    v_cos_f32 v6, v4
    v_sin_f32 v8, v4
    v_add_f32 v4, v4, v5
    v_cos_f32 v7, v4
    v_sin_f32 v9, v4
    v_add_f32 v4, v4, v5
    v_cvt_pk_bf16_f32 v152, v6, v7
    v_cvt_pk_bf16_f32 v156, v8, v9
    v_xor_b32 v160, s91, v156
    v_cos_f32 v6, v4
    v_sin_f32 v8, v4
    v_add_f32 v4, v4, v5
    v_cos_f32 v7, v4
    v_sin_f32 v9, v4
    v_add_f32_e64 v4, v4, v5
    v_cvt_pk_bf16_f32 v153, v6, v7
    v_cvt_pk_bf16_f32 v157, v8, v9
    v_xor_b32_e64 v161, s91, v157
    v_bfe_i32 v11, v1, 0, 1
    v_and_b32 v11, s91, v11
    v_xor_b32 v154, v11, v152
    v_xor_b32 v155, v11, v153
    v_xor_b32 v158, v11, v156
    v_xor_b32 v159, v11, v157
    v_xor_b32 v162, v11, v160
    v_xor_b32_e64 v163, v11, v161
    v_mov_b32 v11, 0x80000000
    v_xor_b32 v164, v11, v152
    v_xor_b32 v165, v11, v153
    v_xor_b32 v166, v11, v154
    v_xor_b32 v167, v11, v155
    v_xor_b32 v168, v11, v156
    v_xor_b32 v169, v11, v157
    v_xor_b32 v170, v11, v158
    v_xor_b32 v171, v11, v159
    v_xor_b32 v172, v11, v160
    v_xor_b32 v173, v11, v161
    v_xor_b32 v174, v11, v162
    v_xor_b32 v175, v11, v163
    v_lshl_add_u32 v10, v2, 2, s90
    v_cvt_f32_u32 v10, v10
    v_add_u32 v11, 0, v1
    v_cvt_f32_u32_e64 v11, v11
    v_mul_f32 v5, 0x3a000000, v11
    v_mul_f32 v4, v10, v5
    v_cos_f32 v240, v4
    v_sin_f32 v248, v4
    v_add_f32 v4, v4, v5
    v_cos_f32 v241, v4
    v_sin_f32 v249, v4
    v_add_f32 v4, v4, v5
    v_cos_f32 v242, v4
    v_sin_f32 v250, v4
    v_add_f32 v4, v4, v5
    v_cos_f32 v243, v4
    v_sin_f32 v251, v4
    v_add_u32 v11, 16, v1
    v_cvt_f32_u32 v11, v11
    v_mul_f32 v5, 0x3a000000, v11
    v_mul_f32 v4, v10, v5
    v_cos_f32 v244, v4
    v_sin_f32 v252, v4
    v_add_f32 v4, v4, v5
    v_cos_f32 v245, v4
    v_sin_f32 v253, v4
    v_add_f32 v4, v4, v5
    v_cos_f32 v246, v4
    v_sin_f32 v254, v4
    v_add_f32 v4, v4, v5
    v_cos_f32 v247, v4
    v_sin_f32 v255, v4
    s_lshl_b32 s89, s3, 5
    s_and_b32 s89, s89, 32
    s_add_u32 s89, s89, 0
    v_and_b32 v11, 12, v1
    v_add3_u32 v11, v11, v1, s89
    v_cvt_f32_u32_e64 v11, v11
    v_mul_f32 v5, 0x3c800000, v11
    v_mul_f32 v10, 0x41500000, v5
    v_mul_f32 v4, 4.0, v3
    v_mul_f32 v4, v4, v5
    v_cos_f32 v6, v4
    v_sin_f32 v8, v4
    v_add_f32 v4, v4, v5
    v_cos_f32 v7, v4
    v_sin_f32 v9, v4
    v_add_f32 v4, v4, v5
    v_cvt_pk_bf16_f32 v178, v6, v7
    v_cvt_pk_bf16_f32 v176, v8, v9
    v_xor_b32 v180, s91, v176
    v_cos_f32 v6, v4
    v_sin_f32 v8, v4
    v_add_f32 v4, v4, v5
    v_cos_f32 v7, v4
    v_sin_f32 v9, v4
    v_add_f32_e64 v4, v4, v10
    v_cvt_pk_bf16_f32 v179, v6, v7
    v_cvt_pk_bf16_f32 v177, v8, v9
    v_xor_b32 v181, s91, v177
    v_cos_f32 v6, v4
    v_sin_f32 v8, v4
    v_add_f32 v4, v4, v5
    v_cos_f32 v7, v4
    v_sin_f32 v9, v4
    v_add_f32_e64 v4, v4, v5
    v_cvt_pk_bf16_f32 v184, v6, v7
    v_cvt_pk_bf16_f32 v182, v8, v9
    v_xor_b32 v186, s91, v182
    v_cos_f32 v6, v4
    v_sin_f32 v8, v4
    v_add_f32 v4, v4, v5
    v_cos_f32 v7, v4
    v_sin_f32 v9, v4
    v_add_f32_e64 v4, v4, v10
    v_cvt_pk_bf16_f32 v185, v6, v7
    v_cvt_pk_bf16_f32 v183, v8, v9
    v_xor_b32_e64 v187, s91, v183
    v_bfe_i32 v11, v1, 0, 1
    v_and_b32 v11, s91, v11
    v_xor_b32 v188, v11, v176
    v_xor_b32 v189, v11, v177
    v_xor_b32 v190, v11, v178
    v_xor_b32 v191, v11, v179
    v_xor_b32 v192, v11, v180
    v_xor_b32 v193, v11, v181
    v_xor_b32 v194, v11, v182
    v_xor_b32 v195, v11, v183
    v_xor_b32 v196, v11, v184
    v_xor_b32 v197, v11, v185
    v_xor_b32 v198, v11, v186
    v_xor_b32_e64 v199, v11, v187
    s_and_b32 s5, s2, 7
    s_lshl_b32 s5, s5, 5
    s_add_u32 s5, s5, s3
    s_lshl_b32 s5, s5, 7
    s_add_u32 s5, s5, 2160
    v_and_b32_e64 v79, 4, v0
    buffer_load_dword v76, v79, s[8:11], s5 offen sc1
    s_waitcnt vmcnt(0)
    s_branch L_p0done
L_r3:
L_pg9259:
    s_cbranch_execz L_hopr2
    s_load_dwordx2 s[28:29], s[0:1], 48
    s_add_u32 s48, s92, 80
    v_mov_b32 v10, 1
    v_mul_u32_u24 v11, 4096, v0
    v_lshl_add_u32 v11, s3, 28, v11
    s_mov_b64 exec, 0xff
    s_waitcnt vmcnt(0) lgkmcnt(0)
    s_barrier
    buffer_atomic_add v10, v11, s[8:11], s48 offen sc1
    s_mov_b64 exec, -1
    s_sub_u32 s56, s2, 160
    s_mov_b32 s44, s28
    s_mov_b32 s45, s29
    s_mov_b32 s46, 1966080
    s_mov_b32 s47, 0x00020000
    s_lshl_b32 s48, s56, 1
    s_and_b32 s49, s3, 1
    s_add_u32 s48, s48, s49
    s_mul_i32 s48, s48, 10240
    s_lshr_b32 s49, s3, 1
    s_lshl_b32 s49, s49, 7
    s_add_u32 s48, s48, s49
    v_lshrrev_b32 v6, 3, v0
    v_and_b32_e64 v7, 7, v0
    v_mul_u32_u24 v6, 1280, v6
    v_lshl_add_u32 v6, v7, 4, v6
    buffer_load_dwordx4 v[48:51], v6, s[44:47], s48 offen offset:0 nt
    buffer_load_dwordx4 v[52:55], v6, s[44:47], s48 offen offset:256 nt
    buffer_load_dwordx4 v[56:59], v6, s[44:47], s48 offen offset:512 nt
    buffer_load_dwordx4 v[60:63], v6, s[44:47], s48 offen offset:768 nt
    buffer_load_dwordx4 v[64:67], v6, s[44:47], s48 offen offset:1024 nt
    s_cmp_lt_u32 s2, 200
    s_cbranch_scc0 L_noft
    s_lshl_b32 s48, s56, 4
    buffer_load_dwordx4 a[0:3], v15, s[8:11], s83 offen offset:0 sc1
    v_add_u32 v4, s48, v1
    v_add_u32 v5, s3, v2
    v_cmp_eq_u32_e64 vcc, 0, v5
    v_mul_u32_u24 v5, 77, v4
    v_and_b32 v5, 127, v5
    s_lshl_b32 s48, s3, 4
    v_lshl_add_u32 v6, v2, 2, s48
    buffer_load_dwordx4 a[4:7], v15, s[8:11], s83 offen offset:1024 sc1
    v_add_u32 v7, 0, v6
    v_mul_u32_u24_e64 v7, v7, v5
    v_and_b32 v7, 127, v7
    v_cvt_f32_u32_e64 v7, v7
    v_mul_f32 v16, 0x3c000000, v7
    v_add_u32 v7, 1, v6
    v_mul_u32_u24 v7, v7, v5
    v_and_b32 v7, 127, v7
    buffer_load_dwordx4 a[8:11], v15, s[8:11], s83 offen offset:2048 sc1
    v_cvt_f32_u32_e64 v7, v7
    v_mul_f32 v17, 0x3c000000, v7
    v_add_u32 v7, 2, v6
    v_mul_u32_u24 v7, v7, v5
    v_and_b32 v7, 127, v7
    v_cvt_f32_u32_e64 v7, v7
    v_mul_f32 v18, 0x3c000000, v7
    v_add_u32_e64 v7, 3, v6
    buffer_load_dwordx4 a[12:15], v15, s[8:11], s83 offen offset:3072 sc1
    s_add_u32 s83, s83, 0x1000
    v_mul_u32_u24_e64 v7, v7, v5
    v_and_b32 v7, 127, v7
    v_cvt_f32_u32_e64 v7, v7
    v_mul_f32 v19, 0x3c000000, v7
    v_and_b32 v7, 1, v4
    v_cvt_f32_u32 v7, v7
    v_mul_f32_e64 v7, 0.5, v7
    v_add_f32 v7, 0xbe800000, v7
    buffer_load_dwordx4 a[16:19], v15, s[8:11], s83 offen offset:0 sc1
    v_cndmask_b32_e64 v20, v16, v7, vcc
    v_mov_b32 v7, 0x3d64f92e
    v_mov_b32 v8, 0x3d21e89b
    v_cndmask_b32 v21, v7, v8, vcc
    v_lshlrev_b32 v7, 1, v4
    v_mul_u32_u24 v8, 13108, v7
    v_lshrrev_b32 v8, 16, v8
    v_mul_u32_u24 v8, 5, v8
    buffer_load_dwordx4 a[20:23], v15, s[8:11], s83 offen offset:1024 sc1
    v_sub_u32 v7, v7, v8
    v_cvt_f32_u32 v7, v7
    v_mul_f32 v22, 0x3e4ccccd, v7
    s_mov_b32 s51, 0x3d64f92e
    v_mul_f32 v3, 0x00000000, v22
    v_add_f32 v7, v3, v16
    v_add_f32 v8, v3, v20
    v_cos_f32 v7, v7
    buffer_load_dwordx4 a[24:27], v15, s[8:11], s83 offen offset:2048 sc1
    v_sin_f32 v8, -v8
    v_mul_f32 v7, v21, v7
    v_mul_f32 v8, v21, v8
    v_cvt_pk_bf16_f32 v24, v7, v8
    v_add_f32 v7, v3, v17
    v_add_f32 v8, v3, v17
    v_cos_f32_e64 v7, v7
    v_sin_f32 v8, -v8
    buffer_load_dwordx4 a[28:31], v15, s[8:11], s83 offen offset:3072 sc1
    s_add_u32 s83, s83, 0x1000
    v_mul_f32 v7, s51, v7
    v_mul_f32 v8, s51, v8
    v_cvt_pk_bf16_f32 v25, v7, v8
    v_add_f32 v7, v3, v18
    v_add_f32 v8, v3, v18
    v_cos_f32_e64 v7, v7
    v_sin_f32 v8, -v8
    v_mul_f32_e64 v7, s51, v7
    buffer_load_dwordx4 a[32:35], v15, s[8:11], s83 offen offset:0 sc1
    v_mul_f32_e64 v8, s51, v8
    v_cvt_pk_bf16_f32 v26, v7, v8
    v_add_f32 v7, v3, v19
    v_add_f32 v8, v3, v19
    v_cos_f32_e64 v7, v7
    v_sin_f32 v8, -v8
    v_mul_f32_e64 v7, s51, v7
    buffer_load_dwordx4 a[36:39], v15, s[8:11], s83 offen offset:1024 sc1
    v_mul_f32_e64 v8, s51, v8
    v_cvt_pk_bf16_f32 v27, v7, v8
    v_mul_f32 v3, 0x3f800000, v22
    v_add_f32 v7, v3, v16
    v_add_f32 v8, v3, v16
    v_cos_f32 v7, v7
    v_sin_f32 v8, -v8
    v_mul_f32_e64 v7, s51, v7
    buffer_load_dwordx4 a[40:43], v15, s[8:11], s83 offen offset:2048 sc1
    v_mul_f32_e64 v8, s51, v8
    v_cvt_pk_bf16_f32 v28, v7, v8
    v_add_f32 v7, v3, v17
    v_add_f32 v8, v3, v17
    v_cos_f32_e64 v7, v7
    v_sin_f32 v8, -v8
    v_mul_f32 v7, s51, v7
    v_mul_f32 v8, s51, v8
    buffer_load_dwordx4 a[44:47], v15, s[8:11], s83 offen offset:3072 sc1
    s_add_u32 s83, s83, 0x1000
    v_cvt_pk_bf16_f32 v29, v7, v8
    v_add_f32 v7, v3, v18
    v_add_f32 v8, v3, v18
    v_cos_f32_e64 v7, v7
    v_sin_f32 v8, -v8
    v_mul_f32 v7, s51, v7
    v_mul_f32 v8, s51, v8
    v_cvt_pk_bf16_f32 v30, v7, v8
    buffer_load_dwordx4 a[48:51], v15, s[8:11], s83 offen offset:0 sc1
    v_add_f32 v7, v3, v19
    v_add_f32 v8, v3, v19
    v_cos_f32_e64 v7, v7
    v_sin_f32 v8, -v8
    v_mul_f32 v7, s51, v7
    v_mul_f32 v8, s51, v8
    v_cvt_pk_bf16_f32 v31, v7, v8
    v_mul_f32_e64 v3, 0x40000000, v22
    buffer_load_dwordx4 a[52:55], v15, s[8:11], s83 offen offset:1024 sc1
    v_add_f32 v7, v3, v16
    v_add_f32 v8, v3, v16
    v_cos_f32_e64 v7, v7
    v_sin_f32 v8, -v8
    v_mul_f32 v7, s51, v7
    v_mul_f32 v8, s51, v8
    v_cvt_pk_bf16_f32 v32, v7, v8
    v_add_f32_e64 v7, v3, v17
    buffer_load_dwordx4 a[56:59], v15, s[8:11], s83 offen offset:2048 sc1
    v_add_f32 v8, v3, v17
    v_cos_f32 v7, v7
    v_sin_f32 v8, -v8
    v_mul_f32 v7, s51, v7
    v_mul_f32 v8, s51, v8
    v_cvt_pk_bf16_f32 v33, v7, v8
    v_add_f32 v7, v3, v18
    v_add_f32 v8, v3, v18
    buffer_load_dwordx4 a[60:63], v15, s[8:11], s83 offen offset:3072 sc1
    s_add_u32 s83, s83, 0x1000
    v_cos_f32_e64 v7, v7
    v_sin_f32 v8, -v8
    v_mul_f32 v7, s51, v7
    v_mul_f32 v8, s51, v8
    v_cvt_pk_bf16_f32 v34, v7, v8
    v_add_f32 v7, v3, v19
    v_add_f32 v8, v3, v19
    v_cos_f32_e64 v7, v7
    buffer_load_dwordx4 a[64:67], v15, s[8:11], s83 offen offset:0 sc1
    v_sin_f32 v8, -v8
    v_mul_f32 v7, s51, v7
    v_mul_f32 v8, s51, v8
    v_cvt_pk_bf16_f32 v35, v7, v8
    v_mul_f32 v3, 0x40400000, v22
    v_add_f32 v7, v3, v20
    v_add_f32 v8, v3, v20
    buffer_load_dwordx4 a[68:71], v15, s[8:11], s83 offen offset:1024 sc1
    v_cos_f32_e64 v7, v7
    v_sin_f32 v8, -v8
    v_mul_f32 v7, s51, v7
    v_mul_f32 v8, s51, v8
    v_cvt_pk_bf16_f32 v36, v7, v8
    v_add_f32 v7, v3, v17
    v_add_f32 v8, v3, v17
    v_cos_f32_e64 v7, v7
    buffer_load_dwordx4 a[72:75], v15, s[8:11], s83 offen offset:2048 sc1
    v_sin_f32 v8, -v8
    v_mul_f32 v7, s51, v7
    v_mul_f32 v8, s51, v8
    v_cvt_pk_bf16_f32 v37, v7, v8
    v_add_f32 v7, v3, v18
    v_add_f32 v8, v3, v18
    v_cos_f32_e64 v7, v7
    v_sin_f32 v8, -v8
    buffer_load_dwordx4 a[76:79], v15, s[8:11], s83 offen offset:3072 sc1
    s_add_u32 s83, s83, 0x1000
    v_mul_f32 v7, s51, v7
    v_mul_f32 v8, s51, v8
    v_cvt_pk_bf16_f32 v38, v7, v8
    v_add_f32 v7, v3, v19
    v_add_f32 v8, v3, v19
    v_cos_f32_e64 v7, v7
    v_sin_f32 v8, -v8
    v_mul_f32_e64 v7, s51, v7
    buffer_load_dwordx4 a[80:83], v15, s[8:11], s83 offen offset:0 sc1
    v_mul_f32_e64 v8, s51, v8
    v_cvt_pk_bf16_f32 v39, v7, v8
    v_mul_f32 v3, 0x40800000, v22
    v_add_f32 v7, v3, v20
    v_add_f32 v8, v3, v20
    v_cos_f32 v7, v7
    v_sin_f32 v8, -v8
    v_mul_f32_e64 v7, s51, v7
    buffer_load_dwordx4 a[84:87], v15, s[8:11], s83 offen offset:1024 sc1
    v_mul_f32_e64 v8, s51, v8
    v_cvt_pk_bf16_f32 v40, v7, v8
    v_add_f32 v7, v3, v17
    v_add_f32 v8, v3, v17
    v_cos_f32_e64 v7, v7
    v_sin_f32 v8, -v8
    v_mul_f32 v7, s51, v7
    v_mul_f32 v8, s51, v8
    buffer_load_dwordx4 a[88:91], v15, s[8:11], s83 offen offset:2048 sc1
    v_cvt_pk_bf16_f32 v41, v7, v8
    v_add_f32 v7, v3, v18
    v_add_f32 v8, v3, v18
    v_cos_f32_e64 v7, v7
    v_sin_f32 v8, -v8
    v_mul_f32 v7, s51, v7
    v_mul_f32 v8, s51, v8
    v_cvt_pk_bf16_f32 v42, v7, v8
    buffer_load_dwordx4 a[92:95], v15, s[8:11], s83 offen offset:3072 sc1
    s_add_u32 s83, s83, 0x1000
    v_add_f32 v7, v3, v19
    v_add_f32 v8, v3, v19
    v_cos_f32_e64 v7, v7
    v_sin_f32 v8, -v8
    v_mul_f32 v7, s51, v7
    v_mul_f32 v8, s51, v8
    v_cvt_pk_bf16_f32 v43, v7, v8
    s_mul_i32 s48, s56, 52
    s_lshr_b32 s48, s48, 8
    s_mul_i32 s49, s48, 5
    s_sub_u32 s49, s56, s49
    s_sub_u32 s50, s49, s3
    s_add_u32 s50, s50, 3
    s_and_b32 s50, s50, 3
    s_add_u32 s50, s50, 1
    s_cmp_eq_u32 s49, 4
    s_cselect_b32 s50, 0, s50
    s_and_b32 s49, s48, 3
    s_mul_i32 s49, s49, 294912
    s_lshr_b32 s48, s48, 2
    s_lshl_b32 s48, s48, 21
    s_add_u32 s48, s48, s49
    s_add_u32 s48, s48, 58720256
    v_add_u32 v13, 8192, v12
    s_mul_i32 s52, s3, 12
    s_and_b32 s49, s50, 1
    s_lshr_b32 s51, s50, 1
    s_add_u32 s51, s51, s52
    s_mul_i32 s49, s49, 96
    s_add_u32 s49, s49, s51
    s_and_b32 s51, s51, 0x38
    s_add_u32 s49, s49, s51
    s_lshl_b32 s49, s49, 10
    s_add_u32 s49, s49, s48
    s_add_u32 s50, s50, 5
    buffer_store_dwordx4 v[24:27], v12, s[8:11], s49 offen sc1
    buffer_store_dwordx4 v[24:27], v13, s[8:11], s49 offen sc1
    s_and_b32 s49, s50, 1
    s_lshr_b32 s51, s50, 1
    s_add_u32 s51, s51, s52
    s_mul_i32 s49, s49, 96
    s_add_u32 s49, s49, s51
    s_and_b32 s51, s51, 0x38
    s_add_u32 s49, s49, s51
    s_lshl_b32 s49, s49, 10
    s_add_u32 s49, s49, s48
    s_add_u32 s50, s50, 5
    buffer_store_dwordx4 v[28:31], v12, s[8:11], s49 offen sc1
    buffer_store_dwordx4 v[28:31], v13, s[8:11], s49 offen sc1
    s_and_b32 s49, s50, 1
    s_lshr_b32 s51, s50, 1
    s_add_u32 s51, s51, s52
    s_mul_i32 s49, s49, 96
    s_add_u32 s49, s49, s51
    s_and_b32 s51, s51, 0x38
    s_add_u32 s49, s49, s51
    s_lshl_b32 s49, s49, 10
    s_add_u32 s49, s49, s48
    s_add_u32 s50, s50, 5
    buffer_store_dwordx4 v[32:35], v12, s[8:11], s49 offen sc1
    buffer_store_dwordx4 v[32:35], v13, s[8:11], s49 offen sc1
    s_and_b32 s49, s50, 1
    s_lshr_b32 s51, s50, 1
    s_add_u32 s51, s51, s52
    s_mul_i32 s49, s49, 96
    s_add_u32 s49, s49, s51
    s_and_b32 s51, s51, 0x38
    s_add_u32 s49, s49, s51
    s_lshl_b32 s49, s49, 10
    s_add_u32 s49, s49, s48
    s_add_u32 s50, s50, 5
    buffer_store_dwordx4 v[36:39], v12, s[8:11], s49 offen sc1
    buffer_store_dwordx4 v[36:39], v13, s[8:11], s49 offen sc1
    s_and_b32 s49, s50, 1
    s_lshr_b32 s51, s50, 1
    s_cmp_eq_u32 s50, 24
    s_cselect_b32 s49, 2, s49
    s_cselect_b32 s51, 0, s51
    s_add_u32 s51, s51, s52
    s_mul_i32 s49, s49, 96
    s_add_u32 s49, s49, s51
    s_and_b32 s51, s51, 0x38
    s_add_u32 s49, s49, s51
    s_lshl_b32 s49, s49, 10
    s_add_u32 s49, s49, s48
    s_add_u32 s50, s50, 5
    buffer_store_dwordx4 v[40:43], v12, s[8:11], s49 offen sc1
    buffer_store_dwordx4 v[40:43], v13, s[8:11], s49 offen sc1
    s_branch L_ftd
L_noft:
    buffer_load_dwordx4 a[0:3], v15, s[8:11], s83 offen offset:0 sc1
    buffer_load_dwordx4 a[4:7], v15, s[8:11], s83 offen offset:1024 sc1
    buffer_load_dwordx4 a[8:11], v15, s[8:11], s83 offen offset:2048 sc1
    buffer_load_dwordx4 a[12:15], v15, s[8:11], s83 offen offset:3072 sc1
    s_add_u32 s83, s83, 0x1000
    buffer_load_dwordx4 a[16:19], v15, s[8:11], s83 offen offset:0 sc1
    buffer_load_dwordx4 a[20:23], v15, s[8:11], s83 offen offset:1024 sc1
    buffer_load_dwordx4 a[24:27], v15, s[8:11], s83 offen offset:2048 sc1
    buffer_load_dwordx4 a[28:31], v15, s[8:11], s83 offen offset:3072 sc1
    s_add_u32 s83, s83, 0x1000
    buffer_load_dwordx4 a[32:35], v15, s[8:11], s83 offen offset:0 sc1
    buffer_load_dwordx4 a[36:39], v15, s[8:11], s83 offen offset:1024 sc1
    buffer_load_dwordx4 a[40:43], v15, s[8:11], s83 offen offset:2048 sc1
    buffer_load_dwordx4 a[44:47], v15, s[8:11], s83 offen offset:3072 sc1
    s_add_u32 s83, s83, 0x1000
    buffer_load_dwordx4 a[48:51], v15, s[8:11], s83 offen offset:0 sc1
    buffer_load_dwordx4 a[52:55], v15, s[8:11], s83 offen offset:1024 sc1
    buffer_load_dwordx4 a[56:59], v15, s[8:11], s83 offen offset:2048 sc1
    buffer_load_dwordx4 a[60:63], v15, s[8:11], s83 offen offset:3072 sc1
    s_add_u32 s83, s83, 0x1000
    buffer_load_dwordx4 a[64:67], v15, s[8:11], s83 offen offset:0 sc1
    buffer_load_dwordx4 a[68:71], v15, s[8:11], s83 offen offset:1024 sc1
    buffer_load_dwordx4 a[72:75], v15, s[8:11], s83 offen offset:2048 sc1
    buffer_load_dwordx4 a[76:79], v15, s[8:11], s83 offen offset:3072 sc1
    s_add_u32 s83, s83, 0x1000
    buffer_load_dwordx4 a[80:83], v15, s[8:11], s83 offen offset:0 sc1
    buffer_load_dwordx4 a[84:87], v15, s[8:11], s83 offen offset:1024 sc1
    buffer_load_dwordx4 a[88:91], v15, s[8:11], s83 offen offset:2048 sc1
    buffer_load_dwordx4 a[92:95], v15, s[8:11], s83 offen offset:3072 sc1
    s_add_u32 s83, s83, 0x1000
L_ftd:
    s_and_b32 s48, s3, 1
    s_mul_i32 s48, s48, 10752
    s_lshr_b32 s49, s3, 1
    s_lshl_b32 s49, s49, 7
    s_add_u32 s48, s48, s49
    v_lshrrev_b32_e64 v6, 3, v0
    v_mul_u32_u24 v6, 1344, v6
    v_and_b32_e64 v7, 7, v0
    v_lshl_add_u32 v7, v7, 4, s48
    v_add_u32 v6, v6, v7
    s_waitcnt vmcnt(28)
    ds_write_b128 v6, v[48:51] offset:61568
    s_waitcnt vmcnt(27)
    ds_write_b128 v6, v[52:55] offset:61824
    s_waitcnt vmcnt(26)
    ds_write_b128 v6, v[56:59] offset:62080
    s_waitcnt vmcnt(25)
    ds_write_b128 v6, v[60:63] offset:62336
    s_waitcnt vmcnt(24)
    ds_write_b128 v6, v[64:67] offset:62592
    v_bfe_u32 v6, v0, 2, 2
    v_and_b32_e64 v7, 1, v2
    v_lshl_add_u32 v6, v7, 3, v6
    v_mul_u32_u24 v6, 1344, v6
    v_and_b32_e64 v7, 3, v0
    v_lshl_add_u32 v6, v7, 3, v6
    v_and_b32_e64 v7, 32, v0
    s_mul_i32 s48, s3, 320
    s_add_u32 s48, s48, 61568
    v_add3_u32 v6, v6, v7, s48
    v_lshrrev_b32_e64 v9, 5, v0
    v_mul_u32_u24 v9, 97792, v9
    v_lshl_add_u32 v9, v0, 4, v9
    s_and_b32 s52, s3, 1
    s_mul_i32 s52, s52, 1920
    s_add_u32 s52, s52, s56
    s_and_b32 s53, s56, 0x70
    s_add_u32 s52, s52, s53
    s_lshl_b32 s52, s52, 9
    s_lshr_b32 s54, s3, 1
    s_lshl_b32 s54, s54, 21
    s_add_u32 s52, s52, s54
    s_add_u32 s52, s52, 54525952
    s_add_u32 s54, s52, 8192
    s_waitcnt lgkmcnt(0)
    s_barrier
    s_nop 0
    ds_read_b64_tr_b16 v[48:49], v6 offset:0
    ds_read_b64_tr_b16 v[50:51], v6 offset:5376
    ds_read_b64_tr_b16 v[52:53], v6 offset:64
    ds_read_b64_tr_b16 v[54:55], v6 offset:5440
    ds_read_b64_tr_b16 v[56:57], v6 offset:128
    ds_read_b64_tr_b16 v[58:59], v6 offset:5504
    ds_read_b64_tr_b16 v[60:61], v6 offset:192
    ds_read_b64_tr_b16 v[62:63], v6 offset:5568
    ds_read_b64_tr_b16 v[64:65], v6 offset:256
    ds_read_b64_tr_b16 v[66:67], v6 offset:5632
    s_waitcnt lgkmcnt(8)
    buffer_store_dwordx4 v[48:51], v9, s[8:11], s52 offen sc1
    s_add_u32 s52, s52, 196608
    buffer_store_dwordx4 v[48:51], v9, s[8:11], s54 offen sc1
    s_add_u32 s54, s54, 196608
    s_waitcnt lgkmcnt(6)
    buffer_store_dwordx4 v[52:55], v9, s[8:11], s52 offen sc1
    s_add_u32 s52, s52, 196608
    buffer_store_dwordx4 v[52:55], v9, s[8:11], s54 offen sc1
    s_add_u32 s54, s54, 196608
    s_waitcnt lgkmcnt(4)
    buffer_store_dwordx4 v[56:59], v9, s[8:11], s52 offen sc1
    s_add_u32 s52, s52, 196608
    buffer_store_dwordx4 v[56:59], v9, s[8:11], s54 offen sc1
    s_add_u32 s54, s54, 196608
    s_waitcnt lgkmcnt(2)
    buffer_store_dwordx4 v[60:63], v9, s[8:11], s52 offen sc1
    s_add_u32 s52, s52, 196608
    buffer_store_dwordx4 v[60:63], v9, s[8:11], s54 offen sc1
    s_add_u32 s54, s54, 196608
    s_waitcnt lgkmcnt(0)
    s_nop 0
    buffer_store_dwordx4 v[64:67], v9, s[8:11], s52 offen sc1
    buffer_store_dwordx4 v[64:67], v9, s[8:11], s54 offen sc1
    buffer_load_dwordx4 a[96:99], v15, s[8:11], s83 offen offset:0 sc1
    buffer_load_dwordx4 a[100:103], v15, s[8:11], s83 offen offset:1024 sc1
    buffer_load_dwordx4 a[104:107], v15, s[8:11], s83 offen offset:2048 sc1
    buffer_load_dwordx4 a[108:111], v15, s[8:11], s83 offen offset:3072 sc1
    s_add_u32 s83, s83, 0x1000
    buffer_load_dwordx4 a[112:115], v15, s[8:11], s83 offen offset:0 sc1
    buffer_load_dwordx4 a[116:119], v15, s[8:11], s83 offen offset:1024 sc1
    buffer_load_dwordx4 a[120:123], v15, s[8:11], s83 offen offset:2048 sc1
    buffer_load_dwordx4 a[124:127], v15, s[8:11], s83 offen offset:3072 sc1
    s_add_u32 s83, s83, 0x1000
    buffer_load_dwordx4 a[128:131], v15, s[8:11], s83 offen offset:0 sc1
    buffer_load_dwordx4 a[132:135], v15, s[8:11], s83 offen offset:1024 sc1
    buffer_load_dwordx4 a[136:139], v15, s[8:11], s83 offen offset:2048 sc1
    buffer_load_dwordx4 a[140:143], v15, s[8:11], s83 offen offset:3072 sc1
    s_add_u32 s83, s83, 0x1000
    buffer_load_dwordx4 a[144:147], v15, s[8:11], s83 offen offset:0 sc1
    buffer_load_dwordx4 a[148:151], v15, s[8:11], s83 offen offset:1024 sc1
    buffer_load_dwordx4 a[152:155], v15, s[8:11], s83 offen offset:2048 sc1
    buffer_load_dwordx4 a[156:159], v15, s[8:11], s83 offen offset:3072 sc1
    s_add_u32 s83, s83, 0x1000
    s_add_u32 s48, s92, 96
    v_mov_b32_e64 v10, 1
    v_mul_u32_u24 v11, 4096, v0
    v_lshl_add_u32 v11, s3, 28, v11
    s_mov_b64 exec, 0xff
    s_waitcnt vmcnt(16) lgkmcnt(0)
    s_barrier
    buffer_atomic_add v10, v11, s[8:11], s48 offen sc1
    s_mov_b64 exec, -1
    s_nop 0
    buffer_load_dwordx4 a[160:163], v15, s[8:11], s83 offen offset:0 sc1
    buffer_load_dwordx4 a[164:167], v15, s[8:11], s83 offen offset:1024 sc1
    buffer_load_dwordx4 a[168:171], v15, s[8:11], s83 offen offset:2048 sc1
    buffer_load_dwordx4 a[172:175], v15, s[8:11], s83 offen offset:3072 sc1
    s_add_u32 s83, s83, 0x1000
    buffer_load_dwordx4 a[176:179], v15, s[8:11], s83 offen offset:0 sc1
    buffer_load_dwordx4 a[180:183], v15, s[8:11], s83 offen offset:1024 sc1
    buffer_load_dwordx4 a[184:187], v15, s[8:11], s83 offen offset:2048 sc1
    buffer_load_dwordx4 a[188:191], v15, s[8:11], s83 offen offset:3072 sc1
    s_add_u32 s83, s83, 0x3000
    buffer_load_dwordx4 a[224:227], v15, s[8:11], s83 offen offset:0 sc1
    buffer_load_dwordx4 a[228:231], v15, s[8:11], s83 offen offset:1024 sc1
    buffer_load_dwordx4 a[232:235], v15, s[8:11], s83 offen offset:2048 sc1
    buffer_load_dwordx4 a[236:239], v15, s[8:11], s83 offen offset:3072 sc1
    s_add_u32 s83, s83, 0x1000
    s_branch L_g1b
L_slow0:
    s_mov_b32 s7, 0x20000
L_poll_19:
    buffer_load_dword v76, v77, s[36:39], 0 offen sc1
    s_waitcnt vmcnt(0)
    v_cmp_gt_u32 vcc, s4, v76
    s_nop 0
    s_cbranch_vccz L_polld_20
    s_sleep 4
    s_sub_u32 s7, s7, 1
    s_cmp_eq_u32 s7, 0
    s_cbranch_scc0 L_poll_19
L_polld_20:
    s_branch L_back0
L_slow1:
    s_mov_b32 s7, 0x20000
L_poll_21:
    buffer_load_dword v76, v79, s[8:11], s5 offen sc1
    s_waitcnt vmcnt(0)
    v_and_b32 v78, 0x80008, v76
    v_cmp_eq_u32_e64 vcc, 0, v78
    s_nop 0
    s_cbranch_vccz L_polld_22
    s_sleep 4
    s_sub_u32 s7, s7, 1
    s_cmp_eq_u32 s7, 0
    s_cbranch_scc0 L_poll_21
L_polld_22:
    s_branch L_back1
L_slow2:
    s_mov_b32 s7, 0x20000
L_poll_23:
    buffer_load_dword v76, v77, s[36:39], 0 offen sc1
    s_waitcnt vmcnt(0)
    v_cmp_gt_u32_e64 vcc, s4, v76
    s_nop 0
    s_cbranch_vccz L_polld_24
    s_sleep 4
    s_sub_u32 s7, s7, 1
    s_cmp_eq_u32 s7, 0
    s_cbranch_scc0 L_poll_23
L_polld_24:
    s_branch L_back2
L_slow3:
    s_mov_b32 s7, 0x20000
L_poll_25:
    buffer_load_dword v76, v77, s[36:39], 0 offen sc1
    s_waitcnt vmcnt(0)
    v_cmp_gt_u32_e64 vcc, s4, v76
    s_nop 0
    s_cbranch_vccz L_polld_26
    s_sleep 4
    s_sub_u32 s7, s7, 1
    s_cmp_eq_u32 s7, 0
    s_cbranch_scc0 L_poll_25
L_polld_26:
    s_branch L_back3
L_slow4:
    s_mov_b32 s7, 0x20000
L_poll_27:
    buffer_load_dword v76, v79, s[8:11], s5 offen sc1
    s_waitcnt vmcnt(0)
    v_and_b32 v78, 0x80008, v76
    v_cmp_eq_u32_e64 vcc, 0, v78
    s_nop 0
    s_cbranch_vccz L_polld_28
    s_sleep 4
    s_sub_u32 s7, s7, 1
    s_cmp_eq_u32 s7, 0
    s_cbranch_scc0 L_poll_27
L_polld_28:
    s_branch L_back4
L_slow5:
    s_mov_b32 s7, 0x20000
L_poll_29:
    buffer_load_dword v14, v10, s[8:11], s55 offen sc1
    s_sub_u32 s7, s7, 1
    s_cbranch_scc1 L_polld_30
    s_waitcnt vmcnt(0)
    v_cmp_gt_u32_e64 vcc, 8, v14
    s_nop 0
    s_cbranch_vccnz L_poll_29
L_polld_30:
    s_branch L_back5
L_slow6:
    s_mov_b32 s7, 0x20000
L_poll_31:
    buffer_load_dword v12, v240, s[8:11], s98 offen sc1
    s_sub_u32 s7, s7, 1
    s_cbranch_scc1 L_polld_32
    s_waitcnt vmcnt(0)
    v_cmp_gt_u32_e64 vcc, 8, v12
    s_nop 0
    s_cbranch_vccnz L_poll_31
L_polld_32:
    s_branch L_back6
L_slow7:
    s_mov_b32 s7, 0x20000
L_poll_33:
    buffer_load_dword v12, v11, s[8:11], s55 offen sc1
    s_sub_u32 s7, s7, 1
    s_cbranch_scc1 L_polld_34
    s_waitcnt vmcnt(0)
    v_cmp_eq_u32_e64 vcc, 0, v12
    s_nop 0
    s_cbranch_vccnz L_poll_33
L_polld_34:
    s_branch L_back7
L_slow8:
    s_mov_b32 s7, 0x20000
L_poll_35:
    buffer_load_dword v246, v245, s[8:11], s55 offen sc1
    s_sub_u32 s7, s7, 1
    s_cbranch_scc1 L_polld_36
    s_waitcnt vmcnt(0)
    v_cmp_eq_u32_e64 vcc, 0, v246
    s_nop 0
    s_cbranch_vccnz L_poll_35
L_polld_36:
    s_branch L_back8
L_slow9:
    s_mov_b32 s7, 0x20000
L_poll_37:
    buffer_load_dword v12, v240, s[8:11], s98 offen sc1
    s_sub_u32 s7, s7, 1
    s_cbranch_scc1 L_polld_38
    s_waitcnt vmcnt(0)
    v_cmp_gt_u32_e64 vcc, 8, v12
    s_nop 0
    s_cbranch_vccnz L_poll_37
L_polld_38:
    s_branch L_back9
L_slow10:
    s_mov_b32 s7, 0x20000
L_poll_39:
    buffer_load_dword v12, v11, s[8:11], s55 offen sc1
    s_sub_u32 s7, s7, 1
    s_cbranch_scc1 L_polld_40
    s_waitcnt vmcnt(0)
    v_cmp_eq_u32_e64 vcc, 0, v12
    s_nop 0
    s_cbranch_vccnz L_poll_39
L_polld_40:
    s_branch L_back10
L_slow11:
    s_mov_b32 s7, 0x20000
L_poll_41:
    buffer_load_dword v12, v11, s[8:11], s55 offen sc1
    s_sub_u32 s7, s7, 1
    s_cbranch_scc1 L_polld_42
    s_waitcnt vmcnt(0)
    v_cmp_eq_u32 vcc, 0, v12
    s_nop 0
    s_cbranch_vccnz L_poll_41
L_polld_42:
    s_branch L_back11
L_last:
.section .rodata,"a"
.p2align 6
.amdhsa_kernel interleave_layers__spectral_gfnet__glu_gated_reglu__prompt_kernel
  .amdhsa_next_free_vgpr 512
  .amdhsa_next_free_sgpr 102
  .amdhsa_accum_offset 256
  .amdhsa_group_segment_fixed_size 0
  .amdhsa_kernarg_size 80
  .amdhsa_user_sgpr_count 2
  .amdhsa_user_sgpr_kernarg_segment_ptr 1
  .amdhsa_system_sgpr_workgroup_id_x 1
  .amdhsa_float_denorm_mode_32 3
.end_amdhsa_kernel
```
